```python
import torch

def _softmax(x, axis=-1):
    return torch.softmax(x, dim=axis)
def _gelu(x):
    return torch.nn.functional.gelu(x, approximate="tanh")
def _silu(x):
    return torch.nn.functional.silu(x)
def _sigmoid(x):
    return torch.sigmoid(x)
def _layernorm(x, axis=-1, eps=1e-5):
    m = x.mean(dim=axis, keepdim=True)
    v = x.var(dim=axis, keepdim=True, unbiased=False)
    return (x - m) / torch.sqrt(v + eps)
def _scatter_add(tgt, idx, src, axis=0):
    return tgt.clone().index_add_(axis, idx, src)
def _segment_sum(src, seg, n):
    out = torch.zeros((n,) + src.shape[1:], dtype=src.dtype)
    return out.index_add_(0, seg, src)
def _pad(x, pw):
    flat = tuple(v for pair in reversed(pw) for v in pair)
    return torch.nn.functional.pad(x, flat)

kernel_name = 'interleave_layers__ssm_conv_h3__glu_gated_reglu__prompt'

def setup_inputs():

    _w = (lambda a: (lambda t: t.to(torch.bfloat16) if t.is_floating_point() else t)(torch.as_tensor(a)))
    def _A_setup():
        B, S, D = 1, 2048, 512
        ks = 4
        return {
            "q": _w((lambda *s: torch.randn(*s, dtype=torch.bfloat16) * 0.05)(B, S, D)),
            "k": _w((lambda *s: torch.randn(*s, dtype=torch.bfloat16) * 0.4)(B, S, D)),
            "v": _w((lambda *s: torch.randn(*s, dtype=torch.bfloat16) * 0.4)(B, S, D)),
            "shift_k": _w((lambda *s: torch.randn(*s, dtype=torch.bfloat16) * 0.4)(D, ks) * 0.5),
            "ssm_k": _w((lambda *s: torch.randn(*s, dtype=torch.bfloat16) * 0.4)(D, S) * (1.0 / S ** 0.5)),
            "ssm_D": _w((lambda *s: torch.randn(*s, dtype=torch.bfloat16) * 0.4)(D)),
        }
    _A_in = _A_setup()

    def _B_setup():
        B, S, D, F = 1, 2048, 512, 1376
        return {
            "x": _w((lambda *s: torch.randn(*s, dtype=torch.bfloat16) * 0.05)(B, S, D)),
            "W_gate": _w((lambda *s: torch.randn(*s, dtype=torch.bfloat16) * 0.8)(D, F) * (2.0 / D) ** 0.5),
            "W_up": _w((lambda *s: torch.randn(*s, dtype=torch.bfloat16) * 0.8)(D, F) * (2.0 / D) ** 0.5),
            "W_down": _w((lambda *s: torch.randn(*s, dtype=torch.bfloat16) * 0.8)(F, D) * (1.0 / F) ** 0.5),
        }
    _B_in = _B_setup()

    return {
        "A_q": _A_in["q"],
        "A_k": _A_in["k"],
        "A_v": _A_in["v"],
        "A_shift_k": _A_in["shift_k"],
        "A_ssm_k": _A_in["ssm_k"],
        "A_ssm_D": _A_in["ssm_D"],
        "B_x": _B_in["x"],
        "B_W_gate": _B_in["W_gate"],
        "B_W_up": _B_in["W_up"],
        "B_W_down": _B_in["W_down"],
    }

def reference(A_q, A_k, A_v, A_shift_k, A_ssm_k, A_ssm_D, B_x, B_W_gate, B_W_up, B_W_down):
    def _A_ref(q, k, v, shift_k, ssm_k, ssm_D):
        B, S, D = q.shape
        ks = shift_k.shape[-1]
        k_pad = _pad(k, ((0, 0), (ks - 1, 0), (0, 0)))
        k_shift = torch.zeros_like(k)
        for t in range(ks):
            k_shift = k_shift + k_pad[:, t:t + S, :] * shift_k[:, ks - 1 - t][None, None, :]
        kv = k_shift * v
        L = 2 * S
        kv_pad = _pad(kv, ((0, 0), (0, S), (0, 0)))
        kf_pad = _pad(ssm_k, ((0, 0), (0, S)))
        kv_f = (lambda x, axes=(-2,-1): torch.fft.rfft2(x.float(), dim=axes))(kv_pad[:, None, :, :], axes=(1, 2))
        kf_f = (lambda x, axes=(-2,-1): torch.fft.rfft2(x.float(), dim=axes))(kf_pad[:, None, :], axes=(1, 2))
        kf_f = (lambda x, *d: x.permute(*d))(kf_f, 1, 2, 0)
        y_f = kv_f * kf_f[None, :, :, :]
        y = (lambda x, s, axes=(-2,-1): torch.fft.irfft2(x, s=s, dim=axes).to(torch.bfloat16))(y_f, (1, L), axes=(1, 2))[:, 0, :S, :]
        y = y + kv * ssm_D[None, None, :]
        return q * y

    def _B_ref(x, W_gate, W_up, W_down):
        gate = torch.einsum("bsd,df->bsf", x, W_gate)
        up = torch.einsum("bsd,df->bsf", x, W_up)
        gate = gate * (lambda x, dt: x.to(dt))(gate > 0, gate.dtype)
        h = gate * up
        return torch.einsum("bsf,fd->bsd", h, W_down)

    x = A_q
    x = x + _A_ref(_layernorm(x, axis=-1), A_k, A_v, A_shift_k, A_ssm_k, A_ssm_D)
    x = x + _B_ref(_layernorm(x, axis=-1), B_W_gate, B_W_up, B_W_down)
    x = x + _A_ref(_layernorm(x, axis=-1), A_k, A_v, A_shift_k, A_ssm_k, A_ssm_D)
    x = x + _B_ref(_layernorm(x, axis=-1), B_W_gate, B_W_up, B_W_down)
    return x
```

```asm
; @launch grid=(256,1,1) block=(256,1,1) lds=163840
.amdgcn_target "amdgcn-amd-amdhsa--gfx950"
.text
.globl interleave_layers__ssm_conv_h3__glu_gated_reglu__prompt_kernel
.p2align 8
.type interleave_layers__ssm_conv_h3__glu_gated_reglu__prompt_kernel,@function
interleave_layers__ssm_conv_h3__glu_gated_reglu__prompt_kernel:
  s_cmp_ge_u32 s2, 256
  s_cbranch_scc1 L_end
  s_load_dwordx16 s[64:79], s[0:1], 0
  s_load_dwordx8 s[80:87], s[0:1], 64
  s_load_dwordx2 s[16:17], s[0:1], 96
  v_lshrrev_b32 v40, 6, v0
  v_and_b32 v135, 63, v0
  s_and_b32 s4, s2, 7
  s_lshr_b32 s5, s2, 3
  v_readfirstlane_b32 s6, v40
  v_lshlrev_b32 v1, 4, v135
  s_getpc_b64 s[60:61]
L_pc:
  s_lshl_b32 s3, s6, 5
  s_add_u32 s3, s3, s5
  s_lshl_b32 s3, s3, 10
  v_add_u32 v42, s3, v1
  v_min_u32 v42, L_fast_end-L_pc-16, v42
  v_mov_b32 v43, s61
  v_add_co_u32 v42, vcc, s60, v42
  v_lshrrev_b32 v48, 3, v135
  v_and_b32 v49, 7, v135
  v_addc_co_u32 v43, vcc, 0, v43, vcc
  global_load_dwordx4 v[44:47], v[42:43], off
  v_lshlrev_b32 v49, 4, v49
  v_lshl_add_u32 v126, v48, 10, v49
  s_lshl_b32 s3, s5, 16
  s_lshl_b32 s15, s4, 7
  s_add_u32 s3, s3, s15
  s_sub_u32 s15, s3, 8192
  v_add_u32 v49, s15, v126
  s_lshl_b32 s15, s6, 13
  s_add_u32 s3, s3, s15
  v_add_u32 v48, s3, v126
  s_mul_i32 s15, s6, 1056
  s_mov_b32 s63, 32768
  s_mov_b32 s22, 2097152
  s_mov_b32 s23, 0x20000
  s_mov_b32 s26, 2097152
  s_mov_b32 s27, 0x20000
  s_mov_b32 s18, 268435456
  s_mov_b32 s19, 0x20000
  s_mov_b32 s54, 4096
  s_mov_b32 s55, 0x20000
  v_and_b32 v136, 15, v135
  v_lshrrev_b32 v137, 4, v135
  s_lshl_b32 s3, s4, 6
  s_lshl_b32 s60, s6, 4
  s_add_u32 s3, s3, s60
  v_add_u32 v55, s3, v136
  v_lshlrev_b32 v78, 3, v55
  v_mov_b32 v50, 0
  s_add_u32 m0, s15, 43552
  s_mov_b32 s60, 60448
  s_waitcnt lgkmcnt(0)
  s_mov_b64 s[20:21], s[66:67]
  s_mov_b64 s[24:25], s[68:69]
  buffer_load_dwordx4 v48, s[20:23], 0 offen lds
  s_add_u32 m0, s15, 52000
  s_nop 0
  buffer_load_dwordx4 v48, s[24:27], 0 offen lds
  s_add_u32 m0, s15, 47776
  s_nop 0
  buffer_load_dwordx4 v48, s[20:23], s63 offen lds
  s_add_u32 m0, s15, 56224
  s_nop 0
  buffer_load_dwordx4 v48, s[24:27], s63 offen lds
  s_cmp_eq_u32 s6, 3
  s_cselect_b32 m0, 42496, s60
  s_cselect_b32 s63, 0, 2147483392
  buffer_load_dwordx4 v49, s[20:23], s63 offen lds
  s_mov_b64 s[52:53], s[70:71]
  s_mov_b64 s[32:33], s[72:73]
  s_mov_b64 s[56:57], s[74:75]
  s_mov_b64 s[28:29], s[64:65]
  s_mov_b64 s[36:37], s[78:79]
  s_mov_b64 s[40:41], s[80:81]
  s_mov_b64 s[44:45], s[82:83]
  s_mov_b64 s[48:49], s[84:85]
  buffer_load_dwordx2 v[80:81], v78, s[52:55], 0 offen
  buffer_load_dword v51, v50, s[16:19], 0 offen sc1
  s_mov_b32 s34, 4096
  s_mov_b32 s35, 0x20000
  s_mov_b32 s58, 1024
  s_mov_b32 s59, 0x20000
  s_mov_b32 s30, 2097152
  s_mov_b32 s31, 0x20000
  s_mov_b32 s38, 1409024
  s_mov_b32 s39, 0x20000
  s_mov_b32 s42, 1409024
  s_mov_b32 s43, 0x20000
  s_mov_b32 s46, 1409024
  s_mov_b32 s47, 0x20000
  s_mov_b32 s50, 2097152
  s_mov_b32 s51, 0x20000
  s_lshr_b32 s3, s5, 4
  s_lshl_b32 s7, s4, 1
  s_add_u32 s7, s7, s3
  s_and_b32 s8, s5, 15
  s_lshr_b32 s9, s8, 3
  s_and_b32 s10, s8, 7
  s_lshr_b32 s11, s6, 1
  s_and_b32 s12, s6, 1
  s_waitcnt lgkmcnt(0)
  s_mov_b32 s0, 0x100000
  s_cmp_eq_u32 s8, 15
  s_cselect_b32 s38, 0, s38
  s_cselect_b32 s42, 0, s42
  s_lshl_b32 s3, s4, 6
  s_lshl_b32 s15, s5, 1
  s_add_u32 s3, s3, s15
  s_add_u32 s60, s3, s11
  s_lshl_b32 s3, s60, 12
  s_add_u32 s32, s32, s3
  s_addc_u32 s33, s33, 0
  s_lshl_b32 s3, s12, 11
  v_add_u32 v52, s3, v1
  v_min_u32 v53, 1, v135
  v_lshlrev_b32 v53, 4, v53
  v_subrev_u32 v53, 32, v53
  s_lshl_b32 s3, s60, 1
  v_mov_b32 v139, s3
  s_mul_i32 s3, s11, 4608
  s_lshl_b32 s15, s12, 11
  s_add_u32 s3, s3, s15
  s_add_u32 m0, s3, 33792
  s_nop 0
  buffer_load_dwordx4 v1, s[32:35], s15 offen lds
  buffer_load_dwordx4 v1, s[32:35], s15 offen offset:1024 lds
  buffer_load_ushort v139, v139, s[56:59], 0 offen
  v_and_b32 v96, 1, v137
  v_lshlrev_b32 v96, 2, v96
  v_lshrrev_b32 v97, 2, v136
  v_add_u32 v96, v96, v97
  v_lshlrev_b32 v96, 16, v96
  v_and_b32 v97, 3, v136
  v_lshl_add_u32 v96, v97, 5, v96
  v_lshrrev_b32 v97, 1, v137
  v_lshl_add_u32 v96, v97, 4, v96
  s_lshl_b32 s3, s12, 19
  s_lshl_b32 s15, s60, 7
  s_add_u32 s3, s3, s15
  s_add_u32 s3, s3, 4194304
  v_add_u32 v138, s3, v96
  s_mov_b32 s14, s60
  v_mov_b32 v2, 2147483392
  v_cmp_eq_u32 vcc, 0, v135
  s_nop 1
  v_cndmask_b32 v2, v2, v50, vcc
  s_lshl_b32 s3, s7, 2
  s_lshl_b32 s15, s9, 1
  s_add_u32 s15, s15, s11
  s_add_u32 s3, s3, s15
  s_lshl_b32 s15, s11, 1
  s_add_u32 s15, s15, s9
  s_lshl_b32 s72, s3, 12
  s_add_u32 s72, s72, 1048576
  s_lshl_b32 s73, s3, 10
  s_add_u32 s73, s73, 262144
  s_lshl_b32 s61, s10, 1
  s_add_u32 s61, s61, s12
  s_lshl_b32 s70, s61, 8
  s_add_u32 s70, s70, s72
  s_lshl_b32 s71, s61, 2
  s_add_u32 s71, s71, s73
  s_lshl_b32 s68, s7, 17
  s_lshl_b32 s15, s15, 14
  s_add_u32 s68, s68, s15
  s_lshl_b32 s15, s4, 1
  s_sub_u32 s15, s61, s15
  s_and_b32 s15, s15, 15
  s_lshl_b32 s15, s15, 10
  s_add_u32 s68, s68, s15
  s_add_u32 s68, s68, 2097152
  s_lshl_b32 s3, s3, 14
  s_lshl_b32 s15, s61, 6
  s_add_u32 s3, s3, s15
  v_lshlrev_b32 v3, 10, v136
  v_lshl_add_u32 v3, v137, 4, v3
  v_add_u32 v3, s3, v3
  v_lshlrev_b32 v4, 4, v136
  v_lshl_add_u32 v5, v137, 10, v4
  v_lshl_add_u32 v4, v137, 2, v4
  v_lshlrev_b32 v7, 6, v136
  v_mov_b32 v6, 2147483392
  v_cmp_eq_u32 vcc, 0, v137
  s_nop 1
  v_cndmask_b32 v6, v6, v7, vcc
  v_lshl_add_u32 v7, v137, 4, v7
  s_lshl_b32 s3, s4, 5
  s_add_u32 s3, s3, s5
  s_lshl_b32 s76, s3, 7
  s_lshl_b32 s3, s6, 2
  s_add_u32 s76, s76, s3
  s_add_u32 s76, s76, 65536
  s_lshl_b32 s64, s12, 14
  s_lshl_b32 s3, s11, 12
  s_add_u32 s64, s64, s3
  s_lshl_b32 s3, s7, 17
  s_add_u32 s3, s3, s64
  s_add_u32 s3, s3, 2097152
  v_add_u32 v8, s3, v1
  s_lshl_b32 s65, s6, 13
  s_mul_i32 s66, s11, 24576
  s_lshl_b32 s67, s11, 13
  s_add_u32 s67, s67, 8192
  s_lshl_b32 s3, s7, 3
  s_add_u32 s15, s9, s3
  s_mul_i32 s15, s15, 48
  s_mul_i32 s61, s11, 21
  s_add_u32 s15, s15, s61
  s_lshl_b32 s15, s15, 10
  s_add_u32 s15, s15, 6291456
  v_add_u32 v9, s15, v1
  s_mul_i32 s3, s3, 49152
  s_mul_i32 s15, s8, 12
  s_mul_i32 s61, s6, 3
  s_add_u32 s15, s15, s61
  s_lshl_b32 s15, s15, 8
  s_add_u32 s3, s3, s15
  s_add_u32 s3, s3, 6291456
  s_mov_b32 s15, 49152
  v_lshlrev_b32 v97, 4, v136
  v_add_u32 v97, s3, v97
  v_and_b32 v98, 1, v137
  v_mad_u32_u24 v10, v98, s15, v97
  v_add_u32 v11, 512, v10
  v_cmp_gt_u32 vcc, 32, v135
  v_mov_b32 v97, 2147483392
  s_nop 0
  v_cndmask_b32 v11, v97, v11, vcc
  v_lshrrev_b32 v98, 1, v137
  v_lshl_add_u32 v10, v98, 8, v10
  v_lshlrev_b32 v12, 2, v135
  v_min_u32 v13, 57, v135
  v_lshlrev_b32 v13, 2, v13
  s_lshl_b32 s69, s7, 9
  s_lshl_b32 s1, s8, 2
  s_add_u32 s1, s1, s6
  s_lshl_b32 s1, s1, 2
  s_add_u32 s1, s1, s69
  s_nop 0
  s_lshl_b32 s3, s8, 2
  s_add_u32 s3, s3, s6
  s_cmp_ge_u32 s3, 58
  s_cselect_b32 s3, 0x40000000, 0
  v_or_b32 v10, s3, v10
  v_or_b32 v11, s3, v11
  s_cmp_eq_u32 s8, 15
  s_cselect_b32 s3, 0x40000000, 0
  v_or_b32 v8, s3, v8
  v_add_u32 v100, 0, v135
  v_mul_u32_u24 v101, 43691, v100
  v_lshrrev_b32 v101, 19, v101
  v_mul_u32_u24 v102, 12, v101
  v_sub_u32 v100, v100, v102
  v_lshlrev_b32 v100, 4, v100
  v_lshrrev_b32 v102, 3, v101
  v_lshlrev_b32 v102, 5, v102
  v_sub_u32 v100, v100, v102
  v_add_u32 v102, 192, v100
  v_min_u32 v100, v100, v102
  v_mul_u32_u24 v101, 2752, v101
  v_add_u32 v129, v100, v101
  s_cmp_eq_u32 s8, 14
  s_cselect_b32 s3, 64, 192
  v_cmp_gt_u32 vcc, s3, v100
  v_mov_b32 v101, 0x40000000
  s_nop 0
  v_cndmask_b32 v129, v101, v129, vcc
  v_add_u32 v100, 64, v135
  v_mul_u32_u24 v101, 43691, v100
  v_lshrrev_b32 v101, 19, v101
  v_mul_u32_u24 v102, 12, v101
  v_sub_u32 v100, v100, v102
  v_lshlrev_b32 v100, 4, v100
  v_lshrrev_b32 v102, 3, v101
  v_lshlrev_b32 v102, 5, v102
  v_sub_u32 v100, v100, v102
  v_add_u32 v102, 192, v100
  v_min_u32 v100, v100, v102
  v_mul_u32_u24 v101, 2752, v101
  v_add_u32 v130, v100, v101
  s_cmp_eq_u32 s8, 14
  s_cselect_b32 s3, 64, 192
  v_cmp_gt_u32 vcc, s3, v100
  v_mov_b32 v101, 0x40000000
  s_nop 0
  v_cndmask_b32 v130, v101, v130, vcc
  v_add_u32 v100, 128, v135
  v_mul_u32_u24 v101, 43691, v100
  v_lshrrev_b32 v101, 19, v101
  v_mul_u32_u24 v102, 12, v101
  v_sub_u32 v100, v100, v102
  v_lshlrev_b32 v100, 4, v100
  v_lshrrev_b32 v102, 3, v101
  v_lshlrev_b32 v102, 5, v102
  v_sub_u32 v100, v100, v102
  v_add_u32 v102, 192, v100
  v_min_u32 v100, v100, v102
  v_mul_u32_u24 v101, 2752, v101
  v_add_u32 v131, v100, v101
  s_cmp_eq_u32 s8, 14
  s_cselect_b32 s3, 64, 192
  v_cmp_gt_u32 vcc, s3, v100
  v_mov_b32 v101, 0x40000000
  s_nop 0
  v_cndmask_b32 v131, v101, v131, vcc
  s_mul_i32 s3, s6, 44032
  s_mul_i32 s15, s8, 192
  s_add_u32 s3, s3, s15
  v_add_u32 v129, s3, v129
  v_add_u32 v130, s3, v130
  v_subrev_u32 v130, 1024, v130
  v_add_u32 v131, s3, v131
  v_subrev_u32 v131, 2048, v131
  v_bfe_u32 v100, v135, 2, 2
  v_lshl_add_u32 v100, v137, 3, v100
  v_and_b32 v101, 3, v135
  v_mul_u32_u24 v102, 192, v100
  s_mul_i32 s3, s6, 48
  v_and_b32 v104, 1, v137
  v_lshlrev_b32 v104, 5, v104
  v_add_u32 v104, s3, v104
  v_lshl_add_u32 v103, v101, 3, v104
  v_subrev_u32 v105, 192, v103
  v_min_u32 v103, v103, v105
  v_add_u32 v132, v102, v103
  v_lshrrev_b32 v103, 1, v101
  v_lshl_add_u32 v103, v103, 3, v104
  v_add_u32 v103, 32, v103
  v_subrev_u32 v105, 192, v103
  v_min_u32 v103, v103, v105
  v_add_u32 v102, v102, v103
  v_and_b32 v103, 1, v101
  v_mul_u32_u24 v103, 12288, v103
  v_add_u32 v133, v102, v103
  v_lshlrev_b32 v102, 7, v100
  v_lshl_add_u32 v102, v101, 4, v102
  s_lshl_b32 s15, s6, 12
  s_add_u32 s15, s15, 139264
  v_add_u32 v127, s15, v102
  s_mul_i32 s74, s6, 3072
  v_mul_u32_u24 v83, 2112, v137
  v_bfe_u32 v101, v135, 2, 2
  v_lshl_add_u32 v83, v101, 7, v83
  v_and_b32 v101, 3, v135
  v_lshl_add_u32 v83, v101, 3, v83
  s_lshl_b32 s3, s6, 5
  v_add_u32 v83, s3, v83
  v_and_b32 v55, -9, v55
  v_lshlrev_b32 v55, 12, v55
  v_lshl_add_u32 v55, v137, 5, v55
  v_lshrrev_b32 v101, 3, v136
  v_lshl_add_u32 v55, v101, 4, v55
  s_lshl_b32 s3, s5, 7
  s_add_u32 s3, s3, 2097152
  v_add_u32 v55, s3, v55
  v_lshrrev_b32 v100, 5, v135
  v_mul_u32_u24 v100, 4096, v100
  v_add_u32 v100, v100, v1
  v_mov_b32 v104, 0
  v_mov_b32 v105, 0
  v_mov_b32 v106, 0
  v_mov_b32 v107, 0
  ds_write_b128 v100, v[104:107] offset:33280
  s_lshl_b32 s3, s6, 12
  s_add_u32 s15, s3, 42496
  v_add_u32 v160, s15, v1
  s_lshl_b32 s60, s12, 11
  v_add_u32 v161, s60, v160
  v_xor_b32 v162, 4096, v1
  s_xor_b32 s3, s3, 4096
  s_add_u32 s3, s3, s60
  s_add_u32 s3, s3, 42496
  v_add_u32 v162, s3, v1
  s_lshl_b32 s3, s12, 10
  s_mul_i32 s15, s11, 4608
  s_add_u32 s3, s3, s15
  s_add_u32 s3, s3, 33800
  v_lshlrev_b32 v163, 5, v136
  v_lshrrev_b32 v100, 1, v137
  v_lshl_add_u32 v163, v100, 4, v163
  v_and_b32 v100, 1, v137
  v_lshlrev_b32 v100, 3, v100
  v_sub_u32 v163, v163, v100
  v_add_u32 v163, s3, v163
  v_lshrrev_b32 v100, 2, v0
  v_lshlrev_b32 v100, 7, v100
  v_and_b32 v101, 3, v0
  v_lshl_add_u32 v100, v101, 4, v100
  s_lshl_b32 s3, s7, 16
  s_lshl_b32 s15, s10, 13
  s_add_u32 s3, s3, s15
  s_lshl_b32 s15, s9, 6
  s_add_u32 s3, s3, s15
  s_add_u32 s3, s3, 4194304
  v_add_u32 v164, s3, v100
  v_lshlrev_b32 v165, 4, v0
  v_add_u32 v165, 155648, v165
  v_bfe_u32 v100, v135, 2, 2
  v_lshl_add_u32 v100, v137, 3, v100
  v_lshlrev_b32 v100, 6, v100
  v_and_b32 v101, 3, v135
  v_lshl_add_u32 v100, v101, 3, v100
  s_lshl_b32 s3, s12, 11
  s_lshl_b32 s15, s11, 5
  s_add_u32 s3, s3, s15
  s_add_u32 s3, s3, 155648
  v_add_u32 v166, s3, v100
  v_and_b32 v100, 7, v135
  v_lshlrev_b32 v100, 7, v100
  v_bfe_u32 v101, v135, 3, 2
  v_lshl_add_u32 v100, v101, 14, v100
  s_lshl_b32 s3, s69, 1
  s_add_u32 s3, s3, 524288
  v_add_u32 v167, s3, v100
  v_and_b32 v100, 31, v135
  v_lshlrev_b32 v100, 7, v100
  v_cmp_gt_u32 vcc, 32, v135
  s_lshl_b32 s3, s10, 12
  s_lshl_b32 s15, s4, 12
  v_mov_b32 v101, s3
  v_mov_b32 v102, s15
  v_cndmask_b32 v101, v101, v102, vcc
  v_add_u32 v100, 65536, v100
  v_add_u32 v15, v100, v101
  s_and_b32 s60, s6, 1
  s_lshl_b32 s60, s60, 11
  s_cmp_lt_u32 s6, 2
  s_cselect_b32 s3, s15, s3
  s_add_u32 s3, s3, s60
  s_add_u32 s3, s3, 65536
  v_lshlrev_b32 v100, 7, v136
  v_add_u32 v15, s3, v100
  s_lshl_b32 s3, s14, 12
  s_lshl_b32 s15, s12, 11
  s_add_u32 s3, s3, s15
  s_add_u32 s3, s3, 2097152
  v_lshlrev_b32 v100, 7, v135
  v_add_u32 v100, s3, v100
  s_lshr_b32 s3, s5, 3
  s_lshl_b32 s15, s4, 2
  s_add_u32 s3, s3, s15
  s_lshl_b32 s3, s3, 7
  s_add_u32 s3, s3, 4096
  v_mov_b32 v101, s3
  v_cmp_gt_u32 vcc, 16, v135
  s_nop 1
  v_cndmask_b32 v193, v101, v100, vcc
  s_lshl_b32 s3, s8, 2
  s_add_u32 s3, s3, s6
  s_and_b32 s3, s3, 31
  s_nop 1
  v_readlane_b32 s3, v167, s3
  s_nop 3
  v_writelane_b32 v193, s3, 17
  buffer_load_dword v193, v193, s[16:19], 0 offen sc1
  v_lshlrev_b32 v124, 4, v136
  v_lshl_add_u32 v124, v137, 18, v124
  v_lshrrev_b32 v125, 3, v135
  v_lshlrev_b32 v125, 16, v125
  v_and_b32 v100, 7, v135
  v_lshl_add_u32 v125, v100, 4, v125
  s_lshl_b32 s3, s12, 17
  s_lshl_b32 s15, s10, 7
  s_add_u32 s3, s3, s15
  s_add_u32 s3, s3, s73
  v_add_u32 v125, s3, v125
  v_cmp_gt_u32 vcc, 16, v135
  v_mov_b32 v100, 2147483392
  v_add_u32 v124, s70, v124
  v_cndmask_b32 v125, v100, v125, vcc
  s_waitcnt vmcnt(6)
  s_barrier
  ds_read_b64_tr_b16 v[84:85], v83 offset:43008
  ds_read_b64_tr_b16 v[86:87], v83 offset:43552
  ds_read_b64_tr_b16 v[88:89], v83 offset:44064
  ds_read_b64_tr_b16 v[90:91], v83 offset:44608
  ds_read_b64_tr_b16 v[92:93], v83 offset:45120
  ds_read_b64_tr_b16 v[94:95], v83 offset:52000
  ds_read_b64_tr_b16 v[96:97], v83 offset:52512
  ds_read_b64_tr_b16 v[98:99], v83 offset:53056
  ds_read_b64_tr_b16 v[100:101], v83 offset:53568
  s_waitcnt vmcnt(5)
  v_alignbit_b32 v40, v80, v80, 16
  v_alignbit_b32 v41, v81, v81, 16
  v_and_b32 v42, 0xffff, v80
  v_and_b32 v43, 0xffff0000, v81
  v_and_b32 v44, 0xffff0000, v80
  v_and_b32 v45, 0xffff, v81
  v_or_b32 v44, v44, v45
  s_waitcnt lgkmcnt(7)
  v_dot2_f32_bf16 v16, v86, v42, 0
  v_dot2_f32_bf16 v17, v86, v40, 0
  v_dot2_f32_bf16 v18, v87, v42, 0
  v_dot2_f32_bf16 v19, v87, v40, 0
  s_waitcnt lgkmcnt(6)
  v_dot2_f32_bf16 v20, v88, v42, 0
  v_dot2_f32_bf16 v21, v88, v40, 0
  v_dot2_f32_bf16 v22, v89, v42, 0
  v_dot2_f32_bf16 v23, v89, v40, 0
  s_waitcnt lgkmcnt(5)
  v_dot2_f32_bf16 v24, v90, v42, 0
  v_dot2_f32_bf16 v25, v90, v40, 0
  v_dot2_f32_bf16 v26, v91, v42, 0
  v_dot2_f32_bf16 v27, v91, v40, 0
  s_waitcnt lgkmcnt(4)
  v_dot2_f32_bf16 v28, v92, v42, 0
  v_dot2_f32_bf16 v29, v92, v40, 0
  v_dot2_f32_bf16 v30, v93, v42, 0
  v_dot2_f32_bf16 v31, v93, v40, 0
  v_dot2_f32_bf16 v16, v85, v44, v16
  v_dot2_f32_bf16 v17, v85, v41, v17
  v_dot2_f32_bf16 v18, v86, v44, v18
  v_dot2_f32_bf16 v19, v86, v41, v19
  v_dot2_f32_bf16 v20, v87, v44, v20
  v_dot2_f32_bf16 v21, v87, v41, v21
  v_dot2_f32_bf16 v22, v88, v44, v22
  v_dot2_f32_bf16 v23, v88, v41, v23
  v_dot2_f32_bf16 v24, v89, v44, v24
  v_dot2_f32_bf16 v25, v89, v41, v25
  v_dot2_f32_bf16 v26, v90, v44, v26
  v_dot2_f32_bf16 v27, v90, v41, v27
  v_dot2_f32_bf16 v28, v91, v44, v28
  v_dot2_f32_bf16 v29, v91, v41, v29
  v_dot2_f32_bf16 v30, v92, v44, v30
  v_dot2_f32_bf16 v31, v92, v41, v31
  v_dot2_f32_bf16 v16, v84, v43, v16
  v_dot2_f32_bf16 v18, v85, v43, v18
  v_dot2_f32_bf16 v20, v86, v43, v20
  v_dot2_f32_bf16 v22, v87, v43, v22
  v_dot2_f32_bf16 v24, v88, v43, v24
  v_dot2_f32_bf16 v26, v89, v43, v26
  v_dot2_f32_bf16 v28, v90, v43, v28
  v_dot2_f32_bf16 v30, v91, v43, v30
  s_waitcnt lgkmcnt(3)
  v_lshlrev_b32 v102, 16, v94
  v_and_b32 v103, 0xffff0000, v94
  v_pk_mul_f32 v[16:17], v[16:17], v[102:103]
  v_lshlrev_b32 v102, 16, v95
  v_and_b32 v103, 0xffff0000, v95
  v_pk_mul_f32 v[18:19], v[18:19], v[102:103]
  s_waitcnt lgkmcnt(2)
  v_lshlrev_b32 v102, 16, v96
  v_and_b32 v103, 0xffff0000, v96
  v_pk_mul_f32 v[20:21], v[20:21], v[102:103]
  v_lshlrev_b32 v102, 16, v97
  v_and_b32 v103, 0xffff0000, v97
  v_pk_mul_f32 v[22:23], v[22:23], v[102:103]
  s_waitcnt lgkmcnt(1)
  v_lshlrev_b32 v102, 16, v98
  v_and_b32 v103, 0xffff0000, v98
  v_pk_mul_f32 v[24:25], v[24:25], v[102:103]
  v_lshlrev_b32 v102, 16, v99
  v_and_b32 v103, 0xffff0000, v99
  v_pk_mul_f32 v[26:27], v[26:27], v[102:103]
  s_waitcnt lgkmcnt(0)
  v_lshlrev_b32 v102, 16, v100
  v_and_b32 v103, 0xffff0000, v100
  v_pk_mul_f32 v[28:29], v[28:29], v[102:103]
  v_lshlrev_b32 v102, 16, v101
  v_and_b32 v103, 0xffff0000, v101
  v_pk_mul_f32 v[30:31], v[30:31], v[102:103]
  v_cvt_pk_bf16_f32 v84, v23, v22
  v_cvt_pk_bf16_f32 v85, v21, v20
  v_cvt_pk_bf16_f32 v86, v19, v18
  v_cvt_pk_bf16_f32 v87, v17, v16
  v_cvt_pk_bf16_f32 v88, v31, v30
  v_cvt_pk_bf16_f32 v89, v29, v28
  v_cvt_pk_bf16_f32 v90, v27, v26
  v_cvt_pk_bf16_f32 v91, v25, v24
  v_mov_b32 v102, v88
  v_mov_b32 v103, v89
  v_mov_b32 v104, v90
  v_mov_b32 v105, v91
  v_mov_b32_dpp v88, v84 row_ror:8 row_mask:0xf bank_mask:0x3
  v_mov_b32_dpp v89, v85 row_ror:8 row_mask:0xf bank_mask:0x3
  v_mov_b32_dpp v90, v86 row_ror:8 row_mask:0xf bank_mask:0x3
  v_mov_b32_dpp v91, v87 row_ror:8 row_mask:0xf bank_mask:0x3
  v_mov_b32_dpp v84, v102 row_ror:8 row_mask:0xf bank_mask:0xc
  v_mov_b32_dpp v85, v103 row_ror:8 row_mask:0xf bank_mask:0xc
  v_mov_b32_dpp v86, v104 row_ror:8 row_mask:0xf bank_mask:0xc
  v_mov_b32_dpp v87, v105 row_ror:8 row_mask:0xf bank_mask:0xc
  s_mov_b32 s3, 32768
  buffer_store_dwordx4 v[84:87], v55, s[16:19], 0 offen
  buffer_store_dwordx4 v[88:91], v55, s[16:19], s3 offen
  v_mov_b32 v112, -1
  v_mov_b32 v113, -1
  v_mov_b32 v114, -1
  v_mov_b32 v115, -1
  buffer_store_dwordx4 v[112:115], v138, s[16:19], 0 offen sc1
  buffer_store_dwordx4 v[112:115], v138, s[16:19], s0 offen sc1
  buffer_store_dwordx4 v[112:115], v124, s[16:19], 0 offen sc1
  buffer_store_dwordx4 v[112:115], v125, s[16:19], 0 offen sc1
  s_add_u32 s75, s4, 0
  s_and_b32 s75, s75, 7
  s_mul_i32 s75, s75, 176128
  s_add_u32 m0, s74, 65536
  s_nop 0
  buffer_load_dwordx4 v129, s[36:39], s75 offen offset:0 lds
  buffer_load_dwordx4 v130, s[36:39], s75 offen offset:1024 lds
  buffer_load_dwordx4 v131, s[36:39], s75 offen offset:2048 lds
  s_add_u32 m0, s74, 77824
  s_nop 0
  buffer_load_dwordx4 v129, s[40:43], s75 offen offset:0 lds
  buffer_load_dwordx4 v130, s[40:43], s75 offen offset:1024 lds
  buffer_load_dwordx4 v131, s[40:43], s75 offen offset:2048 lds
  s_mov_b32 s26, s14
  s_getreg_b32 s14, hwreg(HW_REG_XCC_ID, 0, 4)
  s_waitcnt vmcnt(16)
  v_readfirstlane_b32 s13, v51
  s_nop 0
  s_add_u32 s13, s13, 0x9E3779B0
  s_and_b32 s13, s13, 0xFFFFFFF0
  s_and_b32 s14, s14, 15
  s_or_b32 s14, s14, s13
  v_mov_b32 v14, s13
  v_mov_b32 v98, s14
  s_lshl_b32 s3, s6, 8
  s_add_u32 s3, s3, s2
  s_mul_i32 s15, s3, 1525
  s_lshr_b32 s15, s15, 16
  s_mul_i32 s60, s15, 43
  s_sub_u32 s60, s3, s60
  s_lshl_b32 s56, s60, 15
  s_lshl_b32 s61, s15, 7
  s_add_u32 s56, s56, s61
  s_mul_i32 s57, s15, 86
  s_add_u32 s57, s57, s60
  s_lshl_b32 s57, s57, 11
  s_add_u32 s57, s57, 12582912
  s_lshl_b32 s58, s3, 7
  s_add_u32 s58, s58, 589824
  s_cmp_lt_u32 s3, 344
  s_cselect_b32 s56, s56, 2147483392
  s_cselect_b32 s57, s57, 2147483392
  s_cselect_b32 s58, s58, 2147483392
  s_lshl_b32 s3, s10, 1
  s_add_u32 s3, s3, s12
  s_mul_i32 s3, s3, 43
  s_mul_i32 s15, s11, 21
  s_add_u32 s3, s3, s15
  s_lshl_b32 s3, s3, 11
  s_add_u32 s77, s3, 12582912
  s_cmp_eq_u32 s11, 0
  s_cselect_b32 s59, s77, 2147483392
  s_add_u32 s23, s1, s69
  s_lshl_b32 s52, s12, 12
  s_mul_i32 s53, s12, 3072
  s_lshl_b32 s54, s11, 14
  s_add_u32 s55, s54, s53
  s_add_u32 s54, s54, s52
  s_lshl_b32 s3, s4, 2
  s_add_u32 s15, s3, s6
  s_lshl_b32 s15, s15, 5
  s_add_u32 s15, s15, s5
  s_lshl_b32 s15, s15, 2
  s_add_u32 s15, s15, 4096
  s_lshr_b32 s20, s5, 3
  s_add_u32 s20, s20, s3
  s_lshl_b32 s20, s20, 7
  s_add_u32 s20, s20, 4096
  v_and_b32 v97, 31, v135
  v_lshlrev_b32 v97, 2, v97
  s_mov_b32 s34, 0
  s_waitcnt vmcnt(14)
  s_waitcnt lgkmcnt(0)
  s_barrier
  s_mul_i32 s3, s11, 4608
  s_add_u32 s3, s3, 33792
  v_add_u32 v54, s3, v52
  v_add_u32 v78, s3, v53
  ds_read_b128 v[56:59], v54 offset:0
  ds_read_b64 v[60:61], v54 offset:16
  ds_read_b128 v[64:67], v54 offset:1024
  ds_read_b64 v[68:69], v54 offset:1040
  ds_read_b128 v[72:75], v78 offset:0
  ds_read_b64 v[76:77], v78 offset:16
  s_mul_i32 s3, s11, 16640
  s_add_u32 s3, s3, 32
  v_add_u32 v52, s3, v52
  v_add_u32 v53, s3, v53
  s_waitcnt lgkmcnt(5)
  ds_write_b128 v52, v[56:59] offset:0
  v_alignbit_b32 v100, v57, v56, 16
  v_alignbit_b32 v101, v58, v57, 16
  v_alignbit_b32 v102, v59, v58, 16
  s_waitcnt lgkmcnt(5)
  v_alignbit_b32 v103, v60, v59, 16
  ds_write_b128 v52, v[100:103] offset:4160
  v_mov_b32 v104, v57
  v_mov_b32 v105, v58
  v_mov_b32 v106, v59
  v_mov_b32 v107, v60
  ds_write_b128 v52, v[104:107] offset:8320
  v_alignbit_b32 v108, v58, v57, 16
  v_alignbit_b32 v109, v59, v58, 16
  v_alignbit_b32 v110, v60, v59, 16
  v_alignbit_b32 v111, v61, v60, 16
  ds_write_b128 v52, v[108:111] offset:12480
  s_waitcnt lgkmcnt(7)
  ds_write_b128 v52, v[64:67] offset:1024
  v_alignbit_b32 v112, v65, v64, 16
  v_alignbit_b32 v113, v66, v65, 16
  v_alignbit_b32 v114, v67, v66, 16
  s_waitcnt lgkmcnt(7)
  v_alignbit_b32 v115, v68, v67, 16
  ds_write_b128 v52, v[112:115] offset:5184
  v_mov_b32 v116, v65
  v_mov_b32 v117, v66
  v_mov_b32 v118, v67
  v_mov_b32 v119, v68
  ds_write_b128 v52, v[116:119] offset:9344
  v_alignbit_b32 v120, v66, v65, 16
  v_alignbit_b32 v121, v67, v66, 16
  v_alignbit_b32 v122, v68, v67, 16
  v_alignbit_b32 v123, v69, v68, 16
  ds_write_b128 v52, v[120:123] offset:13504
  s_waitcnt lgkmcnt(8)
  s_barrier
  ds_write_b128 v53, v[72:75] offset:0
  v_alignbit_b32 v100, v73, v72, 16
  v_alignbit_b32 v101, v74, v73, 16
  v_alignbit_b32 v102, v75, v74, 16
  v_alignbit_b32 v103, v76, v75, 16
  ds_write_b128 v53, v[100:103] offset:4160
  v_mov_b32 v104, v73
  v_mov_b32 v105, v74
  v_mov_b32 v106, v75
  v_mov_b32 v107, v76
  ds_write_b128 v53, v[104:107] offset:8320
  v_alignbit_b32 v108, v74, v73, 16
  v_alignbit_b32 v109, v75, v74, 16
  v_alignbit_b32 v110, v76, v75, 16
  v_alignbit_b32 v111, v77, v76, 16
  ds_write_b128 v53, v[108:111] offset:12480
  s_waitcnt vmcnt(10)
  buffer_store_dword v98, v2, s[16:19], s15 offen
  s_add_u32 s75, s4, 1
  s_and_b32 s75, s75, 7
  s_mul_i32 s75, s75, 176128
  s_add_u32 m0, s74, 90112
  s_nop 0
  buffer_load_dwordx4 v129, s[36:39], s75 offen offset:0 lds
  buffer_load_dwordx4 v130, s[36:39], s75 offen offset:1024 lds
  buffer_load_dwordx4 v131, s[36:39], s75 offen offset:2048 lds
  s_add_u32 m0, s74, 102400
  s_nop 0
  buffer_load_dwordx4 v129, s[40:43], s75 offen offset:0 lds
  buffer_load_dwordx4 v130, s[40:43], s75 offen offset:1024 lds
  buffer_load_dwordx4 v131, s[40:43], s75 offen offset:2048 lds
  s_lshl_b32 s3, s26, 12
  s_lshl_b32 s15, s12, 11
  s_add_u32 s3, s3, s15
  s_add_u32 s3, s3, 2097152
  s_mul_i32 s27, s11, 4608
  s_add_u32 s15, s15, s27
  buffer_load_dword v99, v97, s[16:19], s20 offen sc1
  s_lshl_b32 s61, s12, 8
  s_sub_u32 s60, s27, s61
  s_add_u32 s60, s60, 33568
  v_lshlrev_b32 v141, 5, v136
  v_lshl_add_u32 v141, v137, 4, v141
  v_add_u32 v141, s60, v141
  v_add_u32 v142, 1, v136
  v_and_b32 v143, 3, v142
  v_mul_u32_u24 v143, 4160, v143
  v_lshrrev_b32 v142, 2, v142
  v_lshl_add_u32 v142, v142, 3, v143
  v_lshlrev_b32 v143, 4, v137
  v_sub_u32 v142, v142, v143
  s_mul_i32 s60, s11, 16640
  s_add_u32 s60, s60, s61
  s_add_u32 s60, s60, 48
  v_add_u32 v142, s60, v142
  s_add_u32 m0, s15, 33792
  s_waitcnt vmcnt(0)
  v_cmp_ne_u32 vcc, s14, v99
  s_cbranch_vccnz L_f1r
L_f1b:
  buffer_load_dwordx4 v1, s[16:19], s3 offen sc1 lds
  buffer_load_dwordx4 v1, s[16:19], s3 offen offset:1024 sc1 lds
  buffer_store_dword v98, v2, s[16:19], s76 offen sc1
  s_add_u32 s75, s4, 2
  s_and_b32 s75, s75, 7
  s_mul_i32 s75, s75, 176128
  s_add_u32 m0, s74, 114688
  s_nop 0
  buffer_load_dwordx4 v129, s[36:39], s75 offen offset:0 lds
  buffer_load_dwordx4 v130, s[36:39], s75 offen offset:1024 lds
  buffer_load_dwordx4 v131, s[36:39], s75 offen offset:2048 lds
  s_add_u32 m0, s74, 126976
  s_nop 0
  buffer_load_dwordx4 v129, s[40:43], s75 offen offset:0 lds
  buffer_load_dwordx4 v130, s[40:43], s75 offen offset:1024 lds
  buffer_load_dwordx4 v131, s[40:43], s75 offen offset:2048 lds
  v_lshlrev_b32 v139, 16, v139
  s_waitcnt vmcnt(7)
  s_waitcnt lgkmcnt(0)
  s_barrier
  ds_read_b64 v[72:73], v142 offset:0
  ds_read_b64 v[74:75], v142 offset:8
  ds_read_b128 v[28:31], v141 offset:1728
  ds_read_b128 v[24:27], v141 offset:1216
  ds_read_b128 v[20:23], v141 offset:704
  ds_read_b128 v[16:19], v141 offset:192
  s_waitcnt lgkmcnt(3)
  v_mfma_f32_16x16x32_bf16 v[52:55], v[72:75], v[28:31], 0
  ds_read_b64 v[76:77], v142 offset:512
  ds_read_b64 v[78:79], v142 offset:520
  s_waitcnt lgkmcnt(4)
  v_mfma_f32_16x16x32_bf16 v[48:51], v[72:75], v[24:27], 0
  ds_read_b64 v[80:81], v142 offset:1024
  ds_read_b64 v[82:83], v142 offset:1032
  s_waitcnt lgkmcnt(5)
  v_mfma_f32_16x16x32_bf16 v[44:47], v[72:75], v[20:23], 0
  ds_read_b64 v[84:85], v142 offset:1536
  ds_read_b64 v[86:87], v142 offset:1544
  s_waitcnt lgkmcnt(6)
  v_mfma_f32_16x16x32_bf16 v[40:43], v[72:75], v[16:19], 0
  ds_read_b64 v[88:89], v142 offset:64
  ds_read_b64 v[90:91], v142 offset:72
  s_waitcnt lgkmcnt(6)
  v_mfma_f32_16x16x32_bf16 v[52:55], v[76:79], v[24:27], v[52:55]
  ds_read_b128 v[108:111], v141 offset:1664
  ds_read_b128 v[104:107], v141 offset:1152
  v_mfma_f32_16x16x32_bf16 v[48:51], v[76:79], v[20:23], v[48:51]
  ds_read_b128 v[36:39], v141 offset:640
  ds_read_b128 v[32:35], v141 offset:128
  v_mfma_f32_16x16x32_bf16 v[44:47], v[76:79], v[16:19], v[44:47]
  ds_read_b64 v[92:93], v142 offset:576
  ds_read_b64 v[94:95], v142 offset:584
  s_waitcnt lgkmcnt(10)
  v_mfma_f32_16x16x32_bf16 v[52:55], v[80:83], v[20:23], v[52:55]
  buffer_load_dwordx4 v[196:199], v3, s[28:31], 0 offen
  ds_read_b64 v[96:97], v142 offset:1088
  v_mfma_f32_16x16x32_bf16 v[48:51], v[80:83], v[16:19], v[48:51]
  ds_read_b64 v[98:99], v142 offset:1096
  v_add_u32 v128, 65536, v132
  s_waitcnt lgkmcnt(10)
  v_mfma_f32_16x16x32_bf16 v[52:55], v[84:87], v[16:19], v[52:55]
  ds_read_b64 v[100:101], v142 offset:1600
  v_add_u32 v134, 65536, v133
  s_waitcnt lgkmcnt(8)
  v_mfma_f32_16x16x32_bf16 v[52:55], v[88:91], v[108:111], v[52:55]
  s_lshl_b32 s61, s6, 12
  buffer_load_dwordx4 v[200:203], v3, s[28:31], s0 offen
  ds_read_b64 v[102:103], v142 offset:1608
  s_waitcnt lgkmcnt(8)
  v_mfma_f32_16x16x32_bf16 v[48:51], v[88:91], v[104:107], v[48:51]
  s_add_u32 m0, s61, 139264
  ds_read_b64 v[72:73], v142 offset:128
  ds_read_b64 v[74:75], v142 offset:136
  s_waitcnt lgkmcnt(9)
  v_mfma_f32_16x16x32_bf16 v[44:47], v[88:91], v[36:39], v[44:47]
  s_add_u32 s75, s56, 0
  ds_read_b128 v[28:31], v141 offset:1600
  ds_read_b128 v[24:27], v141 offset:1088
  s_waitcnt lgkmcnt(10)
  v_mfma_f32_16x16x32_bf16 v[40:43], v[88:91], v[32:35], v[40:43]
  buffer_load_dwordx4 v126, s[44:47], s75 offen lds
  s_add_u32 m0, s61, 140288
  ds_read_b128 v[20:23], v141 offset:576
  s_waitcnt lgkmcnt(9)
  v_mfma_f32_16x16x32_bf16 v[52:55], v[92:95], v[104:107], v[52:55]
  s_add_u32 s75, s56, 8192
  ds_read_b64_tr_b16 a[0:1], v128 offset:0
  ds_read_b128 v[16:19], v141 offset:64
  v_mfma_f32_16x16x32_bf16 v[48:51], v[92:95], v[36:39], v[48:51]
  ds_read_b64 v[76:77], v142 offset:640
  ds_read_b64 v[78:79], v142 offset:648
  v_mfma_f32_16x16x32_bf16 v[44:47], v[92:95], v[32:35], v[44:47]
  buffer_load_dwordx4 v126, s[44:47], s75 offen lds
  s_add_u32 m0, s61, 141312
  ds_read_b64 v[80:81], v142 offset:1152
  s_waitcnt lgkmcnt(11)
  v_mfma_f32_16x16x32_bf16 v[52:55], v[96:99], v[36:39], v[52:55]
  s_add_u32 s75, s56, 16384
  ds_read_b64_tr_b16 a[4:5], v128 offset:12288
  ds_read_b64 v[82:83], v142 offset:1160
  v_mfma_f32_16x16x32_bf16 v[48:51], v[96:99], v[32:35], v[48:51]
  ds_read_b64_tr_b16 a[8:9], v134 offset:0
  ds_read_b64 v[84:85], v142 offset:1664
  s_waitcnt lgkmcnt(12)
  v_mfma_f32_16x16x32_bf16 v[52:55], v[100:103], v[32:35], v[52:55]
  buffer_load_dwordx4 v126, s[44:47], s75 offen lds
  s_add_u32 m0, s61, 142336
  ds_read_b64 v[86:87], v142 offset:1672
  s_waitcnt lgkmcnt(11)
  v_mfma_f32_16x16x32_bf16 v[52:55], v[72:75], v[28:31], v[52:55]
  s_add_u32 s75, s56, 24576
  ds_read_b64_tr_b16 a[2:3], v128 offset:768
  ds_read_b64 v[88:89], v142 offset:192
  v_mfma_f32_16x16x32_bf16 v[48:51], v[72:75], v[24:27], v[48:51]
  ds_read_b64 v[90:91], v142 offset:200
  ds_read_b128 v[108:111], v141 offset:1536
  s_waitcnt lgkmcnt(12)
  v_mfma_f32_16x16x32_bf16 v[44:47], v[72:75], v[20:23], v[44:47]
  buffer_load_dwordx4 v126, s[44:47], s75 offen lds
  ds_read_b128 v[104:107], v141 offset:1024
  v_mfma_f32_16x16x32_bf16 v[40:43], v[72:75], v[16:19], v[40:43]
  ds_read_b64_tr_b16 a[6:7], v128 offset:13056
  ds_read_b128 v[36:39], v141 offset:512
  s_waitcnt lgkmcnt(12)
  v_mfma_f32_16x16x32_bf16 v[52:55], v[76:79], v[24:27], v[52:55]
  ds_read_b64_tr_b16 a[10:11], v134 offset:768
  ds_read_b128 v[32:35], v141 offset:0
  v_mfma_f32_16x16x32_bf16 v[48:51], v[76:79], v[20:23], v[48:51]
  ds_read_b64 v[92:93], v142 offset:704
  ds_read_b64 v[94:95], v142 offset:712
  v_mfma_f32_16x16x32_bf16 v[44:47], v[76:79], v[16:19], v[44:47]
  ds_read_b64_tr_b16 a[12:13], v128 offset:6144
  ds_read_b64 v[96:97], v142 offset:1216
  s_waitcnt lgkmcnt(13)
  v_mfma_f32_16x16x32_bf16 v[52:55], v[80:83], v[20:23], v[52:55]
  ds_read_b64_tr_b16 a[16:17], v128 offset:18432
  ds_read_b64 v[98:99], v142 offset:1224
  v_mfma_f32_16x16x32_bf16 v[48:51], v[80:83], v[16:19], v[48:51]
  ds_read_b64_tr_b16 a[20:21], v134 offset:6144
  ds_read_b64 v[100:101], v142 offset:1728
  v_mfma_f32_16x16x32_bf16 v[52:55], v[84:87], v[16:19], v[52:55]
  ds_read_b64_tr_b16 a[14:15], v128 offset:6912
  ds_read_b64 v[102:103], v142 offset:1736
  s_waitcnt lgkmcnt(14)
  v_mfma_f32_16x16x32_bf16 v[52:55], v[88:91], v[108:111], v[52:55]
  ds_read_b64_tr_b16 a[18:19], v128 offset:19200
  ds_read_b64 v[76:77], v142 offset:512
  v_mfma_f32_16x16x32_bf16 v[48:51], v[88:91], v[104:107], v[48:51]
  ds_read_b64 v[78:79], v142 offset:520
  ds_read_b128 v[28:31], v141 offset:1728
  s_waitcnt lgkmcnt(14)
  v_mfma_f32_16x16x32_bf16 v[44:47], v[88:91], v[36:39], v[44:47]
  ds_read_b64 v[80:81], v142 offset:1024
  ds_read_b64 v[82:83], v142 offset:1032
  v_mfma_f32_16x16x32_bf16 v[40:43], v[88:91], v[32:35], v[40:43]
  ds_read_b64_tr_b16 a[22:23], v134 offset:6912
  ds_read_b128 v[24:27], v141 offset:1216
  s_waitcnt lgkmcnt(14)
  v_mfma_f32_16x16x32_bf16 v[52:55], v[92:95], v[104:107], v[52:55]
  ds_read_b64 v[84:85], v142 offset:1536
  ds_read_b64 v[86:87], v142 offset:1544
  v_mfma_f32_16x16x32_bf16 v[48:51], v[92:95], v[36:39], v[48:51]
  ds_read_b128 v[20:23], v141 offset:704
  v_add_u32 v128, 90112, v132
  v_mfma_f32_16x16x32_bf16 v[44:47], v[92:95], v[32:35], v[44:47]
  ds_read_b64 v[72:73], v142 offset:0
  v_add_u32 v134, 90112, v133
  s_waitcnt lgkmcnt(12)
  v_mfma_f32_16x16x32_bf16 v[52:55], v[96:99], v[36:39], v[52:55]
  ds_read_b64 v[74:75], v142 offset:8
  ds_read_b128 v[108:111], v141 offset:3776
  v_mfma_f32_16x16x32_bf16 v[48:51], v[96:99], v[32:35], v[48:51]
  ds_read_b64_tr_b16 a[24:25], v128 offset:0
  ds_read_b128 v[104:107], v141 offset:3264
  v_mfma_f32_16x16x32_bf16 v[52:55], v[100:103], v[32:35], v[52:55]
  buffer_load_dwordx4 v[112:115], v15, s[16:19], 0 offen sc1
  ds_read_b128 v[36:39], v141 offset:2752
  s_waitcnt lgkmcnt(11)
  v_mfma_f32_16x16x32_bf16 v[56:59], v[76:79], v[28:31], 0
  ds_read_b64_tr_b16 a[28:29], v128 offset:12288
  ds_read_b128 v[32:35], v141 offset:2240
  v_mfma_f32_16x16x32_bf16 v[60:63], v[80:83], v[28:31], 0
  ds_write_b128 v160, v[40:43] offset:0
  ds_write_b128 v160, v[44:47] offset:1024
  ds_write_b128 v160, v[48:51] offset:2048
  ds_read_b64 v[88:89], v142 offset:2048
  s_waitcnt lgkmcnt(13)
  v_mfma_f32_16x16x32_bf16 v[56:59], v[80:83], v[24:27], v[56:59]
  ds_write_b128 v160, v[52:55] offset:3072
  ds_read_b64 v[168:169], v163 offset:0
  ds_read_b64 v[170:171], v163 offset:512
  ds_read_b64 v[90:91], v142 offset:2056
  v_mfma_f32_16x16x32_bf16 v[64:67], v[84:87], v[28:31], 0
  ds_read_b64_tr_b16 a[32:33], v134 offset:0
  ds_read_b64_tr_b16 a[26:27], v128 offset:768
  ds_read_b64_tr_b16 a[30:31], v128 offset:13056
  ds_read_b128 v[16:19], v141 offset:192
  v_mfma_f32_16x16x32_bf16 v[60:63], v[84:87], v[24:27], v[60:63]
  ds_read_b64_tr_b16 a[34:35], v134 offset:768
  ds_read_b64_tr_b16 a[36:37], v128 offset:6144
  ds_read_b64_tr_b16 a[40:41], v128 offset:18432
  ds_read_b64 v[92:93], v142 offset:2560
  s_waitcnt lgkmcnt(15)
  v_mfma_f32_16x16x32_bf16 v[56:59], v[84:87], v[20:23], v[56:59]
  s_waitcnt lgkmcnt(11)
  s_barrier
  ds_read_b128 v[40:43], v161 offset:0
  ds_read_b128 v[48:51], v162 offset:0
  ds_read_b64 v[94:95], v142 offset:2568
  v_mfma_f32_16x16x32_bf16 v[68:71], v[72:75], v[108:111], 0
  s_add_u32 s75, s4, 3
  ds_read_b128 v[44:47], v161 offset:1024
  ds_read_b128 v[52:55], v162 offset:1024
  ds_read_b64 v[96:97], v142 offset:3072
  s_waitcnt lgkmcnt(15)
  v_and_b32 v172, 0xffff0000, v169
  v_mfma_f32_16x16x32_bf16 v[64:67], v[72:75], v[104:107], v[64:67]
  s_and_b32 s75, s75, 7
  ds_read_b64 v[98:99], v142 offset:3080
  v_lshlrev_b32 v173, 16, v169
  v_and_b32 v174, 0xffff0000, v168
  v_lshlrev_b32 v175, 16, v168
  v_mfma_f32_16x16x32_bf16 v[60:63], v[72:75], v[36:39], v[60:63]
  s_mul_i32 s75, s75, 176128
  ds_read_b64 v[100:101], v142 offset:3584
  s_waitcnt lgkmcnt(7)
  v_fmac_f32 v40, v139, v172
  v_fmac_f32 v41, v139, v173
  v_fmac_f32 v42, v139, v174
  v_mfma_f32_16x16x32_bf16 v[56:59], v[72:75], v[32:35], v[56:59]
  s_add_u32 m0, s74, 65536
  ds_read_b64 v[102:103], v142 offset:3592
  v_fmac_f32 v43, v139, v175
  s_waitcnt lgkmcnt(7)
  v_add_f32 v40, v40, v48
  v_add_f32 v41, v41, v49
  v_mfma_f32_16x16x32_bf16 v[68:71], v[76:79], v[104:107], v[68:71]
  ds_read_b64 v[72:73], v142 offset:64
  v_add_f32 v42, v42, v50
  v_add_f32 v43, v43, v51
  v_cvt_pk_bf16_f32 v176, v40, v41
  v_mfma_f32_16x16x32_bf16 v[64:67], v[76:79], v[36:39], v[64:67]
  ds_read_b64 v[74:75], v142 offset:72
  v_cvt_pk_bf16_f32 v177, v42, v43
  v_and_b32 v172, 0xffff0000, v171
  v_lshlrev_b32 v173, 16, v171
  v_mfma_f32_16x16x32_bf16 v[60:63], v[76:79], v[32:35], v[60:63]
  ds_read_b128 v[108:111], v141 offset:3712
  v_and_b32 v174, 0xffff0000, v170
  v_lshlrev_b32 v175, 16, v170
  s_waitcnt lgkmcnt(8)
  v_fmac_f32 v44, v139, v172
  v_mfma_f32_16x16x32_bf16 v[68:71], v[80:83], v[36:39], v[68:71]
  ds_read_b128 v[104:107], v141 offset:3200
  v_fmac_f32 v45, v139, v173
  v_fmac_f32 v46, v139, v174
  v_fmac_f32 v47, v139, v175
  v_mfma_f32_16x16x32_bf16 v[64:67], v[80:83], v[32:35], v[64:67]
  ds_read_b128 v[36:39], v141 offset:2688
  s_waitcnt lgkmcnt(7)
  v_add_f32 v44, v44, v52
  v_add_f32 v45, v45, v53
  v_add_f32 v46, v46, v54
  v_mfma_f32_16x16x32_bf16 v[68:71], v[84:87], v[32:35], v[68:71]
  v_add_f32 v47, v47, v55
  v_cvt_pk_bf16_f32 v178, v44, v45
  v_cvt_pk_bf16_f32 v179, v46, v47
  s_nop 0
  ds_read_b128 v[32:35], v141 offset:2176
  v_mfma_f32_16x16x32_bf16 v[68:71], v[88:91], v[28:31], v[68:71]
  buffer_load_dwordx4 v129, s[36:39], s75 offen offset:0 lds
  ds_read_b64 v[76:77], v142 offset:576
  v_permlane16_swap_b32 v176, v178
  v_mfma_f32_16x16x32_bf16 v[64:67], v[88:91], v[24:27], v[64:67]
  v_permlane16_swap_b32 v177, v179
  buffer_store_dwordx4 v[176:179], v138, s[16:19], 0 offen sc1
  ds_read_b64 v[78:79], v142 offset:584
  v_mfma_f32_16x16x32_bf16 v[60:63], v[88:91], v[20:23], v[60:63]
  ds_read_b64_tr_b16 a[44:45], v134 offset:6144
  ds_read_b128 v[28:31], v141 offset:1664
  v_mfma_f32_16x16x32_bf16 v[56:59], v[88:91], v[16:19], v[56:59]
  buffer_load_dwordx4 v130, s[36:39], s75 offen offset:1024 lds
  ds_read_b64 v[80:81], v142 offset:1088
  v_mfma_f32_16x16x32_bf16 v[68:71], v[92:95], v[24:27], v[68:71]
  ds_read_b64_tr_b16 a[38:39], v128 offset:6912
  ds_read_b64 v[82:83], v142 offset:1096
  v_mfma_f32_16x16x32_bf16 v[64:67], v[92:95], v[20:23], v[64:67]
  ds_read_b64_tr_b16 a[42:43], v128 offset:19200
  ds_read_b128 v[24:27], v141 offset:1152
  v_mfma_f32_16x16x32_bf16 v[60:63], v[92:95], v[16:19], v[60:63]
  buffer_load_dwordx4 v131, s[36:39], s75 offen offset:2048 lds
  s_add_u32 m0, s74, 77824
  ds_read_b64 v[84:85], v142 offset:1600
  v_mfma_f32_16x16x32_bf16 v[68:71], v[96:99], v[20:23], v[68:71]
  ds_read_b64_tr_b16 a[46:47], v134 offset:6912
  s_waitcnt lgkmcnt(0)
  s_waitcnt vmcnt(11)
  s_barrier
  ds_read_b64 v[86:87], v142 offset:1608
  v_mfma_f32_16x16x32_bf16 v[64:67], v[96:99], v[16:19], v[64:67]
  ds_read_b128 v[20:23], v141 offset:640
  v_add_u32 v128, 114688, v132
  v_mfma_f32_16x16x32_bf16 v[68:71], v[100:103], v[16:19], v[68:71]
  buffer_load_dwordx4 v129, s[40:43], s75 offen offset:0 lds
  ds_read_b64 v[88:89], v142 offset:2112
  v_mfma_f32_16x16x32_bf16 v[68:71], v[72:75], v[108:111], v[68:71]
  ds_read_b64 v[90:91], v142 offset:2120
  v_add_u32 v134, 114688, v133
  v_mfma_f32_16x16x32_bf16 v[64:67], v[72:75], v[104:107], v[64:67]
  ds_read_b64_tr_b16 a[48:49], v128 offset:0
  ds_read_b128 v[16:19], v141 offset:128
  v_mfma_f32_16x16x32_bf16 v[60:63], v[72:75], v[36:39], v[60:63]
  buffer_load_dwordx4 v130, s[40:43], s75 offen offset:1024 lds
  ds_read_b64 v[92:93], v142 offset:2624
  v_mfma_f32_16x16x32_bf16 v[56:59], v[72:75], v[32:35], v[56:59]
  ds_read_b64_tr_b16 a[52:53], v128 offset:12288
  ds_read_b64 v[94:95], v142 offset:2632
  v_mfma_f32_16x16x32_bf16 v[68:71], v[76:79], v[104:107], v[68:71]
  ds_read_b64_tr_b16 a[56:57], v134 offset:0
  ds_read_b64 v[96:97], v142 offset:3136
  v_mfma_f32_16x16x32_bf16 v[64:67], v[76:79], v[36:39], v[64:67]
  buffer_load_dwordx4 v131, s[40:43], s75 offen offset:2048 lds
  s_add_u32 s75, s4, 4
  ds_read_b64 v[98:99], v142 offset:3144
  v_mfma_f32_16x16x32_bf16 v[60:63], v[76:79], v[32:35], v[60:63]
  s_and_b32 s75, s75, 7
  s_mul_i32 s75, s75, 176128
  s_add_u32 m0, s74, 90112
  ds_read_b64 v[100:101], v142 offset:3648
  v_mfma_f32_16x16x32_bf16 v[56:59], v[76:79], v[28:31], v[56:59]
  ds_read_b64_tr_b16 a[50:51], v128 offset:768
  ds_read_b64 v[102:103], v142 offset:3656
  v_mfma_f32_16x16x32_bf16 v[68:71], v[80:83], v[36:39], v[68:71]
  buffer_load_dwordx4 v129, s[36:39], s75 offen offset:0 lds
  ds_read_b64 v[72:73], v142 offset:128
  v_mfma_f32_16x16x32_bf16 v[64:67], v[80:83], v[32:35], v[64:67]
  ds_read_b64_tr_b16 a[54:55], v128 offset:13056
  ds_read_b64 v[74:75], v142 offset:136
  v_mfma_f32_16x16x32_bf16 v[60:63], v[80:83], v[28:31], v[60:63]
  ds_read_b64_tr_b16 a[58:59], v134 offset:768
  ds_read_b128 v[108:111], v141 offset:3648
  v_mfma_f32_16x16x32_bf16 v[56:59], v[80:83], v[24:27], v[56:59]
  buffer_load_dwordx4 v130, s[36:39], s75 offen offset:1024 lds
  ds_read_b128 v[104:107], v141 offset:3136
  s_waitcnt lgkmcnt(10)
  v_mfma_f32_16x16x32_bf16 v[68:71], v[84:87], v[32:35], v[68:71]
  ds_read_b64_tr_b16 a[60:61], v128 offset:6144
  ds_read_b128 v[36:39], v141 offset:2624
  v_mfma_f32_16x16x32_bf16 v[64:67], v[84:87], v[28:31], v[64:67]
  s_waitcnt vmcnt(9)
  ds_read_b128 v[32:35], v141 offset:2112
  v_xor_b32 v113, s13, v113
  v_mfma_f32_16x16x32_bf16 v[60:63], v[84:87], v[24:27], v[60:63]
  ds_read_b64 v[76:77], v142 offset:640
  v_xor_b32 v114, s13, v114
  v_mfma_f32_16x16x32_bf16 v[56:59], v[84:87], v[20:23], v[56:59]
  ds_read_b64 v[78:79], v142 offset:648
  v_xor_b32 v115, s13, v115
  v_mfma_f32_16x16x32_bf16 v[68:71], v[88:91], v[28:31], v[68:71]
  ds_read_b128 v[28:31], v141 offset:1600
  v_or3_b32 v113, v113, v114, v115
  v_mfma_f32_16x16x32_bf16 v[64:67], v[88:91], v[24:27], v[64:67]
  ds_read_b64 v[80:81], v142 offset:1152
  v_xor_b32 v114, s13, v112
  v_mfma_f32_16x16x32_bf16 v[60:63], v[88:91], v[20:23], v[60:63]
  ds_read_b64 v[82:83], v142 offset:1160
  v_or_b32 v113, v113, v114
  v_mfma_f32_16x16x32_bf16 v[56:59], v[88:91], v[16:19], v[56:59]
  v_cmp_lt_u32 vcc, 15, v113
  s_cbranch_vccnz LF_h2r_1
LF_h2b_3:
  ds_read_b64 v[84:85], v142 offset:1664
  v_mfma_f32_16x16x32_bf16 v[68:71], v[92:95], v[24:27], v[68:71]
  s_barrier
  ds_read_b128 v[24:27], v141 offset:1088
  v_mfma_f32_16x16x32_bf16 v[64:67], v[92:95], v[20:23], v[64:67]
  buffer_load_dwordx4 v131, s[36:39], s75 offen offset:2048 lds
  s_add_u32 m0, s74, 102400
  ds_read_b64 v[86:87], v142 offset:1672
  v_mfma_f32_16x16x32_bf16 v[60:63], v[92:95], v[16:19], v[60:63]
  ds_read_b64_tr_b16 a[64:65], v128 offset:18432
  ds_read_b64 v[88:89], v142 offset:2176
  s_waitcnt lgkmcnt(8)
  v_mfma_f32_16x16x32_bf16 v[68:71], v[96:99], v[20:23], v[68:71]
  ds_read_b64_tr_b16 a[68:69], v134 offset:6144
  ds_read_b128 v[20:23], v141 offset:576
  v_mfma_f32_16x16x32_bf16 v[64:67], v[96:99], v[16:19], v[64:67]
  buffer_load_dwordx4 v129, s[40:43], s75 offen offset:0 lds
  ds_read_b64 v[90:91], v142 offset:2184
  v_mfma_f32_16x16x32_bf16 v[68:71], v[100:103], v[16:19], v[68:71]
  ds_read_b64_tr_b16 a[62:63], v128 offset:6912
  ds_read_b128 v[16:19], v141 offset:64
  v_mfma_f32_16x16x32_bf16 v[68:71], v[72:75], v[108:111], v[68:71]
  ds_read_b64_tr_b16 a[66:67], v128 offset:19200
  ds_read_b64 v[92:93], v142 offset:2688
  v_mfma_f32_16x16x32_bf16 v[64:67], v[72:75], v[104:107], v[64:67]
  buffer_load_dwordx4 v130, s[40:43], s75 offen offset:1024 lds
  ds_read_b64 v[94:95], v142 offset:2696
  v_mfma_f32_16x16x32_bf16 v[60:63], v[72:75], v[36:39], v[60:63]
  ds_read_b64_tr_b16 a[70:71], v134 offset:6912
  s_waitcnt lgkmcnt(0)
  s_barrier
  ds_read_b64 v[96:97], v142 offset:3200
  v_mfma_f32_16x16x32_bf16 v[56:59], v[72:75], v[32:35], v[56:59]
  ds_read_b64 v[98:99], v142 offset:3208
  v_mfma_f32_16x16x32_bf16 v[68:71], v[76:79], v[104:107], v[68:71]
  buffer_load_dwordx4 v131, s[40:43], s75 offen offset:2048 lds
  s_add_u32 s75, s4, 5
  ds_read_b64 v[100:101], v142 offset:3712
  v_mfma_f32_16x16x32_bf16 v[64:67], v[76:79], v[36:39], v[64:67]
  s_and_b32 s75, s75, 7
  s_mul_i32 s75, s75, 176128
  s_add_u32 m0, s74, 114688
  ds_read_b64 v[102:103], v142 offset:3720
  v_mfma_f32_16x16x32_bf16 v[60:63], v[76:79], v[32:35], v[60:63]
  ds_read_b64 v[72:73], v142 offset:192
  v_mfma_f32_16x16x32_bf16 v[56:59], v[76:79], v[28:31], v[56:59]
  buffer_load_dwordx4 v129, s[36:39], s75 offen offset:0 lds
  ds_read_b64 v[74:75], v142 offset:200
  v_mfma_f32_16x16x32_bf16 v[68:71], v[80:83], v[36:39], v[68:71]
  ds_read_b128 v[108:111], v141 offset:3584
  v_mfma_f32_16x16x32_bf16 v[64:67], v[80:83], v[32:35], v[64:67]
  ds_read_b128 v[104:107], v141 offset:3072
  v_mfma_f32_16x16x32_bf16 v[60:63], v[80:83], v[28:31], v[60:63]
  buffer_load_dwordx4 v130, s[36:39], s75 offen offset:1024 lds
  ds_read_b128 v[36:39], v141 offset:2560
  v_mfma_f32_16x16x32_bf16 v[56:59], v[80:83], v[24:27], v[56:59]
  ds_read_b64 v[76:77], v142 offset:704
  v_mfma_f32_16x16x32_bf16 v[68:71], v[84:87], v[32:35], v[68:71]
  ds_read_b128 v[32:35], v141 offset:2048
  v_mfma_f32_16x16x32_bf16 v[64:67], v[84:87], v[28:31], v[64:67]
  buffer_load_dwordx4 v131, s[36:39], s75 offen offset:2048 lds
  s_add_u32 m0, s74, 126976
  ds_read_b64 v[78:79], v142 offset:712
  v_mfma_f32_16x16x32_bf16 v[60:63], v[84:87], v[24:27], v[60:63]
  ds_read_b64 v[80:81], v142 offset:1216
  v_mfma_f32_16x16x32_bf16 v[56:59], v[84:87], v[20:23], v[56:59]
  ds_read_b64 v[82:83], v142 offset:1224
  v_mfma_f32_16x16x32_bf16 v[68:71], v[88:91], v[28:31], v[68:71]
  buffer_load_dwordx4 v129, s[40:43], s75 offen offset:0 lds
  ds_read_b128 v[28:31], v141 offset:1536
  v_mfma_f32_16x16x32_bf16 v[64:67], v[88:91], v[24:27], v[64:67]
  ds_read_b64 v[84:85], v142 offset:1728
  v_mfma_f32_16x16x32_bf16 v[60:63], v[88:91], v[20:23], v[60:63]
  ds_read_b64 v[86:87], v142 offset:1736
  v_mfma_f32_16x16x32_bf16 v[56:59], v[88:91], v[16:19], v[56:59]
  s_waitcnt vmcnt(15)
  buffer_load_dwordx4 v[184:187], v164, s[16:19], 0 offen sc1
  ds_read_b64 v[88:89], v142 offset:2240
  v_mfma_f32_16x16x32_bf16 v[68:71], v[92:95], v[24:27], v[68:71]
  buffer_load_dwordx4 v130, s[40:43], s75 offen offset:1024 lds
  ds_read_b128 v[24:27], v141 offset:1024
  v_mfma_f32_16x16x32_bf16 v[64:67], v[92:95], v[20:23], v[64:67]
  ds_read_b64 v[90:91], v142 offset:2248
  v_mfma_f32_16x16x32_bf16 v[60:63], v[92:95], v[16:19], v[60:63]
  ds_read_b64 v[92:93], v142 offset:2752
  s_waitcnt lgkmcnt(7)
  v_mfma_f32_16x16x32_bf16 v[68:71], v[96:99], v[20:23], v[68:71]
  buffer_load_dwordx4 v131, s[40:43], s75 offen offset:2048 lds
  ds_read_b128 v[20:23], v141 offset:512
  v_mfma_f32_16x16x32_bf16 v[64:67], v[96:99], v[16:19], v[64:67]
  buffer_load_dword v124, v124, s[16:19], 0 offen sc1
  ds_read_b64 v[94:95], v142 offset:2760
  v_mfma_f32_16x16x32_bf16 v[68:71], v[100:103], v[16:19], v[68:71]
  ds_read_b128 v[16:19], v141 offset:0
  v_mfma_f32_16x16x32_bf16 v[68:71], v[72:75], v[108:111], v[68:71]
  buffer_load_dword v125, v125, s[16:19], 0 offen sc1
  ds_read_b64 v[96:97], v142 offset:3264
  v_mfma_f32_16x16x32_bf16 v[64:67], v[72:75], v[104:107], v[64:67]
  ds_read_b64 v[98:99], v142 offset:3272
  v_mfma_f32_16x16x32_bf16 v[60:63], v[72:75], v[36:39], v[60:63]
  ds_read_b64 v[100:101], v142 offset:3776
  v_mfma_f32_16x16x32_bf16 v[56:59], v[72:75], v[32:35], v[56:59]
  ds_read_b64 v[102:103], v142 offset:3784
  v_mfma_f32_16x16x32_bf16 v[68:71], v[76:79], v[104:107], v[68:71]
  v_mfma_f32_16x16x32_bf16 v[64:67], v[76:79], v[36:39], v[64:67]
  v_mfma_f32_16x16x32_bf16 v[60:63], v[76:79], v[32:35], v[60:63]
  s_waitcnt lgkmcnt(4)
  v_mfma_f32_16x16x32_bf16 v[56:59], v[76:79], v[28:31], v[56:59]
  v_mfma_f32_16x16x32_bf16 v[68:71], v[80:83], v[36:39], v[68:71]
  v_mfma_f32_16x16x32_bf16 v[64:67], v[80:83], v[32:35], v[64:67]
  v_mfma_f32_16x16x32_bf16 v[60:63], v[80:83], v[28:31], v[60:63]
  v_mfma_f32_16x16x32_bf16 v[56:59], v[80:83], v[24:27], v[56:59]
  v_mfma_f32_16x16x32_bf16 v[68:71], v[84:87], v[32:35], v[68:71]
  v_mfma_f32_16x16x32_bf16 v[64:67], v[84:87], v[28:31], v[64:67]
  v_mfma_f32_16x16x32_bf16 v[60:63], v[84:87], v[24:27], v[60:63]
  v_mfma_f32_16x16x32_bf16 v[56:59], v[84:87], v[20:23], v[56:59]
  v_mfma_f32_16x16x32_bf16 v[68:71], v[88:91], v[28:31], v[68:71]
  v_mfma_f32_16x16x32_bf16 v[64:67], v[88:91], v[24:27], v[64:67]
  v_mfma_f32_16x16x32_bf16 v[60:63], v[88:91], v[20:23], v[60:63]
  v_mfma_f32_16x16x32_bf16 v[56:59], v[88:91], v[16:19], v[56:59]
  v_mfma_f32_16x16x32_bf16 v[68:71], v[92:95], v[24:27], v[68:71]
  v_mfma_f32_16x16x32_bf16 v[64:67], v[92:95], v[20:23], v[64:67]
  v_mfma_f32_16x16x32_bf16 v[60:63], v[92:95], v[16:19], v[60:63]
  s_waitcnt lgkmcnt(0)
  v_mfma_f32_16x16x32_bf16 v[68:71], v[96:99], v[20:23], v[68:71]
  v_mfma_f32_16x16x32_bf16 v[64:67], v[96:99], v[16:19], v[64:67]
  v_mfma_f32_16x16x32_bf16 v[68:71], v[100:103], v[16:19], v[68:71]
  s_waitcnt vmcnt(9)
  ds_write_b128 v160, v[56:59] offset:0
  s_nop 1
  ds_write_b128 v160, v[60:63] offset:1024
  s_nop 1
  ds_write_b128 v160, v[64:67] offset:2048
  ds_write_b128 v160, v[68:71] offset:3072
  ds_read_b64 v[168:169], v163 offset:2048
  ds_read_b64 v[170:171], v163 offset:2560
  s_waitcnt lgkmcnt(0)
  s_barrier
  ds_read_b128 v[56:59], v161 offset:0
  ds_read_b128 v[64:67], v162 offset:0
  ds_read_b128 v[60:63], v161 offset:1024
  ds_read_b128 v[68:71], v162 offset:1024
  v_and_b32 v172, 0xffff0000, v169
  v_lshlrev_b32 v173, 16, v169
  v_and_b32 v174, 0xffff0000, v168
  v_lshlrev_b32 v175, 16, v168
  s_waitcnt lgkmcnt(3)
  v_fmac_f32 v56, v139, v172
  v_fmac_f32 v57, v139, v173
  v_fmac_f32 v58, v139, v174
  v_fmac_f32 v59, v139, v175
  s_waitcnt lgkmcnt(2)
  v_pk_add_f32 v[56:57], v[56:57], v[64:65]
  v_pk_add_f32 v[58:59], v[58:59], v[66:67]
  v_cvt_pk_bf16_f32 v180, v56, v57
  v_cvt_pk_bf16_f32 v181, v58, v59
  v_and_b32 v172, 0xffff0000, v171
  v_lshlrev_b32 v173, 16, v171
  v_and_b32 v174, 0xffff0000, v170
  v_lshlrev_b32 v175, 16, v170
  s_waitcnt lgkmcnt(1)
  v_fmac_f32 v60, v139, v172
  v_fmac_f32 v61, v139, v173
  v_fmac_f32 v62, v139, v174
  v_fmac_f32 v63, v139, v175
  s_waitcnt lgkmcnt(0)
  v_pk_add_f32 v[60:61], v[60:61], v[68:69]
  v_pk_add_f32 v[62:63], v[62:63], v[70:71]
  v_cvt_pk_bf16_f32 v182, v60, v61
  v_cvt_pk_bf16_f32 v183, v62, v63
  s_nop 0
  v_permlane16_swap_b32 v180, v182
  v_permlane16_swap_b32 v181, v183
  buffer_store_dwordx4 v[180:183], v138, s[16:19], s0 offen sc1
  v_mov_b32 v192, 0x3f803f80
  v_lshlrev_b32 v16, 16, v196
  v_and_b32 v17, 0xffff0000, v196
  v_lshlrev_b32 v18, 16, v197
  v_and_b32 v19, 0xffff0000, v197
  v_lshlrev_b32 v20, 16, v198
  v_and_b32 v21, 0xffff0000, v198
  v_lshlrev_b32 v22, 16, v199
  v_and_b32 v23, 0xffff0000, v199
  v_dot2_f32_bf16 v104, v196, v192, 0
  v_dot2_f32_bf16 v105, v196, v196, 0
  v_dot2_f32_bf16 v104, v197, v192, v104
  v_dot2_f32_bf16 v105, v197, v197, v105
  v_dot2_f32_bf16 v104, v198, v192, v104
  v_dot2_f32_bf16 v105, v198, v198, v105
  v_dot2_f32_bf16 v104, v199, v192, v104
  v_dot2_f32_bf16 v105, v199, v199, v105
  s_waitcnt vmcnt(5)
  v_max3_u32 v192, v184, v185, v186
  v_max_u32 v192, v192, v187
  v_cmp_eq_u32 vcc, -1, v192
  s_cbranch_vccnz LF_ytr_4
LF_ytb_6:
  ds_write_b128 v165, v[184:187] offset:0
  s_waitcnt vmcnt(3)
  s_waitcnt lgkmcnt(0)
  s_barrier
  ds_read_b64_tr_b16 v[32:33], v166 offset:0
  ds_read_b64_tr_b16 v[34:35], v166 offset:256
  s_cmp_lg_u32 s34, 0
  s_cbranch_scc1 L_slow
  s_waitcnt lgkmcnt(1)
  v_lshlrev_b32 v40, 16, v32
  v_and_b32 v41, 0xffff0000, v32
  v_lshlrev_b32 v42, 16, v33
  v_and_b32 v43, 0xffff0000, v33
  s_waitcnt lgkmcnt(0)
  v_lshlrev_b32 v44, 16, v34
  v_and_b32 v45, 0xffff0000, v34
  v_lshlrev_b32 v46, 16, v35
  v_and_b32 v47, 0xffff0000, v35
  v_mul_f32 v50, v16, v40
  v_add_f32 v51, v40, v41
  v_fmac_f32 v50, v17, v41
  v_fmac_f32 v50, v18, v42
  v_add_f32 v51, v51, v42
  v_fmac_f32 v50, v19, v43
  v_add_f32 v51, v51, v43
  v_fmac_f32 v50, v20, v44
  v_add_f32 v51, v51, v44
  v_fmac_f32 v50, v21, v45
  v_add_f32 v51, v51, v45
  v_fmac_f32 v50, v22, v46
  v_add_f32 v51, v51, v46
  v_fmac_f32 v50, v23, v47
  v_add_f32 v51, v51, v47
  s_nop 0
  v_permlane32_swap_b32 v104, v50
  v_permlane32_swap_b32 v105, v51
  v_add_f32 v104, v104, v50
  v_add_f32 v105, v105, v51
  s_add_u32 s3, s70, 0
  s_nop 0
  v_permlane16_swap_b32 v104, v105
  v_add_f32 v104, v104, v105
  buffer_store_dword v104, v4, s[16:19], s3 offen
  s_mul_i32 s3, s10, 43
  s_mul_i32 s15, s11, 21
  s_add_u32 s3, s3, s15
  s_lshl_b32 s3, s3, 7
  s_add_u32 s24, s3, 589824
  s_waitcnt vmcnt(2)
  v_min_u32 v125, 21, v135
  v_lshlrev_b32 v125, 7, v125
  s_add_u32 s75, s4, 6
  s_and_b32 s75, s75, 7
  s_mul_i32 s75, s75, 176128
  s_add_u32 m0, s74, 8192
  s_nop 0
  buffer_load_dwordx4 v129, s[36:39], s75 offen offset:0 lds
  buffer_load_dwordx4 v130, s[36:39], s75 offen offset:1024 lds
  buffer_load_dwordx4 v131, s[36:39], s75 offen offset:2048 lds
  s_add_u32 m0, s74, 20480
  s_nop 0
  buffer_load_dwordx4 v129, s[40:43], s75 offen offset:0 lds
  buffer_load_dwordx4 v130, s[40:43], s75 offen offset:1024 lds
  buffer_load_dwordx4 v131, s[40:43], s75 offen offset:2048 lds
  v_add_u32 v128, 65536, v132
  v_add_u32 v134, 65536, v133
  ds_read_b64_tr_b16 a[72:73], v128 offset:0
  ds_read_b64_tr_b16 a[76:77], v128 offset:12288
  ds_read_b64_tr_b16 a[80:81], v134 offset:0
  ds_read_b64_tr_b16 a[74:75], v128 offset:768
  ds_read_b64_tr_b16 a[78:79], v128 offset:13056
  ds_read_b64_tr_b16 a[82:83], v134 offset:768
  ds_read_b64_tr_b16 a[84:85], v128 offset:6144
  ds_read_b64_tr_b16 a[88:89], v128 offset:18432
  ds_read_b64_tr_b16 a[92:93], v134 offset:6144
  ds_read_b64_tr_b16 a[86:87], v128 offset:6912
  ds_read_b64_tr_b16 a[90:91], v128 offset:19200
  ds_read_b64_tr_b16 a[94:95], v134 offset:6912
  v_add_u32 v128, 90112, v132
  v_add_u32 v134, 90112, v133
  ds_read_b64_tr_b16 a[96:97], v128 offset:0
  ds_read_b64_tr_b16 a[100:101], v128 offset:12288
  ds_read_b64_tr_b16 a[104:105], v134 offset:0
  ds_read_b64_tr_b16 a[98:99], v128 offset:768
  ds_read_b64_tr_b16 a[102:103], v128 offset:13056
  ds_read_b64_tr_b16 a[106:107], v134 offset:768
  ds_read_b64_tr_b16 a[108:109], v128 offset:6144
  ds_read_b64_tr_b16 a[112:113], v128 offset:18432
  ds_read_b64_tr_b16 a[116:117], v134 offset:6144
  ds_read_b64_tr_b16 a[110:111], v128 offset:6912
  ds_read_b64_tr_b16 a[114:115], v128 offset:19200
  ds_read_b64_tr_b16 a[118:119], v134 offset:6912
  v_add_u32 v128, 114688, v132
  v_add_u32 v134, 114688, v133
  ds_read_b64_tr_b16 a[120:121], v128 offset:0
  ds_read_b64_tr_b16 a[124:125], v128 offset:12288
  ds_read_b64_tr_b16 a[128:129], v134 offset:0
  ds_read_b64_tr_b16 a[122:123], v128 offset:768
  ds_read_b64_tr_b16 a[126:127], v128 offset:13056
  ds_read_b64_tr_b16 a[130:131], v134 offset:768
  ds_read_b64_tr_b16 a[132:133], v128 offset:6144
  ds_read_b64_tr_b16 a[136:137], v128 offset:18432
  ds_read_b64_tr_b16 a[140:141], v134 offset:6144
  ds_read_b64_tr_b16 a[134:135], v128 offset:6912
  ds_read_b64_tr_b16 a[138:139], v128 offset:19200
  ds_read_b64_tr_b16 a[142:143], v134 offset:6912
  ds_read_b64_tr_b16 v[144:145], v127 offset:0
  ds_read_b64_tr_b16 v[146:147], v127 offset:512
  ds_read_b64_tr_b16 v[148:149], v127 offset:8
  ds_read_b64_tr_b16 v[150:151], v127 offset:520
  ds_read_b64_tr_b16 v[152:153], v127 offset:64
  ds_read_b64_tr_b16 v[154:155], v127 offset:576
  ds_read_b64_tr_b16 v[156:157], v127 offset:72
  ds_read_b64_tr_b16 v[158:159], v127 offset:584
  s_add_u32 s60, s57, 0
  s_waitcnt lgkmcnt(6)
  buffer_store_dwordx4 v[144:147], v1, s[16:19], s60 offen offset:0 sc1
  s_waitcnt lgkmcnt(4)
  buffer_store_dwordx4 v[148:151], v1, s[16:19], s60 offen offset:1024 sc1
  s_add_u32 s60, s57, 88064
  s_waitcnt lgkmcnt(2)
  buffer_store_dwordx4 v[152:155], v1, s[16:19], s60 offen offset:0 sc1
  s_waitcnt lgkmcnt(0)
  buffer_store_dwordx4 v[156:159], v1, s[16:19], s60 offen offset:1024 sc1
  v_mov_b32 v192, 0x3f803f80
  v_lshlrev_b32 v24, 16, v200
  v_and_b32 v25, 0xffff0000, v200
  v_lshlrev_b32 v26, 16, v201
  v_and_b32 v27, 0xffff0000, v201
  v_lshlrev_b32 v28, 16, v202
  v_and_b32 v29, 0xffff0000, v202
  v_lshlrev_b32 v30, 16, v203
  v_and_b32 v31, 0xffff0000, v203
  v_dot2_f32_bf16 v106, v200, v192, 0
  v_dot2_f32_bf16 v107, v200, v200, 0
  v_dot2_f32_bf16 v106, v201, v192, v106
  v_dot2_f32_bf16 v107, v201, v201, v107
  v_dot2_f32_bf16 v106, v202, v192, v106
  v_dot2_f32_bf16 v107, v202, v202, v107
  v_dot2_f32_bf16 v106, v203, v192, v106
  v_dot2_f32_bf16 v107, v203, v203, v107
  s_waitcnt vmcnt(11)
  s_add_u32 s21, s72, 0
  buffer_load_dwordx4 v[40:43], v5, s[16:19], s21 offen offset:0 sc1
  buffer_load_dwordx4 v[44:47], v5, s[16:19], s21 offen offset:256 sc1
  buffer_load_dwordx4 v[48:51], v5, s[16:19], s21 offen offset:512 sc1
  buffer_load_dwordx4 v[52:55], v5, s[16:19], s21 offen offset:768 sc1
  v_lshlrev_b32 v56, 16, v32
  v_and_b32 v57, 0xffff0000, v32
  v_lshlrev_b32 v58, 16, v33
  v_and_b32 v59, 0xffff0000, v33
  v_lshlrev_b32 v60, 16, v34
  v_and_b32 v61, 0xffff0000, v34
  v_lshlrev_b32 v62, 16, v35
  v_and_b32 v63, 0xffff0000, v35
  buffer_load_dwordx4 v[188:191], v164, s[16:19], s0 offen sc1
  s_waitcnt lgkmcnt(0)
  s_barrier
  s_add_u32 s75, s4, 7
  s_and_b32 s75, s75, 7
  s_mul_i32 s75, s75, 176128
  s_add_u32 m0, s74, 65536
  s_nop 0
  buffer_load_dwordx4 v129, s[36:39], s75 offen offset:0 lds
  buffer_load_dwordx4 v130, s[36:39], s75 offen offset:1024 lds
  buffer_load_dwordx4 v131, s[36:39], s75 offen offset:2048 lds
  s_add_u32 m0, s74, 77824
  s_nop 0
  buffer_load_dwordx4 v129, s[40:43], s75 offen offset:0 lds
  buffer_load_dwordx4 v130, s[40:43], s75 offen offset:1024 lds
  buffer_load_dwordx4 v131, s[40:43], s75 offen offset:2048 lds
  s_waitcnt vmcnt(7)
  v_max3_u32 v122, v40, v41, v42
  v_max3_u32 v122, v122, v43, v44
  v_max3_u32 v122, v122, v45, v46
  v_max3_u32 v122, v122, v47, v48
  v_max3_u32 v122, v122, v49, v50
  v_max3_u32 v122, v122, v51, v52
  v_max3_u32 v122, v122, v53, v54
  v_max_u32 v122, v122, v55
  v_cmp_eq_u32 vcc, -1, v122
  s_cbranch_vccnz LF_grr_7
LF_grb_9:
  v_pk_add_f32 v[40:41], v[40:41], v[44:45]
  v_pk_add_f32 v[48:49], v[48:49], v[52:53]
  v_pk_add_f32 v[42:43], v[42:43], v[46:47]
  v_pk_add_f32 v[50:51], v[50:51], v[54:55]
  v_pk_add_f32 v[40:41], v[40:41], v[48:49]
  v_pk_add_f32 v[42:43], v[42:43], v[50:51]
  s_nop 1
  v_permlane32_swap_b32 v40, v42
  v_permlane32_swap_b32 v41, v43
  v_add_f32 v40, v40, v42
  v_add_f32 v41, v41, v43
  s_nop 1
  v_permlane16_swap_b32 v40, v41
  v_add_f32 v40, v40, v41
  v_mov_b32 v41, v40
  s_nop 1
  v_permlane16_swap_b32 v40, v41
  v_mov_b32 v42, v40
  v_mov_b32 v43, v41
  s_nop 0
  v_permlane32_swap_b32 v40, v42
  v_permlane32_swap_b32 v41, v43
  v_mul_f32 v40, 0x3b000000, v40
  v_mul_f32 v41, 0x3b000000, v41
  v_fma_f32 v41, -v40, v40, v41
  v_max_f32 v41, 0, v41
  v_add_f32 v41, 0x3727c5ac, v41
  v_rsq_f32 v41, v41
  v_fma_f32 v42, -v40, v43, v42
  v_mul_f32 v42, 0x3b000000, v42
  v_fma_f32 v42, v41, v42, v40
  v_mul_f32 v40, v40, v41
  v_pk_fma_f32 v[44:45], v[16:17], v[40:41], v[40:41] op_sel:[0,1,0] op_sel_hi:[1,1,0] neg_lo:[0,0,1] neg_hi:[0,0,1]
  v_pk_fma_f32 v[46:47], v[18:19], v[40:41], v[40:41] op_sel:[0,1,0] op_sel_hi:[1,1,0] neg_lo:[0,0,1] neg_hi:[0,0,1]
  v_pk_fma_f32 v[48:49], v[20:21], v[40:41], v[40:41] op_sel:[0,1,0] op_sel_hi:[1,1,0] neg_lo:[0,0,1] neg_hi:[0,0,1]
  v_pk_fma_f32 v[50:51], v[22:23], v[40:41], v[40:41] op_sel:[0,1,0] op_sel_hi:[1,1,0] neg_lo:[0,0,1] neg_hi:[0,0,1]
  v_pk_fma_f32 v[16:17], v[44:45], v[56:57], v[16:17]
  v_pk_fma_f32 v[18:19], v[46:47], v[58:59], v[18:19]
  v_pk_fma_f32 v[20:21], v[48:49], v[60:61], v[20:21]
  v_pk_fma_f32 v[22:23], v[50:51], v[62:63], v[22:23]
  v_pk_add_f32 v[56:57], v[16:17], v[42:43] op_sel_hi:[1,0] neg_lo:[0,1] neg_hi:[0,1]
  v_pk_add_f32 v[58:59], v[18:19], v[42:43] op_sel_hi:[1,0] neg_lo:[0,1] neg_hi:[0,1]
  v_pk_add_f32 v[60:61], v[20:21], v[42:43] op_sel_hi:[1,0] neg_lo:[0,1] neg_hi:[0,1]
  v_pk_add_f32 v[62:63], v[22:23], v[42:43] op_sel_hi:[1,0] neg_lo:[0,1] neg_hi:[0,1]
  s_add_u32 s3, s68, 0
  v_cvt_pk_bf16_f32 v44, v56, v57
  v_cvt_pk_bf16_f32 v45, v58, v59
  v_cvt_pk_bf16_f32 v46, v60, v61
  v_cvt_pk_bf16_f32 v47, v62, v63
  buffer_store_dwordx4 v[44:47], v1, s[16:19], s3 offen nt
  v_mul_f32 v40, v56, v56
  v_fmac_f32 v40, v57, v57
  v_fmac_f32 v40, v58, v58
  v_fmac_f32 v40, v59, v59
  v_fmac_f32 v40, v60, v60
  v_fmac_f32 v40, v61, v61
  v_fmac_f32 v40, v62, v62
  v_fmac_f32 v40, v63, v63
  v_mov_b32 v41, v40
  s_nop 0
  s_add_u32 s15, s71, 0
  v_permlane32_swap_b32 v40, v41
  v_add_f32 v40, v40, v41
  v_mov_b32 v41, v40
  s_nop 1
  v_permlane16_swap_b32 v40, v41
  v_add_f32 v40, v40, v41
  buffer_store_dword v40, v6, s[16:19], s15 offen
  s_waitcnt vmcnt(8)
  v_max3_u32 v192, v188, v189, v190
  v_max_u32 v192, v192, v191
  v_cmp_eq_u32 vcc, -1, v192
  s_cbranch_vccnz LF_ytr_13
LF_ytb_15:
  ds_write_b128 v165, v[188:191] offset:4096
  s_waitcnt lgkmcnt(0)
  s_barrier
  ds_read_b64_tr_b16 v[36:37], v166 offset:4096
  ds_read_b64_tr_b16 v[38:39], v166 offset:4352
  s_add_u32 s22, s23, 524288
  s_waitcnt vmcnt(1)
  buffer_store_dword v14, v2, s[16:19], s22 offen
  buffer_store_dword v14, v2, s[16:19], s58 offen sc1
  v_add_u32 v128, 8192, v132
  v_add_u32 v134, 8192, v133
  ds_read_b64_tr_b16 a[144:145], v128 offset:0
  ds_read_b64_tr_b16 a[148:149], v128 offset:12288
  ds_read_b64_tr_b16 a[152:153], v134 offset:0
  ds_read_b64_tr_b16 a[146:147], v128 offset:768
  ds_read_b64_tr_b16 a[150:151], v128 offset:13056
  ds_read_b64_tr_b16 a[154:155], v134 offset:768
  ds_read_b64_tr_b16 a[156:157], v128 offset:6144
  ds_read_b64_tr_b16 a[160:161], v128 offset:18432
  ds_read_b64_tr_b16 a[164:165], v134 offset:6144
  ds_read_b64_tr_b16 a[158:159], v128 offset:6912
  ds_read_b64_tr_b16 a[162:163], v128 offset:19200
  ds_read_b64_tr_b16 a[166:167], v134 offset:6912
  s_waitcnt lgkmcnt(13)
  v_lshlrev_b32 v64, 16, v36
  v_and_b32 v65, 0xffff0000, v36
  v_lshlrev_b32 v66, 16, v37
  v_and_b32 v67, 0xffff0000, v37
  s_waitcnt lgkmcnt(12)
  v_lshlrev_b32 v68, 16, v38
  v_and_b32 v69, 0xffff0000, v38
  v_lshlrev_b32 v70, 16, v39
  v_and_b32 v71, 0xffff0000, v39
  v_mul_f32 v74, v24, v64
  v_add_f32 v75, v64, v65
  v_fmac_f32 v74, v25, v65
  v_fmac_f32 v74, v26, v66
  v_add_f32 v75, v75, v66
  v_fmac_f32 v74, v27, v67
  v_add_f32 v75, v75, v67
  v_fmac_f32 v74, v28, v68
  v_add_f32 v75, v75, v68
  v_fmac_f32 v74, v29, v69
  v_add_f32 v75, v75, v69
  v_fmac_f32 v74, v30, v70
  v_add_f32 v75, v75, v70
  v_fmac_f32 v74, v31, v71
  v_add_f32 v75, v75, v71
  s_nop 0
  v_permlane32_swap_b32 v106, v74
  v_permlane32_swap_b32 v107, v75
  v_add_f32 v106, v106, v74
  v_add_f32 v107, v107, v75
  s_add_u32 s3, s70, 262144
  s_nop 0
  v_permlane16_swap_b32 v106, v107
  v_add_f32 v106, v106, v107
  buffer_store_dword v106, v4, s[16:19], s3 offen
  s_lshl_b32 s20, s69, 1
  s_add_u32 s20, s20, 524288
  buffer_load_dword v123, v12, s[16:19], s20 offen sc1
  s_waitcnt vmcnt(0)
  v_cmp_ne_u32 vcc, s13, v123
  s_cbranch_vccnz LF_xfr_19
LF_xfb_21:
  s_waitcnt lgkmcnt(0)
  s_barrier
  s_add_u32 s21, s72, 262144
  buffer_load_dwordx4 v[232:235], v5, s[16:19], s21 offen offset:0 sc1
  buffer_load_dwordx4 v[236:239], v5, s[16:19], s21 offen offset:256 sc1
  buffer_load_dwordx4 v[240:243], v5, s[16:19], s21 offen offset:512 sc1
  buffer_load_dwordx4 v[244:247], v5, s[16:19], s21 offen offset:768 sc1
  v_lshlrev_b32 v248, 16, v36
  v_and_b32 v249, 0xffff0000, v36
  v_lshlrev_b32 v250, 16, v37
  v_and_b32 v251, 0xffff0000, v37
  v_lshlrev_b32 v252, 16, v38
  v_and_b32 v253, 0xffff0000, v38
  v_lshlrev_b32 v254, 16, v39
  v_and_b32 v255, 0xffff0000, v39
  s_add_u32 m0, s64, 0
  s_mov_b32 s63, 0
  buffer_load_dwordx4 v8, s[16:19], s63 offen offset:0 sc1 lds
  buffer_load_dwordx4 v8, s[16:19], s63 offen offset:1024 sc1 lds
  buffer_load_dwordx4 v8, s[16:19], s63 offen offset:2048 sc1 lds
  buffer_load_dwordx4 v8, s[16:19], s63 offen offset:3072 sc1 lds
  s_add_u32 m0, s64, 8192
  s_mov_b32 s63, 8192
  buffer_load_dwordx4 v8, s[16:19], s63 offen offset:0 sc1 lds
  buffer_load_dwordx4 v8, s[16:19], s63 offen offset:1024 sc1 lds
  buffer_load_dwordx4 v8, s[16:19], s63 offen offset:2048 sc1 lds
  buffer_load_dwordx4 v8, s[16:19], s63 offen offset:3072 sc1 lds
  s_mul_i32 s3, s7, -327680
  s_add_u32 s3, s3, -2097152
  v_and_b32 v136, 1, v137
  v_mul_u32_u24 v136, 999424, v136
  s_mul_i32 s15, s9, 999424
  v_add_u32 v136, s3, v136
  s_add_u32 s3, s3, s15
  v_add_u32 v138, v11, v136
  v_add_u32 v136, v10, v136
  v_add_u32 v135, s3, v9
  s_waitcnt vmcnt(8)
  v_max3_u32 v122, v232, v233, v234
  v_max3_u32 v122, v122, v235, v236
  v_max3_u32 v122, v122, v237, v238
  v_max3_u32 v122, v122, v239, v240
  v_max3_u32 v122, v122, v241, v242
  v_max3_u32 v122, v122, v243, v244
  v_max3_u32 v122, v122, v245, v246
  v_max_u32 v122, v122, v247
  v_cmp_eq_u32 vcc, -1, v122
  s_cbranch_vccnz LF_grr_10
LF_grb_12:
  v_pk_add_f32 v[232:233], v[232:233], v[236:237]
  v_pk_add_f32 v[240:241], v[240:241], v[244:245]
  v_pk_add_f32 v[234:235], v[234:235], v[238:239]
  v_pk_add_f32 v[242:243], v[242:243], v[246:247]
  v_pk_add_f32 v[232:233], v[232:233], v[240:241]
  v_pk_add_f32 v[234:235], v[234:235], v[242:243]
  s_nop 1
  v_permlane32_swap_b32 v232, v234
  v_permlane32_swap_b32 v233, v235
  v_add_f32 v232, v232, v234
  v_add_f32 v233, v233, v235
  s_nop 1
  v_permlane16_swap_b32 v232, v233
  v_add_f32 v232, v232, v233
  v_mov_b32 v233, v232
  s_nop 1
  v_permlane16_swap_b32 v232, v233
  v_mov_b32 v234, v232
  v_mov_b32 v235, v233
  s_nop 0
  v_permlane32_swap_b32 v232, v234
  v_permlane32_swap_b32 v233, v235
  v_mul_f32 v232, 0x3b000000, v232
  v_mul_f32 v233, 0x3b000000, v233
  v_fma_f32 v233, -v232, v232, v233
  v_max_f32 v233, 0, v233
  v_add_f32 v233, 0x3727c5ac, v233
  v_rsq_f32 v233, v233
  v_fma_f32 v234, -v232, v235, v234
  v_mul_f32 v234, 0x3b000000, v234
  v_fma_f32 v234, v233, v234, v232
  v_mul_f32 v232, v232, v233
  v_pk_fma_f32 v[236:237], v[24:25], v[232:233], v[232:233] op_sel:[0,1,0] op_sel_hi:[1,1,0] neg_lo:[0,0,1] neg_hi:[0,0,1]
  v_pk_fma_f32 v[238:239], v[26:27], v[232:233], v[232:233] op_sel:[0,1,0] op_sel_hi:[1,1,0] neg_lo:[0,0,1] neg_hi:[0,0,1]
  v_pk_fma_f32 v[240:241], v[28:29], v[232:233], v[232:233] op_sel:[0,1,0] op_sel_hi:[1,1,0] neg_lo:[0,0,1] neg_hi:[0,0,1]
  v_pk_fma_f32 v[242:243], v[30:31], v[232:233], v[232:233] op_sel:[0,1,0] op_sel_hi:[1,1,0] neg_lo:[0,0,1] neg_hi:[0,0,1]
  v_pk_fma_f32 v[24:25], v[236:237], v[248:249], v[24:25]
  v_pk_fma_f32 v[26:27], v[238:239], v[250:251], v[26:27]
  v_pk_fma_f32 v[28:29], v[240:241], v[252:253], v[28:29]
  v_pk_fma_f32 v[30:31], v[242:243], v[254:255], v[30:31]
  v_pk_add_f32 v[248:249], v[24:25], v[234:235] op_sel_hi:[1,0] neg_lo:[0,1] neg_hi:[0,1]
  v_pk_add_f32 v[250:251], v[26:27], v[234:235] op_sel_hi:[1,0] neg_lo:[0,1] neg_hi:[0,1]
  v_pk_add_f32 v[252:253], v[28:29], v[234:235] op_sel_hi:[1,0] neg_lo:[0,1] neg_hi:[0,1]
  v_pk_add_f32 v[254:255], v[30:31], v[234:235] op_sel_hi:[1,0] neg_lo:[0,1] neg_hi:[0,1]
  s_add_u32 s3, s68, 65536
  v_cvt_pk_bf16_f32 v236, v248, v249
  v_cvt_pk_bf16_f32 v237, v250, v251
  v_cvt_pk_bf16_f32 v238, v252, v253
  v_cvt_pk_bf16_f32 v239, v254, v255
  buffer_store_dwordx4 v[236:239], v1, s[16:19], s3 offen nt
  v_add_u32 v112, 0, v1
  s_waitcnt vmcnt(5)
  s_barrier
  ds_read_b128 v[88:91], v112 offset:0
  ds_read_b128 v[92:95], v112 offset:16384
  ds_read_b128 v[96:99], v112 offset:1024
  ds_read_b128 v[100:103], v112 offset:17408
  s_waitcnt lgkmcnt(2)
  v_mfma_f32_16x16x32_bf16 v[40:43], a[0:3], v[88:91], 0
  s_add_u32 m0, s64, 32768
  s_mov_b32 s63, 32768
  ds_read_b128 v[104:107], v112 offset:2048
  v_mfma_f32_16x16x32_bf16 v[44:47], a[4:7], v[88:91], 0
  s_add_u32 s22, s23, 524544
  buffer_load_dwordx4 v8, s[16:19], s63 offen offset:0 sc1 lds
  ds_read_b128 v[108:111], v112 offset:18432
  v_mfma_f32_16x16x32_bf16 v[48:51], a[8:11], v[88:91], 0
  buffer_load_dword v124, v125, s[16:19], s24 offen sc1
  v_add_u32 v128, 65536, v132
  v_mfma_f32_16x16x32_bf16 v[52:55], a[0:3], v[92:95], 0
  ds_read_b64_tr_b16 a[168:169], v128 offset:0
  v_add_u32 v134, 65536, v133
  v_mfma_f32_16x16x32_bf16 v[56:59], a[4:7], v[92:95], 0
  ds_read_b64_tr_b16 a[172:173], v128 offset:12288
  ds_read_b64_tr_b16 a[176:177], v134 offset:0
  v_mfma_f32_16x16x32_bf16 v[60:63], a[8:11], v[92:95], 0
  s_waitcnt lgkmcnt(5)
  ds_read_b64_tr_b16 a[170:171], v128 offset:768
  ds_read_b64_tr_b16 a[174:175], v128 offset:13056
  v_mfma_f32_16x16x32_bf16 v[40:43], a[12:15], v[96:99], v[40:43]
  buffer_load_dwordx4 v8, s[16:19], s63 offen offset:1024 sc1 lds
  ds_read_b128 v[88:91], v112 offset:3072
  v_mfma_f32_16x16x32_bf16 v[44:47], a[16:19], v[96:99], v[44:47]
  ds_read_b64_tr_b16 a[178:179], v134 offset:768
  ds_read_b128 v[92:95], v112 offset:19456
  v_mfma_f32_16x16x32_bf16 v[48:51], a[20:23], v[96:99], v[48:51]
  ds_read_b64_tr_b16 a[180:181], v128 offset:6144
  ds_read_b64_tr_b16 a[184:185], v128 offset:18432
  v_mfma_f32_16x16x32_bf16 v[52:55], a[12:15], v[100:103], v[52:55]
  ds_read_b64_tr_b16 a[188:189], v134 offset:6144
  ds_read_b64_tr_b16 a[182:183], v128 offset:6912
  v_mfma_f32_16x16x32_bf16 v[56:59], a[16:19], v[100:103], v[56:59]
  ds_read_b64_tr_b16 a[186:187], v128 offset:19200
  ds_read_b64_tr_b16 a[190:191], v134 offset:6912
  v_mfma_f32_16x16x32_bf16 v[60:63], a[20:23], v[100:103], v[60:63]
  s_waitcnt lgkmcnt(14)
  buffer_load_dwordx4 v8, s[16:19], s63 offen offset:2048 sc1 lds
  v_mul_f32 v232, v248, v248
  v_mfma_f32_16x16x32_bf16 v[40:43], a[24:27], v[104:107], v[40:43]
  ds_read_b128 v[96:99], v112 offset:4096
  v_fmac_f32 v232, v249, v249
  v_mfma_f32_16x16x32_bf16 v[44:47], a[28:31], v[104:107], v[44:47]
  ds_read_b128 v[100:103], v112 offset:20480
  v_fmac_f32 v232, v250, v250
  v_mfma_f32_16x16x32_bf16 v[48:51], a[32:35], v[104:107], v[48:51]
  s_waitcnt lgkmcnt(2)
  s_barrier
  v_fmac_f32 v232, v251, v251
  v_mfma_f32_16x16x32_bf16 v[52:55], a[24:27], v[108:111], v[52:55]
  buffer_load_dwordx4 v8, s[16:19], s63 offen offset:3072 sc1 lds
  s_add_u32 m0, s64, 40960
  s_mov_b32 s63, 40960
  v_mfma_f32_16x16x32_bf16 v[56:59], a[28:31], v[108:111], v[56:59]
  v_fmac_f32 v232, v252, v252
  v_fmac_f32 v232, v253, v253
  v_mfma_f32_16x16x32_bf16 v[60:63], a[32:35], v[108:111], v[60:63]
  v_fmac_f32 v232, v254, v254
  v_fmac_f32 v232, v255, v255
  v_mfma_f32_16x16x32_bf16 v[40:43], a[36:39], v[88:91], v[40:43]
  buffer_load_dwordx4 v8, s[16:19], s63 offen offset:0 sc1 lds
  ds_read_b128 v[104:107], v112 offset:5120
  v_mfma_f32_16x16x32_bf16 v[44:47], a[40:43], v[88:91], v[44:47]
  v_mov_b32 v233, v232
  s_nop 0
  ds_read_b128 v[108:111], v112 offset:21504
  v_mfma_f32_16x16x32_bf16 v[48:51], a[44:47], v[88:91], v[48:51]
  s_add_u32 s15, s71, 65536
  v_permlane32_swap_b32 v232, v233
  v_mfma_f32_16x16x32_bf16 v[52:55], a[36:39], v[92:95], v[52:55]
  v_add_f32 v232, v232, v233
  v_mov_b32 v233, v232
  v_mfma_f32_16x16x32_bf16 v[56:59], a[40:43], v[92:95], v[56:59]
  s_nop 0
  v_permlane16_swap_b32 v232, v233
  v_mfma_f32_16x16x32_bf16 v[60:63], a[44:47], v[92:95], v[60:63]
  s_waitcnt lgkmcnt(2)
  buffer_load_dwordx4 v8, s[16:19], s63 offen offset:1024 sc1 lds
  v_add_f32 v232, v232, v233
  v_mfma_f32_16x16x32_bf16 v[40:43], a[48:51], v[96:99], v[40:43]
  buffer_store_dword v232, v6, s[16:19], s15 offen
  ds_read_b128 v[88:91], v112 offset:6144
  v_mfma_f32_16x16x32_bf16 v[44:47], a[52:55], v[96:99], v[44:47]
  ds_read_b128 v[92:95], v112 offset:22528
  v_mfma_f32_16x16x32_bf16 v[48:51], a[56:59], v[96:99], v[48:51]
  v_mfma_f32_16x16x32_bf16 v[52:55], a[48:51], v[100:103], v[52:55]
  v_mfma_f32_16x16x32_bf16 v[56:59], a[52:55], v[100:103], v[56:59]
  buffer_load_dwordx4 v8, s[16:19], s63 offen offset:2048 sc1 lds
  v_mfma_f32_16x16x32_bf16 v[60:63], a[56:59], v[100:103], v[60:63]
  s_waitcnt lgkmcnt(2)
  v_mfma_f32_16x16x32_bf16 v[40:43], a[60:63], v[104:107], v[40:43]
  ds_read_b128 v[96:99], v112 offset:7168
  v_mfma_f32_16x16x32_bf16 v[44:47], a[64:67], v[104:107], v[44:47]
  ds_read_b128 v[100:103], v112 offset:23552
  v_mfma_f32_16x16x32_bf16 v[48:51], a[68:71], v[104:107], v[48:51]
  v_mfma_f32_16x16x32_bf16 v[52:55], a[60:63], v[108:111], v[52:55]
  s_waitcnt vmcnt(9)
  buffer_store_dword v14, v2, s[16:19], s22 offen
  v_mfma_f32_16x16x32_bf16 v[56:59], a[64:67], v[108:111], v[56:59]
  buffer_load_dwordx4 v8, s[16:19], s63 offen offset:3072 sc1 lds
  v_mfma_f32_16x16x32_bf16 v[60:63], a[68:71], v[108:111], v[60:63]
  s_waitcnt lgkmcnt(2)
  v_mfma_f32_16x16x32_bf16 v[40:43], a[72:75], v[88:91], v[40:43]
  s_barrier
  ds_read_b128 v[104:107], v112 offset:8192
  v_mfma_f32_16x16x32_bf16 v[44:47], a[76:79], v[88:91], v[44:47]
  ds_read_b128 v[108:111], v112 offset:24576
  v_mfma_f32_16x16x32_bf16 v[48:51], a[80:83], v[88:91], v[48:51]
  v_mfma_f32_16x16x32_bf16 v[52:55], a[72:75], v[92:95], v[52:55]
  v_mfma_f32_16x16x32_bf16 v[56:59], a[76:79], v[92:95], v[56:59]
  v_mfma_f32_16x16x32_bf16 v[60:63], a[80:83], v[92:95], v[60:63]
  s_waitcnt lgkmcnt(2)
  v_mfma_f32_16x16x32_bf16 v[40:43], a[84:87], v[96:99], v[40:43]
  ds_read_b128 v[88:91], v112 offset:9216
  v_mfma_f32_16x16x32_bf16 v[44:47], a[88:91], v[96:99], v[44:47]
  ds_read_b128 v[92:95], v112 offset:25600
  v_mfma_f32_16x16x32_bf16 v[48:51], a[92:95], v[96:99], v[48:51]
  v_mfma_f32_16x16x32_bf16 v[52:55], a[84:87], v[100:103], v[52:55]
  v_mfma_f32_16x16x32_bf16 v[56:59], a[88:91], v[100:103], v[56:59]
  s_waitcnt vmcnt(9)
  v_cmp_ne_u32 vcc, s13, v124
  s_cbranch_vccnz LF_ppr_16
LF_ppb_18:
  v_mfma_f32_16x16x32_bf16 v[60:63], a[92:95], v[100:103], v[60:63]
  s_waitcnt lgkmcnt(2)
  buffer_load_dwordx4 v[144:147], v1, s[16:19], s59 offen offset:0 sc1
  v_mfma_f32_16x16x32_bf16 v[40:43], a[96:99], v[104:107], v[40:43]
  buffer_load_dwordx4 v[148:151], v1, s[16:19], s59 offen offset:1024 sc1
  ds_read_b128 v[96:99], v112 offset:10240
  v_mfma_f32_16x16x32_bf16 v[44:47], a[100:103], v[104:107], v[44:47]
  ds_read_b128 v[100:103], v112 offset:26624
  v_mfma_f32_16x16x32_bf16 v[48:51], a[104:107], v[104:107], v[48:51]
  v_mfma_f32_16x16x32_bf16 v[52:55], a[96:99], v[108:111], v[52:55]
  buffer_load_dwordx4 v[152:155], v1, s[16:19], s77 offen offset:2048 sc1
  v_mfma_f32_16x16x32_bf16 v[56:59], a[100:103], v[108:111], v[56:59]
  v_mfma_f32_16x16x32_bf16 v[60:63], a[104:107], v[108:111], v[60:63]
  s_waitcnt lgkmcnt(2)
  v_mfma_f32_16x16x32_bf16 v[40:43], a[108:111], v[88:91], v[40:43]
  ds_read_b128 v[104:107], v112 offset:11264
  v_mfma_f32_16x16x32_bf16 v[44:47], a[112:115], v[88:91], v[44:47]
  s_add_u32 s56, s77, 4096
  buffer_load_dwordx4 v[156:159], v1, s[16:19], s77 offen offset:3072 sc1
  ds_read_b128 v[108:111], v112 offset:27648
  v_mfma_f32_16x16x32_bf16 v[48:51], a[116:119], v[88:91], v[48:51]
  v_mfma_f32_16x16x32_bf16 v[52:55], a[108:111], v[92:95], v[52:55]
  v_mfma_f32_16x16x32_bf16 v[56:59], a[112:115], v[92:95], v[56:59]
  v_mfma_f32_16x16x32_bf16 v[60:63], a[116:119], v[92:95], v[60:63]
  s_waitcnt lgkmcnt(2)
  buffer_load_dwordx4 v[160:163], v1, s[16:19], s56 offen offset:0 sc1
  v_mfma_f32_16x16x32_bf16 v[40:43], a[120:123], v[96:99], v[40:43]
  ds_read_b128 v[88:91], v112 offset:12288
  v_mfma_f32_16x16x32_bf16 v[44:47], a[124:127], v[96:99], v[44:47]
  ds_read_b128 v[92:95], v112 offset:28672
  v_mfma_f32_16x16x32_bf16 v[48:51], a[128:131], v[96:99], v[48:51]
  v_mfma_f32_16x16x32_bf16 v[52:55], a[120:123], v[100:103], v[52:55]
  s_lshl_b32 s20, s69, 1
  s_add_u32 s20, s20, 524544
  buffer_load_dword v123, v12, s[16:19], s20 offen sc1
  v_mfma_f32_16x16x32_bf16 v[56:59], a[124:127], v[100:103], v[56:59]
  buffer_load_dwordx4 v[164:167], v1, s[16:19], s56 offen offset:1024 sc1
  v_mfma_f32_16x16x32_bf16 v[60:63], a[128:131], v[100:103], v[60:63]
  s_waitcnt lgkmcnt(2)
  v_mfma_f32_16x16x32_bf16 v[40:43], a[132:135], v[104:107], v[40:43]
  ds_read_b128 v[96:99], v112 offset:13312
  v_mfma_f32_16x16x32_bf16 v[44:47], a[136:139], v[104:107], v[44:47]
  buffer_load_dwordx4 v[168:171], v1, s[16:19], s56 offen offset:2048 sc1
  ds_read_b128 v[100:103], v112 offset:29696
  v_mfma_f32_16x16x32_bf16 v[48:51], a[140:143], v[104:107], v[48:51]
  v_mfma_f32_16x16x32_bf16 v[52:55], a[132:135], v[108:111], v[52:55]
  v_mfma_f32_16x16x32_bf16 v[56:59], a[136:139], v[108:111], v[56:59]
  v_mfma_f32_16x16x32_bf16 v[60:63], a[140:143], v[108:111], v[60:63]
  s_waitcnt lgkmcnt(2)
  v_mfma_f32_16x16x32_bf16 v[40:43], a[144:147], v[88:91], v[40:43]
  ds_read_b128 v[104:107], v112 offset:14336
  v_mfma_f32_16x16x32_bf16 v[44:47], a[148:151], v[88:91], v[44:47]
  ds_read_b128 v[108:111], v112 offset:30720
  v_mfma_f32_16x16x32_bf16 v[48:51], a[152:155], v[88:91], v[48:51]
  v_mfma_f32_16x16x32_bf16 v[52:55], a[144:147], v[92:95], v[52:55]
  v_mfma_f32_16x16x32_bf16 v[56:59], a[148:151], v[92:95], v[56:59]
  v_mfma_f32_16x16x32_bf16 v[60:63], a[152:155], v[92:95], v[60:63]
  s_waitcnt lgkmcnt(2)
  v_mfma_f32_16x16x32_bf16 v[40:43], a[156:159], v[96:99], v[40:43]
  ds_read_b128 v[88:91], v112 offset:15360
  v_mfma_f32_16x16x32_bf16 v[44:47], a[160:163], v[96:99], v[44:47]
  ds_read_b128 v[92:95], v112 offset:31744
  v_mfma_f32_16x16x32_bf16 v[48:51], a[164:167], v[96:99], v[48:51]
  v_mfma_f32_16x16x32_bf16 v[52:55], a[156:159], v[100:103], v[52:55]
  v_mfma_f32_16x16x32_bf16 v[56:59], a[160:163], v[100:103], v[56:59]
  v_mfma_f32_16x16x32_bf16 v[60:63], a[164:167], v[100:103], v[60:63]
  s_waitcnt lgkmcnt(2)
  v_mfma_f32_16x16x32_bf16 v[40:43], a[168:171], v[104:107], v[40:43]
  s_waitcnt vmcnt(8)
  v_add_u32 v112, 0, v1
  s_barrier
  ds_read_b128 v[96:99], v112 offset:32768
  v_mfma_f32_16x16x32_bf16 v[44:47], a[172:175], v[104:107], v[44:47]
  buffer_load_dwordx4 v[172:175], v1, s[16:19], s56 offen offset:3072 sc1
  s_add_u32 s56, s77, 8192
  ds_read_b128 v[100:103], v112 offset:49152
  v_mfma_f32_16x16x32_bf16 v[48:51], a[176:179], v[104:107], v[48:51]
  buffer_load_dwordx4 v[176:179], v1, s[16:19], s56 offen offset:0 sc1
  v_mfma_f32_16x16x32_bf16 v[52:55], a[168:171], v[108:111], v[52:55]
  v_mfma_f32_16x16x32_bf16 v[56:59], a[172:175], v[108:111], v[56:59]
  v_mfma_f32_16x16x32_bf16 v[60:63], a[176:179], v[108:111], v[60:63]
  s_waitcnt lgkmcnt(2)
  buffer_load_dwordx4 v[180:183], v1, s[16:19], s56 offen offset:1024 sc1
  v_mfma_f32_16x16x32_bf16 v[40:43], a[180:183], v[88:91], v[40:43]
  ds_read_b128 v[104:107], v112 offset:33792
  v_mfma_f32_16x16x32_bf16 v[44:47], a[184:187], v[88:91], v[44:47]
  ds_read_b128 v[108:111], v112 offset:50176
  v_mfma_f32_16x16x32_bf16 v[48:51], a[188:191], v[88:91], v[48:51]
  v_mfma_f32_16x16x32_bf16 v[52:55], a[180:183], v[92:95], v[52:55]
  buffer_load_dwordx4 v[184:187], v1, s[16:19], s56 offen offset:2048 sc1
  v_mfma_f32_16x16x32_bf16 v[56:59], a[184:187], v[92:95], v[56:59]
  v_mfma_f32_16x16x32_bf16 v[60:63], a[188:191], v[92:95], v[60:63]
  s_waitcnt lgkmcnt(2)
  v_mfma_f32_16x16x32_bf16 v[64:67], a[0:3], v[96:99], 0
  s_waitcnt vmcnt(6)
  v_cmp_ne_u32 vcc, s13, v123
  s_cbranch_vccnz LF_xfr_22
LF_xfb_24:
  ds_read_b128 v[88:91], v112 offset:34816
  v_mfma_f32_16x16x32_bf16 v[68:71], a[4:7], v[96:99], 0
  s_add_u32 m0, s64, 65536
  s_mov_b32 s63, 65536
  v_max_f32 v40, 0, v40
  v_max_f32 v41, 0, v41
  v_max_f32 v42, 0, v42
  v_max_f32 v43, 0, v43
  v_mul_f32 v40, v40, v44
  v_mul_f32 v41, v41, v45
  ds_read_b128 v[92:95], v112 offset:51200
  v_mfma_f32_16x16x32_bf16 v[72:75], a[8:11], v[96:99], 0
  buffer_load_dwordx4 v8, s[16:19], s63 offen offset:0 sc1 lds
  v_mul_f32 v42, v42, v46
  v_mul_f32 v43, v43, v47
  v_cvt_pk_bf16_f32 v114, v40, v41
  v_cvt_pk_bf16_f32 v115, v42, v43
  v_max_f32 v52, 0, v52
  v_max_f32 v53, 0, v53
  v_max_f32 v54, 0, v54
  v_mfma_f32_16x16x32_bf16 v[76:79], a[0:3], v[100:103], 0
  buffer_load_dwordx4 v8, s[16:19], s63 offen offset:1024 sc1 lds
  v_max_f32 v55, 0, v55
  v_mul_f32 v52, v52, v56
  v_mul_f32 v53, v53, v57
  v_mul_f32 v54, v54, v58
  v_mul_f32 v55, v55, v59
  v_cvt_pk_bf16_f32 v116, v52, v53
  v_cvt_pk_bf16_f32 v117, v54, v55
  v_mfma_f32_16x16x32_bf16 v[80:83], a[4:7], v[100:103], 0
  v_permlane16_swap_b32 v48, v60
  v_permlane16_swap_b32 v49, v61
  v_permlane16_swap_b32 v50, v62
  v_permlane16_swap_b32 v51, v63
  v_mfma_f32_16x16x32_bf16 v[84:87], a[8:11], v[100:103], 0
  s_mov_b32 s15, 0
  s_waitcnt lgkmcnt(2)
  buffer_load_dwordx4 v8, s[16:19], s63 offen offset:2048 sc1 lds
  v_permlane16_swap_b32 v114, v116
  v_permlane16_swap_b32 v115, v117
  buffer_store_dwordx4 v[114:117], v10, s[16:19], s15 offen sc1
  v_max_f32 v48, 0, v48
  v_mfma_f32_16x16x32_bf16 v[64:67], a[12:15], v[104:107], v[64:67]
  ds_read_b128 v[96:99], v112 offset:35840
  v_max_f32 v49, 0, v49
  v_max_f32 v50, 0, v50
  v_max_f32 v51, 0, v51
  v_mul_f32 v48, v48, v60
  v_mul_f32 v49, v49, v61
  v_mul_f32 v50, v50, v62
  v_mul_f32 v51, v51, v63
  v_mfma_f32_16x16x32_bf16 v[68:71], a[16:19], v[104:107], v[68:71]
  v_cvt_pk_bf16_f32 v118, v48, v49
  v_cvt_pk_bf16_f32 v119, v50, v51
  v_mov_b32 v120, v118
  v_mov_b32 v121, v119
  s_nop 0
  ds_read_b128 v[100:103], v112 offset:52224
  v_permlane32_swap_b32 v118, v120
  v_mfma_f32_16x16x32_bf16 v[72:75], a[20:23], v[104:107], v[72:75]
  v_permlane32_swap_b32 v119, v121
  buffer_store_dwordx4 v[118:121], v11, s[16:19], s15 offen sc1
  v_mfma_f32_16x16x32_bf16 v[76:79], a[12:15], v[108:111], v[76:79]
  s_add_u32 s22, s23, 557056
  v_mfma_f32_16x16x32_bf16 v[80:83], a[16:19], v[108:111], v[80:83]
  v_mfma_f32_16x16x32_bf16 v[84:87], a[20:23], v[108:111], v[84:87]
  s_waitcnt lgkmcnt(2)
  v_mfma_f32_16x16x32_bf16 v[64:67], a[24:27], v[88:91], v[64:67]
  ds_read_b128 v[104:107], v112 offset:36864
  v_mfma_f32_16x16x32_bf16 v[68:71], a[28:31], v[88:91], v[68:71]
  ds_read_b128 v[108:111], v112 offset:53248
  v_mfma_f32_16x16x32_bf16 v[72:75], a[32:35], v[88:91], v[72:75]
  buffer_load_dwordx4 v8, s[16:19], s63 offen offset:3072 sc1 lds
  s_add_u32 m0, s64, 73728
  s_mov_b32 s63, 73728
  v_mfma_f32_16x16x32_bf16 v[76:79], a[24:27], v[92:95], v[76:79]
  v_mfma_f32_16x16x32_bf16 v[80:83], a[28:31], v[92:95], v[80:83]
  v_mfma_f32_16x16x32_bf16 v[84:87], a[32:35], v[92:95], v[84:87]
  s_waitcnt lgkmcnt(2)
  v_mfma_f32_16x16x32_bf16 v[64:67], a[36:39], v[96:99], v[64:67]
  ds_read_b128 v[88:91], v112 offset:37888
  v_mfma_f32_16x16x32_bf16 v[68:71], a[40:43], v[96:99], v[68:71]
  buffer_load_dwordx4 v8, s[16:19], s63 offen offset:0 sc1 lds
  ds_read_b128 v[92:95], v112 offset:54272
  v_mfma_f32_16x16x32_bf16 v[72:75], a[44:47], v[96:99], v[72:75]
  v_mfma_f32_16x16x32_bf16 v[76:79], a[36:39], v[100:103], v[76:79]
  v_mfma_f32_16x16x32_bf16 v[80:83], a[40:43], v[100:103], v[80:83]
  v_mfma_f32_16x16x32_bf16 v[84:87], a[44:47], v[100:103], v[84:87]
  s_waitcnt lgkmcnt(2)
  v_mfma_f32_16x16x32_bf16 v[64:67], a[48:51], v[104:107], v[64:67]
  buffer_load_dwordx4 v8, s[16:19], s63 offen offset:1024 sc1 lds
  ds_read_b128 v[96:99], v112 offset:38912
  v_mfma_f32_16x16x32_bf16 v[68:71], a[52:55], v[104:107], v[68:71]
  ds_read_b128 v[100:103], v112 offset:55296
  v_mfma_f32_16x16x32_bf16 v[72:75], a[56:59], v[104:107], v[72:75]
  v_mfma_f32_16x16x32_bf16 v[76:79], a[48:51], v[108:111], v[76:79]
  v_mfma_f32_16x16x32_bf16 v[80:83], a[52:55], v[108:111], v[80:83]
  v_mfma_f32_16x16x32_bf16 v[84:87], a[56:59], v[108:111], v[84:87]
  s_waitcnt lgkmcnt(2)
  buffer_load_dwordx4 v8, s[16:19], s63 offen offset:2048 sc1 lds
  v_mfma_f32_16x16x32_bf16 v[64:67], a[60:63], v[88:91], v[64:67]
  ds_read_b128 v[104:107], v112 offset:39936
  v_mfma_f32_16x16x32_bf16 v[68:71], a[64:67], v[88:91], v[68:71]
  ds_read_b128 v[108:111], v112 offset:56320
  v_mfma_f32_16x16x32_bf16 v[72:75], a[68:71], v[88:91], v[72:75]
  v_mfma_f32_16x16x32_bf16 v[76:79], a[60:63], v[92:95], v[76:79]
  buffer_load_dwordx4 v8, s[16:19], s63 offen offset:3072 sc1 lds
  s_add_u32 m0, s64, 98304
  s_mov_b32 s63, 98304
  v_mfma_f32_16x16x32_bf16 v[80:83], a[64:67], v[92:95], v[80:83]
  v_mfma_f32_16x16x32_bf16 v[84:87], a[68:71], v[92:95], v[84:87]
  s_waitcnt lgkmcnt(2)
  v_mfma_f32_16x16x32_bf16 v[64:67], a[72:75], v[96:99], v[64:67]
  ds_read_b128 v[88:91], v112 offset:40960
  v_mfma_f32_16x16x32_bf16 v[68:71], a[76:79], v[96:99], v[68:71]
  ds_read_b128 v[92:95], v112 offset:57344
  v_mfma_f32_16x16x32_bf16 v[72:75], a[80:83], v[96:99], v[72:75]
  buffer_load_dwordx4 v8, s[16:19], s63 offen offset:0 sc1 lds
  v_mfma_f32_16x16x32_bf16 v[76:79], a[72:75], v[100:103], v[76:79]
  v_mfma_f32_16x16x32_bf16 v[80:83], a[76:79], v[100:103], v[80:83]
  v_mfma_f32_16x16x32_bf16 v[84:87], a[80:83], v[100:103], v[84:87]
  s_waitcnt lgkmcnt(2)
  v_mfma_f32_16x16x32_bf16 v[64:67], a[84:87], v[104:107], v[64:67]
  ds_read_b128 v[96:99], v112 offset:41984
  v_mfma_f32_16x16x32_bf16 v[68:71], a[88:91], v[104:107], v[68:71]
  buffer_load_dwordx4 v8, s[16:19], s63 offen offset:1024 sc1 lds
  ds_read_b128 v[100:103], v112 offset:58368
  v_mfma_f32_16x16x32_bf16 v[72:75], a[92:95], v[104:107], v[72:75]
  v_mfma_f32_16x16x32_bf16 v[76:79], a[84:87], v[108:111], v[76:79]
  v_mfma_f32_16x16x32_bf16 v[80:83], a[88:91], v[108:111], v[80:83]
  v_mfma_f32_16x16x32_bf16 v[84:87], a[92:95], v[108:111], v[84:87]
  s_waitcnt lgkmcnt(2)
  v_mfma_f32_16x16x32_bf16 v[64:67], a[96:99], v[88:91], v[64:67]
  buffer_load_dwordx4 v8, s[16:19], s63 offen offset:2048 sc1 lds
  ds_read_b128 v[104:107], v112 offset:43008
  v_mfma_f32_16x16x32_bf16 v[68:71], a[100:103], v[88:91], v[68:71]
  ds_read_b128 v[108:111], v112 offset:59392
  v_mfma_f32_16x16x32_bf16 v[72:75], a[104:107], v[88:91], v[72:75]
  v_mfma_f32_16x16x32_bf16 v[76:79], a[96:99], v[92:95], v[76:79]
  v_mfma_f32_16x16x32_bf16 v[80:83], a[100:103], v[92:95], v[80:83]
  v_mfma_f32_16x16x32_bf16 v[84:87], a[104:107], v[92:95], v[84:87]
  buffer_load_dwordx4 v8, s[16:19], s63 offen offset:3072 sc1 lds
  s_add_u32 m0, s64, 106496
  s_mov_b32 s63, 106496
  s_waitcnt lgkmcnt(2)
  v_mfma_f32_16x16x32_bf16 v[64:67], a[108:111], v[96:99], v[64:67]
  ds_read_b128 v[88:91], v112 offset:44032
  v_mfma_f32_16x16x32_bf16 v[68:71], a[112:115], v[96:99], v[68:71]
  ds_read_b128 v[92:95], v112 offset:60416
  v_mfma_f32_16x16x32_bf16 v[72:75], a[116:119], v[96:99], v[72:75]
  v_mfma_f32_16x16x32_bf16 v[76:79], a[108:111], v[100:103], v[76:79]
  v_mfma_f32_16x16x32_bf16 v[80:83], a[112:115], v[100:103], v[80:83]
  buffer_load_dwordx4 v8, s[16:19], s63 offen offset:0 sc1 lds
  v_mfma_f32_16x16x32_bf16 v[84:87], a[116:119], v[100:103], v[84:87]
  s_waitcnt lgkmcnt(2)
  v_mfma_f32_16x16x32_bf16 v[64:67], a[120:123], v[104:107], v[64:67]
  ds_read_b128 v[96:99], v112 offset:45056
  v_mfma_f32_16x16x32_bf16 v[68:71], a[124:127], v[104:107], v[68:71]
  ds_read_b128 v[100:103], v112 offset:61440
  v_mfma_f32_16x16x32_bf16 v[72:75], a[128:131], v[104:107], v[72:75]
  buffer_load_dwordx4 v8, s[16:19], s63 offen offset:1024 sc1 lds
  v_mfma_f32_16x16x32_bf16 v[76:79], a[120:123], v[108:111], v[76:79]
  v_mfma_f32_16x16x32_bf16 v[80:83], a[124:127], v[108:111], v[80:83]
  v_mfma_f32_16x16x32_bf16 v[84:87], a[128:131], v[108:111], v[84:87]
  s_waitcnt lgkmcnt(2)
  v_mfma_f32_16x16x32_bf16 v[64:67], a[132:135], v[88:91], v[64:67]
  ds_read_b128 v[104:107], v112 offset:46080
  v_mfma_f32_16x16x32_bf16 v[68:71], a[136:139], v[88:91], v[68:71]
  buffer_load_dwordx4 v8, s[16:19], s63 offen offset:2048 sc1 lds
  ds_read_b128 v[108:111], v112 offset:62464
  v_mfma_f32_16x16x32_bf16 v[72:75], a[140:143], v[88:91], v[72:75]
  v_mfma_f32_16x16x32_bf16 v[76:79], a[132:135], v[92:95], v[76:79]
  v_mfma_f32_16x16x32_bf16 v[80:83], a[136:139], v[92:95], v[80:83]
  v_mfma_f32_16x16x32_bf16 v[84:87], a[140:143], v[92:95], v[84:87]
  s_waitcnt vmcnt(12)
  s_waitcnt lgkmcnt(2)
  buffer_store_dword v14, v2, s[16:19], s22 offen
  v_mfma_f32_16x16x32_bf16 v[64:67], a[144:147], v[96:99], v[64:67]
  ds_read_b128 v[88:91], v112 offset:47104
  v_mfma_f32_16x16x32_bf16 v[68:71], a[148:151], v[96:99], v[68:71]
  buffer_load_dwordx4 v8, s[16:19], s63 offen offset:3072 sc1 lds
  ds_read_b128 v[92:95], v112 offset:63488
  v_mfma_f32_16x16x32_bf16 v[72:75], a[152:155], v[96:99], v[72:75]
  v_mfma_f32_16x16x32_bf16 v[76:79], a[144:147], v[100:103], v[76:79]
  v_mfma_f32_16x16x32_bf16 v[80:83], a[148:151], v[100:103], v[80:83]
  v_mfma_f32_16x16x32_bf16 v[84:87], a[152:155], v[100:103], v[84:87]
  buffer_load_dwordx4 v[188:191], v1, s[16:19], s56 offen offset:3072 sc1
  s_add_u32 s56, s77, 12288
  s_waitcnt lgkmcnt(2)
  v_mfma_f32_16x16x32_bf16 v[64:67], a[156:159], v[104:107], v[64:67]
  ds_read_b128 v[96:99], v112 offset:48128
  v_mfma_f32_16x16x32_bf16 v[68:71], a[160:163], v[104:107], v[68:71]
  ds_read_b128 v[100:103], v112 offset:64512
  v_mfma_f32_16x16x32_bf16 v[72:75], a[164:167], v[104:107], v[72:75]
  v_mfma_f32_16x16x32_bf16 v[76:79], a[156:159], v[108:111], v[76:79]
  buffer_load_dwordx4 v[192:195], v1, s[16:19], s56 offen offset:0 sc1
  v_mfma_f32_16x16x32_bf16 v[80:83], a[160:163], v[108:111], v[80:83]
  v_mfma_f32_16x16x32_bf16 v[84:87], a[164:167], v[108:111], v[84:87]
  s_waitcnt lgkmcnt(2)
  v_mfma_f32_16x16x32_bf16 v[64:67], a[168:171], v[88:91], v[64:67]
  s_waitcnt vmcnt(11)
  v_add_u32 v112, 65536, v1
  s_barrier
  ds_read_b128 v[104:107], v112 offset:0
  v_mfma_f32_16x16x32_bf16 v[68:71], a[172:175], v[88:91], v[68:71]
  buffer_load_dwordx4 v[196:199], v1, s[16:19], s56 offen offset:1024 sc1
  ds_read_b128 v[108:111], v112 offset:16384
  v_mfma_f32_16x16x32_bf16 v[72:75], a[176:179], v[88:91], v[72:75]
  buffer_load_dwordx4 v[200:203], v1, s[16:19], s56 offen offset:2048 sc1
  v_mfma_f32_16x16x32_bf16 v[76:79], a[168:171], v[92:95], v[76:79]
  v_mfma_f32_16x16x32_bf16 v[80:83], a[172:175], v[92:95], v[80:83]
  v_mfma_f32_16x16x32_bf16 v[84:87], a[176:179], v[92:95], v[84:87]
  s_waitcnt lgkmcnt(2)
  v_mfma_f32_16x16x32_bf16 v[64:67], a[180:183], v[96:99], v[64:67]
  buffer_load_dwordx4 v[204:207], v1, s[16:19], s56 offen offset:3072 sc1
  s_add_u32 s56, s77, 16384
  ds_read_b128 v[88:91], v112 offset:1024
  v_mfma_f32_16x16x32_bf16 v[68:71], a[184:187], v[96:99], v[68:71]
  ds_read_b128 v[92:95], v112 offset:17408
  v_mfma_f32_16x16x32_bf16 v[72:75], a[188:191], v[96:99], v[72:75]
  v_mfma_f32_16x16x32_bf16 v[76:79], a[180:183], v[100:103], v[76:79]
  v_mfma_f32_16x16x32_bf16 v[80:83], a[184:187], v[100:103], v[80:83]
  buffer_load_dwordx4 v[208:211], v1, s[16:19], s56 offen offset:0 sc1
  v_mfma_f32_16x16x32_bf16 v[84:87], a[188:191], v[100:103], v[84:87]
  s_lshl_b32 s20, s69, 1
  s_add_u32 s20, s20, 557056
  s_waitcnt lgkmcnt(2)
  buffer_load_dword v123, v13, s[16:19], s20 offen sc1
  v_mfma_f32_16x16x32_bf16 v[40:43], a[0:3], v[104:107], 0
  ds_read_b128 v[96:99], v112 offset:2048
  v_mfma_f32_16x16x32_bf16 v[44:47], a[4:7], v[104:107], 0
  ds_read_b128 v[100:103], v112 offset:18432
  v_max_f32 v64, 0, v64
  v_max_f32 v65, 0, v65
  v_max_f32 v66, 0, v66
  v_max_f32 v67, 0, v67
  v_mul_f32 v64, v64, v68
  v_mul_f32 v65, v65, v69
  v_mul_f32 v66, v66, v70
  v_mfma_f32_16x16x32_bf16 v[48:51], a[8:11], v[104:107], 0
  buffer_load_dwordx4 v[212:215], v1, s[16:19], s56 offen offset:1024 sc1
  v_mul_f32 v67, v67, v71
  v_cvt_pk_bf16_f32 v114, v64, v65
  v_cvt_pk_bf16_f32 v115, v66, v67
  v_max_f32 v76, 0, v76
  v_max_f32 v77, 0, v77
  v_max_f32 v78, 0, v78
  v_max_f32 v79, 0, v79
  v_mfma_f32_16x16x32_bf16 v[52:55], a[0:3], v[108:111], 0
  v_mul_f32 v76, v76, v80
  v_mul_f32 v77, v77, v81
  v_mul_f32 v78, v78, v82
  v_mul_f32 v79, v79, v83
  v_cvt_pk_bf16_f32 v116, v76, v77
  v_cvt_pk_bf16_f32 v117, v78, v79
  v_permlane16_swap_b32 v72, v84
  v_mfma_f32_16x16x32_bf16 v[56:59], a[4:7], v[108:111], 0
  v_permlane16_swap_b32 v73, v85
  v_permlane16_swap_b32 v74, v86
  v_permlane16_swap_b32 v75, v87
  v_permlane16_swap_b32 v114, v116
  v_mfma_f32_16x16x32_bf16 v[60:63], a[8:11], v[108:111], 0
  s_mov_b32 s15, 98304
  s_waitcnt lgkmcnt(2)
  v_permlane16_swap_b32 v115, v117
  buffer_store_dwordx4 v[114:117], v10, s[16:19], s15 offen sc1
  v_max_f32 v72, 0, v72
  v_max_f32 v73, 0, v73
  v_max_f32 v74, 0, v74
  v_max_f32 v75, 0, v75
  v_mfma_f32_16x16x32_bf16 v[40:43], a[12:15], v[88:91], v[40:43]
  ds_read_b128 v[104:107], v112 offset:3072
  v_mul_f32 v72, v72, v84
  v_mul_f32 v73, v73, v85
  v_mul_f32 v74, v74, v86
  v_mul_f32 v75, v75, v87
  v_cvt_pk_bf16_f32 v118, v72, v73
  v_cvt_pk_bf16_f32 v119, v74, v75
  v_mov_b32 v120, v118
  v_mfma_f32_16x16x32_bf16 v[44:47], a[16:19], v[88:91], v[44:47]
  v_mov_b32 v121, v119
  s_nop 0
  v_permlane32_swap_b32 v118, v120
  v_permlane32_swap_b32 v119, v121
  buffer_store_dwordx4 v[118:121], v11, s[16:19], s15 offen sc1
  ds_read_b128 v[108:111], v112 offset:19456
  v_mfma_f32_16x16x32_bf16 v[48:51], a[20:23], v[88:91], v[48:51]
  s_add_u32 s22, s23, 557312
  v_mfma_f32_16x16x32_bf16 v[52:55], a[12:15], v[92:95], v[52:55]
  v_mfma_f32_16x16x32_bf16 v[56:59], a[16:19], v[92:95], v[56:59]
  buffer_load_dwordx4 v[216:219], v1, s[16:19], s56 offen offset:2048 sc1
  v_mfma_f32_16x16x32_bf16 v[60:63], a[20:23], v[92:95], v[60:63]
  s_waitcnt lgkmcnt(2)
  v_mfma_f32_16x16x32_bf16 v[40:43], a[24:27], v[96:99], v[40:43]
  ds_read_b128 v[88:91], v112 offset:4096
  v_mfma_f32_16x16x32_bf16 v[44:47], a[28:31], v[96:99], v[44:47]
  buffer_load_dwordx4 v[220:223], v1, s[16:19], s56 offen offset:3072 sc1
  s_add_u32 s56, s77, 20480
  ds_read_b128 v[92:95], v112 offset:20480
  v_mfma_f32_16x16x32_bf16 v[48:51], a[32:35], v[96:99], v[48:51]
  v_mfma_f32_16x16x32_bf16 v[52:55], a[24:27], v[100:103], v[52:55]
  v_mfma_f32_16x16x32_bf16 v[56:59], a[28:31], v[100:103], v[56:59]
  v_mfma_f32_16x16x32_bf16 v[60:63], a[32:35], v[100:103], v[60:63]
  s_waitcnt lgkmcnt(2)
  buffer_load_dwordx4 v[224:227], v1, s[16:19], s56 offen offset:0 sc1
  v_mfma_f32_16x16x32_bf16 v[40:43], a[36:39], v[104:107], v[40:43]
  buffer_load_dwordx4 v[228:231], v1, s[16:19], s56 offen offset:1024 sc1
  ds_read_b128 v[96:99], v112 offset:5120
  v_mfma_f32_16x16x32_bf16 v[44:47], a[40:43], v[104:107], v[44:47]
  ds_read_b128 v[100:103], v112 offset:21504
  v_mfma_f32_16x16x32_bf16 v[48:51], a[44:47], v[104:107], v[48:51]
  v_mfma_f32_16x16x32_bf16 v[52:55], a[36:39], v[108:111], v[52:55]
  v_mfma_f32_16x16x32_bf16 v[56:59], a[40:43], v[108:111], v[56:59]
  buffer_load_dwordx4 v[232:235], v1, s[16:19], s56 offen offset:2048 sc1
  v_mfma_f32_16x16x32_bf16 v[60:63], a[44:47], v[108:111], v[60:63]
  s_waitcnt lgkmcnt(2)
  v_mfma_f32_16x16x32_bf16 v[40:43], a[48:51], v[88:91], v[40:43]
  ds_read_b128 v[104:107], v112 offset:6144
  v_mfma_f32_16x16x32_bf16 v[44:47], a[52:55], v[88:91], v[44:47]
  ds_read_b128 v[108:111], v112 offset:22528
  v_mfma_f32_16x16x32_bf16 v[48:51], a[56:59], v[88:91], v[48:51]
  buffer_load_dwordx4 v[236:239], v1, s[16:19], s56 offen offset:3072 sc1
  s_add_u32 s56, s77, 24576
  v_mfma_f32_16x16x32_bf16 v[52:55], a[48:51], v[92:95], v[52:55]
  v_mfma_f32_16x16x32_bf16 v[56:59], a[52:55], v[92:95], v[56:59]
  v_mfma_f32_16x16x32_bf16 v[60:63], a[56:59], v[92:95], v[60:63]
  s_waitcnt vmcnt(9)
  v_cmp_ne_u32 vcc, s13, v123
  s_cbranch_vccnz LF_hfr_37
LF_hfb_39:
  s_waitcnt lgkmcnt(2)
  v_mfma_f32_16x16x32_bf16 v[40:43], a[60:63], v[96:99], v[40:43]
  s_add_u32 m0, s54, 0
  s_add_u32 s63, s52, 0
  ds_read_b128 v[88:91], v112 offset:7168
  v_mfma_f32_16x16x32_bf16 v[44:47], a[64:67], v[96:99], v[44:47]
  buffer_load_dwordx4 v9, s[16:19], s63 offen offset:0 sc1 lds
  ds_read_b128 v[92:95], v112 offset:23552
  v_mfma_f32_16x16x32_bf16 v[48:51], a[68:71], v[96:99], v[48:51]
  buffer_load_dwordx4 v[240:243], v1, s[16:19], s56 offen offset:0 sc1
  v_mfma_f32_16x16x32_bf16 v[52:55], a[60:63], v[100:103], v[52:55]
  v_mfma_f32_16x16x32_bf16 v[56:59], a[64:67], v[100:103], v[56:59]
  v_mfma_f32_16x16x32_bf16 v[60:63], a[68:71], v[100:103], v[60:63]
  s_waitcnt lgkmcnt(2)
  v_mfma_f32_16x16x32_bf16 v[40:43], a[72:75], v[104:107], v[40:43]
  ds_read_b128 v[96:99], v112 offset:8192
  v_mfma_f32_16x16x32_bf16 v[44:47], a[76:79], v[104:107], v[44:47]
  ds_read_b128 v[100:103], v112 offset:24576
  v_mfma_f32_16x16x32_bf16 v[48:51], a[80:83], v[104:107], v[48:51]
  v_mfma_f32_16x16x32_bf16 v[52:55], a[72:75], v[108:111], v[52:55]
  v_mfma_f32_16x16x32_bf16 v[56:59], a[76:79], v[108:111], v[56:59]
  v_mfma_f32_16x16x32_bf16 v[60:63], a[80:83], v[108:111], v[60:63]
  s_waitcnt lgkmcnt(2)
  v_mfma_f32_16x16x32_bf16 v[40:43], a[84:87], v[88:91], v[40:43]
  ds_read_b128 v[104:107], v112 offset:9216
  v_mfma_f32_16x16x32_bf16 v[44:47], a[88:91], v[88:91], v[44:47]
  ds_read_b128 v[108:111], v112 offset:25600
  v_mfma_f32_16x16x32_bf16 v[48:51], a[92:95], v[88:91], v[48:51]
  v_mfma_f32_16x16x32_bf16 v[52:55], a[84:87], v[92:95], v[52:55]
  v_mfma_f32_16x16x32_bf16 v[56:59], a[88:91], v[92:95], v[56:59]
  buffer_load_dwordx4 v9, s[16:19], s63 offen offset:1024 sc1 lds
  v_mfma_f32_16x16x32_bf16 v[60:63], a[92:95], v[92:95], v[60:63]
  s_waitcnt lgkmcnt(2)
  v_mfma_f32_16x16x32_bf16 v[40:43], a[96:99], v[96:99], v[40:43]
  ds_read_b128 v[88:91], v112 offset:10240
  v_mfma_f32_16x16x32_bf16 v[44:47], a[100:103], v[96:99], v[44:47]
  ds_read_b128 v[92:95], v112 offset:26624
  v_mfma_f32_16x16x32_bf16 v[48:51], a[104:107], v[96:99], v[48:51]
  buffer_load_dwordx4 v9, s[16:19], s63 offen offset:2048 sc1 lds
  v_mfma_f32_16x16x32_bf16 v[52:55], a[96:99], v[100:103], v[52:55]
  v_mfma_f32_16x16x32_bf16 v[56:59], a[100:103], v[100:103], v[56:59]
  v_mfma_f32_16x16x32_bf16 v[60:63], a[104:107], v[100:103], v[60:63]
  s_waitcnt lgkmcnt(2)
  v_mfma_f32_16x16x32_bf16 v[40:43], a[108:111], v[104:107], v[40:43]
  buffer_load_dwordx4 v9, s[16:19], s63 offen offset:3072 sc1 lds
  s_add_u32 m0, s54, 32768
  ds_read_b128 v[96:99], v112 offset:11264
  v_mfma_f32_16x16x32_bf16 v[44:47], a[112:115], v[104:107], v[44:47]
  s_add_u32 s63, s52, 8192
  ds_read_b128 v[100:103], v112 offset:27648
  v_mfma_f32_16x16x32_bf16 v[48:51], a[116:119], v[104:107], v[48:51]
  v_mfma_f32_16x16x32_bf16 v[52:55], a[108:111], v[108:111], v[52:55]
  v_mfma_f32_16x16x32_bf16 v[56:59], a[112:115], v[108:111], v[56:59]
  v_mfma_f32_16x16x32_bf16 v[60:63], a[116:119], v[108:111], v[60:63]
  s_waitcnt lgkmcnt(2)
  v_mfma_f32_16x16x32_bf16 v[40:43], a[120:123], v[88:91], v[40:43]
  buffer_load_dwordx4 v9, s[16:19], s63 offen offset:0 sc1 lds
  ds_read_b128 v[104:107], v112 offset:12288
  v_mfma_f32_16x16x32_bf16 v[44:47], a[124:127], v[88:91], v[44:47]
  ds_read_b128 v[108:111], v112 offset:28672
  v_mfma_f32_16x16x32_bf16 v[48:51], a[128:131], v[88:91], v[48:51]
  v_mfma_f32_16x16x32_bf16 v[52:55], a[120:123], v[92:95], v[52:55]
  s_waitcnt vmcnt(12)
  buffer_store_dword v14, v2, s[16:19], s22 offen
  v_mfma_f32_16x16x32_bf16 v[56:59], a[124:127], v[92:95], v[56:59]
  v_mfma_f32_16x16x32_bf16 v[60:63], a[128:131], v[92:95], v[60:63]
  s_waitcnt lgkmcnt(2)
  v_mfma_f32_16x16x32_bf16 v[40:43], a[132:135], v[96:99], v[40:43]
  buffer_load_dwordx4 v9, s[16:19], s63 offen offset:1024 sc1 lds
  ds_read_b128 v[88:91], v112 offset:13312
  v_mfma_f32_16x16x32_bf16 v[44:47], a[136:139], v[96:99], v[44:47]
  ds_read_b128 v[92:95], v112 offset:29696
  v_mfma_f32_16x16x32_bf16 v[48:51], a[140:143], v[96:99], v[48:51]
  v_mfma_f32_16x16x32_bf16 v[52:55], a[132:135], v[100:103], v[52:55]
  v_mfma_f32_16x16x32_bf16 v[56:59], a[136:139], v[100:103], v[56:59]
  v_mfma_f32_16x16x32_bf16 v[60:63], a[140:143], v[100:103], v[60:63]
  s_waitcnt lgkmcnt(2)
  v_mfma_f32_16x16x32_bf16 v[40:43], a[144:147], v[104:107], v[40:43]
  buffer_load_dwordx4 v9, s[16:19], s63 offen offset:2048 sc1 lds
  ds_read_b128 v[96:99], v112 offset:14336
  v_mfma_f32_16x16x32_bf16 v[44:47], a[148:151], v[104:107], v[44:47]
  ds_read_b128 v[100:103], v112 offset:30720
  v_mfma_f32_16x16x32_bf16 v[48:51], a[152:155], v[104:107], v[48:51]
  v_mfma_f32_16x16x32_bf16 v[52:55], a[144:147], v[108:111], v[52:55]
  v_mfma_f32_16x16x32_bf16 v[56:59], a[148:151], v[108:111], v[56:59]
  v_mfma_f32_16x16x32_bf16 v[60:63], a[152:155], v[108:111], v[60:63]
  s_waitcnt lgkmcnt(2)
  v_mfma_f32_16x16x32_bf16 v[40:43], a[156:159], v[88:91], v[40:43]
  buffer_load_dwordx4 v9, s[16:19], s63 offen offset:3072 sc1 lds
  s_add_u32 m0, s55, 131072
  ds_read_b128 v[104:107], v112 offset:15360
  v_mfma_f32_16x16x32_bf16 v[44:47], a[160:163], v[88:91], v[44:47]
  s_add_u32 s63, s53, 16384
  ds_read_b128 v[108:111], v112 offset:31744
  v_mfma_f32_16x16x32_bf16 v[48:51], a[164:167], v[88:91], v[48:51]
  v_mfma_f32_16x16x32_bf16 v[52:55], a[156:159], v[92:95], v[52:55]
  v_mfma_f32_16x16x32_bf16 v[56:59], a[160:163], v[92:95], v[56:59]
  v_mfma_f32_16x16x32_bf16 v[60:63], a[164:167], v[92:95], v[60:63]
  s_waitcnt lgkmcnt(2)
  v_mfma_f32_16x16x32_bf16 v[40:43], a[168:171], v[96:99], v[40:43]
  v_add_u32 v112, 65536, v1
  s_barrier
  ds_read_b128 v[88:91], v112 offset:32768
  v_mfma_f32_16x16x32_bf16 v[44:47], a[172:175], v[96:99], v[44:47]
  buffer_load_dwordx4 v9, s[16:19], s63 offen offset:0 sc1 lds
  ds_read_b128 v[92:95], v112 offset:49152
  v_mfma_f32_16x16x32_bf16 v[48:51], a[176:179], v[96:99], v[48:51]
  v_mfma_f32_16x16x32_bf16 v[52:55], a[168:171], v[100:103], v[52:55]
  s_lshl_b32 s20, s69, 1
  s_add_u32 s20, s20, 557312
  buffer_load_dword v123, v13, s[16:19], s20 offen sc1
  v_mfma_f32_16x16x32_bf16 v[56:59], a[172:175], v[100:103], v[56:59]
  buffer_load_dwordx4 v9, s[16:19], s63 offen offset:1024 sc1 lds
  v_mfma_f32_16x16x32_bf16 v[60:63], a[176:179], v[100:103], v[60:63]
  s_waitcnt lgkmcnt(2)
  v_mfma_f32_16x16x32_bf16 v[40:43], a[180:183], v[104:107], v[40:43]
  ds_read_b128 v[96:99], v112 offset:33792
  v_mfma_f32_16x16x32_bf16 v[44:47], a[184:187], v[104:107], v[44:47]
  ds_read_b128 v[100:103], v112 offset:50176
  v_mfma_f32_16x16x32_bf16 v[48:51], a[188:191], v[104:107], v[48:51]
  v_mfma_f32_16x16x32_bf16 v[52:55], a[180:183], v[108:111], v[52:55]
  v_mfma_f32_16x16x32_bf16 v[56:59], a[184:187], v[108:111], v[56:59]
  buffer_load_dwordx4 v9, s[16:19], s63 offen offset:2048 sc1 lds
  v_mfma_f32_16x16x32_bf16 v[60:63], a[188:191], v[108:111], v[60:63]
  s_waitcnt lgkmcnt(2)
  v_mfma_f32_16x16x32_bf16 v[64:67], a[0:3], v[88:91], 0
  ds_read_b128 v[104:107], v112 offset:34816
  v_mfma_f32_16x16x32_bf16 v[68:71], a[4:7], v[88:91], 0
  ds_read_b128 v[108:111], v112 offset:51200
  v_max_f32 v40, 0, v40
  v_max_f32 v41, 0, v41
  v_max_f32 v42, 0, v42
  v_max_f32 v43, 0, v43
  v_mul_f32 v40, v40, v44
  v_mul_f32 v41, v41, v45
  v_mul_f32 v42, v42, v46
  v_mfma_f32_16x16x32_bf16 v[72:75], a[8:11], v[88:91], 0
  buffer_load_dwordx4 v[244:247], v1, s[16:19], s56 offen offset:1024 sc1
  v_mul_f32 v43, v43, v47
  v_cvt_pk_bf16_f32 v114, v40, v41
  v_cvt_pk_bf16_f32 v115, v42, v43
  v_max_f32 v52, 0, v52
  v_max_f32 v53, 0, v53
  v_max_f32 v54, 0, v54
  v_max_f32 v55, 0, v55
  v_mfma_f32_16x16x32_bf16 v[76:79], a[0:3], v[92:95], 0
  v_mul_f32 v52, v52, v56
  v_mul_f32 v53, v53, v57
  v_mul_f32 v54, v54, v58
  v_mul_f32 v55, v55, v59
  v_cvt_pk_bf16_f32 v116, v52, v53
  v_cvt_pk_bf16_f32 v117, v54, v55
  v_permlane16_swap_b32 v48, v60
  v_mfma_f32_16x16x32_bf16 v[80:83], a[4:7], v[92:95], 0
  buffer_load_dwordx4 v[248:251], v1, s[16:19], s56 offen offset:2048 sc1
  v_permlane16_swap_b32 v49, v61
  v_permlane16_swap_b32 v50, v62
  v_permlane16_swap_b32 v51, v63
  v_mfma_f32_16x16x32_bf16 v[84:87], a[8:11], v[92:95], 0
  s_mov_b32 s15, 196608
  s_waitcnt lgkmcnt(2)
  v_permlane16_swap_b32 v114, v116
  v_permlane16_swap_b32 v115, v117
  buffer_store_dwordx4 v[114:117], v10, s[16:19], s15 offen sc1
  v_max_f32 v48, 0, v48
  v_max_f32 v49, 0, v49
  v_mfma_f32_16x16x32_bf16 v[64:67], a[12:15], v[96:99], v[64:67]
  ds_read_b128 v[88:91], v112 offset:35840
  v_max_f32 v50, 0, v50
  v_max_f32 v51, 0, v51
  v_mul_f32 v48, v48, v60
  v_mul_f32 v49, v49, v61
  v_mul_f32 v50, v50, v62
  v_mul_f32 v51, v51, v63
  v_cvt_pk_bf16_f32 v118, v48, v49
  v_mfma_f32_16x16x32_bf16 v[68:71], a[16:19], v[96:99], v[68:71]
  v_cvt_pk_bf16_f32 v119, v50, v51
  v_mov_b32 v120, v118
  v_mov_b32 v121, v119
  s_nop 0
  ds_read_b128 v[92:95], v112 offset:52224
  v_permlane32_swap_b32 v118, v120
  v_permlane32_swap_b32 v119, v121
  v_mfma_f32_16x16x32_bf16 v[72:75], a[20:23], v[96:99], v[72:75]
  buffer_load_dwordx4 v[252:255], v1, s[16:19], s56 offen offset:3072 sc1
  s_add_u32 s56, s77, 28672
  s_add_u32 s24, s73, 0
  buffer_store_dwordx4 v[118:121], v11, s[16:19], s15 offen sc1
  buffer_load_dwordx4 v[140:143], v7, s[16:19], s24 offen sc1
  v_mfma_f32_16x16x32_bf16 v[76:79], a[12:15], v[100:103], v[76:79]
  s_add_u32 s22, s23, 557568
  v_mfma_f32_16x16x32_bf16 v[80:83], a[16:19], v[100:103], v[80:83]
  v_mfma_f32_16x16x32_bf16 v[84:87], a[20:23], v[100:103], v[84:87]
  s_waitcnt lgkmcnt(2)
  v_mfma_f32_16x16x32_bf16 v[64:67], a[24:27], v[104:107], v[64:67]
  ds_read_b128 v[96:99], v112 offset:36864
  v_mfma_f32_16x16x32_bf16 v[68:71], a[28:31], v[104:107], v[68:71]
  ds_read_b128 v[100:103], v112 offset:53248
  v_mfma_f32_16x16x32_bf16 v[72:75], a[32:35], v[104:107], v[72:75]
  v_mfma_f32_16x16x32_bf16 v[76:79], a[24:27], v[108:111], v[76:79]
  buffer_load_dwordx4 a[192:195], v1, s[16:19], s56 offen offset:0 sc1
  v_mfma_f32_16x16x32_bf16 v[80:83], a[28:31], v[108:111], v[80:83]
  s_waitcnt vmcnt(9)
  v_cmp_ne_u32 vcc, s13, v123
  s_cbranch_vccnz LF_hfr_40
LF_hfb_42:
  v_mfma_f32_16x16x32_bf16 v[84:87], a[32:35], v[108:111], v[84:87]
  s_add_u32 m0, s54, 8192
  s_add_u32 s63, s52, 98304
  s_waitcnt lgkmcnt(2)
  v_mfma_f32_16x16x32_bf16 v[64:67], a[36:39], v[88:91], v[64:67]
  ds_read_b128 v[104:107], v112 offset:37888
  v_mfma_f32_16x16x32_bf16 v[68:71], a[40:43], v[88:91], v[68:71]
  buffer_load_dwordx4 v9, s[16:19], s63 offen offset:0 sc1 lds
  ds_read_b128 v[108:111], v112 offset:54272
  v_mfma_f32_16x16x32_bf16 v[72:75], a[44:47], v[88:91], v[72:75]
  v_mfma_f32_16x16x32_bf16 v[76:79], a[36:39], v[92:95], v[76:79]
  v_mfma_f32_16x16x32_bf16 v[80:83], a[40:43], v[92:95], v[80:83]
  v_mfma_f32_16x16x32_bf16 v[84:87], a[44:47], v[92:95], v[84:87]
  s_waitcnt lgkmcnt(2)
  v_mfma_f32_16x16x32_bf16 v[64:67], a[48:51], v[96:99], v[64:67]
  ds_read_b128 v[88:91], v112 offset:38912
  v_mfma_f32_16x16x32_bf16 v[68:71], a[52:55], v[96:99], v[68:71]
  buffer_load_dwordx4 v9, s[16:19], s63 offen offset:1024 sc1 lds
  ds_read_b128 v[92:95], v112 offset:55296
  v_mfma_f32_16x16x32_bf16 v[72:75], a[56:59], v[96:99], v[72:75]
  v_mfma_f32_16x16x32_bf16 v[76:79], a[48:51], v[100:103], v[76:79]
  v_mfma_f32_16x16x32_bf16 v[80:83], a[52:55], v[100:103], v[80:83]
  v_mfma_f32_16x16x32_bf16 v[84:87], a[56:59], v[100:103], v[84:87]
  s_waitcnt lgkmcnt(2)
  v_mfma_f32_16x16x32_bf16 v[64:67], a[60:63], v[104:107], v[64:67]
  buffer_load_dwordx4 v9, s[16:19], s63 offen offset:2048 sc1 lds
  ds_read_b128 v[96:99], v112 offset:39936
  v_mfma_f32_16x16x32_bf16 v[68:71], a[64:67], v[104:107], v[68:71]
  ds_read_b128 v[100:103], v112 offset:56320
  v_mfma_f32_16x16x32_bf16 v[72:75], a[68:71], v[104:107], v[72:75]
  v_mfma_f32_16x16x32_bf16 v[76:79], a[60:63], v[108:111], v[76:79]
  v_mfma_f32_16x16x32_bf16 v[80:83], a[64:67], v[108:111], v[80:83]
  v_mfma_f32_16x16x32_bf16 v[84:87], a[68:71], v[108:111], v[84:87]
  s_waitcnt lgkmcnt(2)
  v_mfma_f32_16x16x32_bf16 v[64:67], a[72:75], v[88:91], v[64:67]
  buffer_load_dwordx4 v9, s[16:19], s63 offen offset:3072 sc1 lds
  s_add_u32 m0, s54, 40960
  ds_read_b128 v[104:107], v112 offset:40960
  v_mfma_f32_16x16x32_bf16 v[68:71], a[76:79], v[88:91], v[68:71]
  s_add_u32 s63, s52, 106496
  ds_read_b128 v[108:111], v112 offset:57344
  v_mfma_f32_16x16x32_bf16 v[72:75], a[80:83], v[88:91], v[72:75]
  v_mfma_f32_16x16x32_bf16 v[76:79], a[72:75], v[92:95], v[76:79]
  v_mfma_f32_16x16x32_bf16 v[80:83], a[76:79], v[92:95], v[80:83]
  v_mfma_f32_16x16x32_bf16 v[84:87], a[80:83], v[92:95], v[84:87]
  s_waitcnt lgkmcnt(2)
  v_mfma_f32_16x16x32_bf16 v[64:67], a[84:87], v[96:99], v[64:67]
  buffer_load_dwordx4 v9, s[16:19], s63 offen offset:0 sc1 lds
  ds_read_b128 v[88:91], v112 offset:41984
  v_mfma_f32_16x16x32_bf16 v[68:71], a[88:91], v[96:99], v[68:71]
  ds_read_b128 v[92:95], v112 offset:58368
  v_mfma_f32_16x16x32_bf16 v[72:75], a[92:95], v[96:99], v[72:75]
  v_mfma_f32_16x16x32_bf16 v[76:79], a[84:87], v[100:103], v[76:79]
  v_mfma_f32_16x16x32_bf16 v[80:83], a[88:91], v[100:103], v[80:83]
  v_mfma_f32_16x16x32_bf16 v[84:87], a[92:95], v[100:103], v[84:87]
  s_waitcnt lgkmcnt(2)
  v_mfma_f32_16x16x32_bf16 v[64:67], a[96:99], v[104:107], v[64:67]
  buffer_load_dwordx4 v9, s[16:19], s63 offen offset:1024 sc1 lds
  ds_read_b128 v[96:99], v112 offset:43008
  v_mfma_f32_16x16x32_bf16 v[68:71], a[100:103], v[104:107], v[68:71]
  ds_read_b128 v[100:103], v112 offset:59392
  v_mfma_f32_16x16x32_bf16 v[72:75], a[104:107], v[104:107], v[72:75]
  v_mfma_f32_16x16x32_bf16 v[76:79], a[96:99], v[108:111], v[76:79]
  v_mfma_f32_16x16x32_bf16 v[80:83], a[100:103], v[108:111], v[80:83]
  v_mfma_f32_16x16x32_bf16 v[84:87], a[104:107], v[108:111], v[84:87]
  s_waitcnt lgkmcnt(2)
  buffer_load_dwordx4 v9, s[16:19], s63 offen offset:2048 sc1 lds
  v_mfma_f32_16x16x32_bf16 v[64:67], a[108:111], v[88:91], v[64:67]
  ds_read_b128 v[104:107], v112 offset:44032
  v_mfma_f32_16x16x32_bf16 v[68:71], a[112:115], v[88:91], v[68:71]
  ds_read_b128 v[108:111], v112 offset:60416
  v_mfma_f32_16x16x32_bf16 v[72:75], a[116:119], v[88:91], v[72:75]
  v_mfma_f32_16x16x32_bf16 v[76:79], a[108:111], v[92:95], v[76:79]
  v_mfma_f32_16x16x32_bf16 v[80:83], a[112:115], v[92:95], v[80:83]
  v_mfma_f32_16x16x32_bf16 v[84:87], a[116:119], v[92:95], v[84:87]
  buffer_load_dwordx4 v9, s[16:19], s63 offen offset:3072 sc1 lds
  s_add_u32 m0, s55, 139264
  s_add_u32 s63, s53, 114688
  s_waitcnt lgkmcnt(2)
  v_mfma_f32_16x16x32_bf16 v[64:67], a[120:123], v[96:99], v[64:67]
  ds_read_b128 v[88:91], v112 offset:45056
  v_mfma_f32_16x16x32_bf16 v[68:71], a[124:127], v[96:99], v[68:71]
  ds_read_b128 v[92:95], v112 offset:61440
  v_mfma_f32_16x16x32_bf16 v[72:75], a[128:131], v[96:99], v[72:75]
  v_mfma_f32_16x16x32_bf16 v[76:79], a[120:123], v[100:103], v[76:79]
  v_mfma_f32_16x16x32_bf16 v[80:83], a[124:127], v[100:103], v[80:83]
  v_mfma_f32_16x16x32_bf16 v[84:87], a[128:131], v[100:103], v[84:87]
  s_waitcnt lgkmcnt(2)
  buffer_load_dwordx4 a[196:199], v1, s[16:19], s56 offen offset:1024 sc1
  v_mfma_f32_16x16x32_bf16 v[64:67], a[132:135], v[104:107], v[64:67]
  ds_read_b128 v[96:99], v112 offset:46080
  v_mfma_f32_16x16x32_bf16 v[68:71], a[136:139], v[104:107], v[68:71]
  ds_read_b128 v[100:103], v112 offset:62464
  v_mfma_f32_16x16x32_bf16 v[72:75], a[140:143], v[104:107], v[72:75]
  v_mfma_f32_16x16x32_bf16 v[76:79], a[132:135], v[108:111], v[76:79]
  buffer_load_dwordx4 a[200:203], v1, s[16:19], s56 offen offset:2048 sc1
  v_mfma_f32_16x16x32_bf16 v[80:83], a[136:139], v[108:111], v[80:83]
  s_waitcnt vmcnt(12)
  buffer_store_dword v14, v2, s[16:19], s22 offen
  v_mfma_f32_16x16x32_bf16 v[84:87], a[140:143], v[108:111], v[84:87]
  s_waitcnt lgkmcnt(2)
  v_mfma_f32_16x16x32_bf16 v[64:67], a[144:147], v[88:91], v[64:67]
  ds_read_b128 v[104:107], v112 offset:47104
  v_mfma_f32_16x16x32_bf16 v[68:71], a[148:151], v[88:91], v[68:71]
  buffer_load_dwordx4 a[204:207], v1, s[16:19], s56 offen offset:3072 sc1
  s_add_u32 s56, s77, 32768
  ds_read_b128 v[108:111], v112 offset:63488
  v_mfma_f32_16x16x32_bf16 v[72:75], a[152:155], v[88:91], v[72:75]
  v_mfma_f32_16x16x32_bf16 v[76:79], a[144:147], v[92:95], v[76:79]
  v_mfma_f32_16x16x32_bf16 v[80:83], a[148:151], v[92:95], v[80:83]
  v_mfma_f32_16x16x32_bf16 v[84:87], a[152:155], v[92:95], v[84:87]
  s_waitcnt lgkmcnt(2)
  buffer_load_dwordx4 a[208:211], v1, s[16:19], s56 offen offset:0 sc1
  v_mfma_f32_16x16x32_bf16 v[64:67], a[156:159], v[96:99], v[64:67]
  ds_read_b128 v[88:91], v112 offset:48128
  v_mfma_f32_16x16x32_bf16 v[68:71], a[160:163], v[96:99], v[68:71]
  ds_read_b128 v[92:95], v112 offset:64512
  v_mfma_f32_16x16x32_bf16 v[72:75], a[164:167], v[96:99], v[72:75]
  v_mfma_f32_16x16x32_bf16 v[76:79], a[156:159], v[100:103], v[76:79]
  v_mfma_f32_16x16x32_bf16 v[80:83], a[160:163], v[100:103], v[80:83]
  buffer_load_dwordx4 a[212:215], v1, s[16:19], s56 offen offset:1024 sc1
  v_mfma_f32_16x16x32_bf16 v[84:87], a[164:167], v[100:103], v[84:87]
  s_waitcnt lgkmcnt(2)
  v_mfma_f32_16x16x32_bf16 v[64:67], a[168:171], v[104:107], v[64:67]
  s_add_u32 s25, s66, 0
  v_add_u32 v112, s25, v1
  s_add_u32 s25, s67, 0
  v_add_u32 v113, s25, v1
  s_waitcnt vmcnt(10)
  s_barrier
  ds_read_b128 v[56:59], v113 offset:0
  v_mfma_f32_16x16x32_bf16 v[68:71], a[172:175], v[104:107], v[68:71]
  buffer_load_dwordx4 v9, s[16:19], s63 offen offset:0 sc1 lds
  ds_read_b128 v[60:63], v112 offset:0
  v_mfma_f32_16x16x32_bf16 v[72:75], a[176:179], v[104:107], v[72:75]
  v_mfma_f32_16x16x32_bf16 v[76:79], a[168:171], v[108:111], v[76:79]
  v_mfma_f32_16x16x32_bf16 v[80:83], a[172:175], v[108:111], v[80:83]
  ds_read_b128 v[96:99], v113 offset:1024
  v_mfma_f32_16x16x32_bf16 v[84:87], a[176:179], v[108:111], v[84:87]
  s_waitcnt lgkmcnt(3)
  ds_read_b128 v[100:103], v112 offset:1024
  v_mfma_f32_16x16x32_bf16 v[64:67], a[180:183], v[88:91], v[64:67]
  buffer_load_dwordx4 v9, s[16:19], s63 offen offset:1024 sc1 lds
  v_mfma_f32_16x16x32_bf16 v[68:71], a[184:187], v[88:91], v[68:71]
  v_mfma_f32_16x16x32_bf16 v[72:75], a[188:191], v[88:91], v[72:75]
  ds_read_b128 v[104:107], v113 offset:2048
  v_mfma_f32_16x16x32_bf16 v[76:79], a[180:183], v[92:95], v[76:79]
  ds_read_b128 v[108:111], v112 offset:2048
  v_mfma_f32_16x16x32_bf16 v[80:83], a[184:187], v[92:95], v[80:83]
  s_lshl_b32 s20, s69, 1
  s_add_u32 s20, s20, 557568
  buffer_load_dword v123, v13, s[16:19], s20 offen sc1
  v_mfma_f32_16x16x32_bf16 v[84:87], a[188:191], v[92:95], v[84:87]
  s_waitcnt lgkmcnt(4)
  v_mfma_f32_16x16x32_bf16 v[48:51], v[144:147], v[56:59], 0
  ds_read_b128 v[88:91], v113 offset:3072
  v_max_f32 v64, 0, v64
  v_max_f32 v65, 0, v65
  v_max_f32 v66, 0, v66
  v_max_f32 v67, 0, v67
  v_mfma_f32_16x16x32_bf16 v[52:55], v[148:151], v[56:59], 0
  ds_read_b128 v[92:95], v112 offset:3072
  v_mul_f32 v64, v64, v68
  v_mul_f32 v65, v65, v69
  v_mul_f32 v66, v66, v70
  v_mul_f32 v67, v67, v71
  v_mfma_f32_16x16x32_bf16 v[40:43], v[144:147], v[60:63], 0
  v_cvt_pk_bf16_f32 v114, v64, v65
  v_cvt_pk_bf16_f32 v115, v66, v67
  v_max_f32 v76, 0, v76
  v_max_f32 v77, 0, v77
  v_max_f32 v78, 0, v78
  v_mfma_f32_16x16x32_bf16 v[44:47], v[148:151], v[60:63], 0
  s_waitcnt lgkmcnt(4)
  buffer_load_dwordx4 v9, s[16:19], s63 offen offset:2048 sc1 lds
  v_max_f32 v79, 0, v79
  v_mul_f32 v76, v76, v80
  v_mul_f32 v77, v77, v81
  v_mul_f32 v78, v78, v82
  v_mfma_f32_16x16x32_bf16 v[48:51], v[152:155], v[96:99], v[48:51]
  ds_read_b128 v[56:59], v113 offset:4096
  v_mul_f32 v79, v79, v83
  v_cvt_pk_bf16_f32 v116, v76, v77
  v_cvt_pk_bf16_f32 v117, v78, v79
  v_mfma_f32_16x16x32_bf16 v[52:55], v[156:159], v[96:99], v[52:55]
  buffer_load_dwordx4 a[216:219], v1, s[16:19], s56 offen offset:2048 sc1
  ds_read_b128 v[60:63], v112 offset:4096
  v_permlane16_swap_b32 v72, v84
  v_mfma_f32_16x16x32_bf16 v[40:43], v[152:155], v[100:103], v[40:43]
  v_permlane16_swap_b32 v73, v85
  v_permlane16_swap_b32 v74, v86
  v_mfma_f32_16x16x32_bf16 v[44:47], v[156:159], v[100:103], v[44:47]
  s_waitcnt lgkmcnt(4)
  v_permlane16_swap_b32 v75, v87
  v_permlane16_swap_b32 v114, v116
  v_mfma_f32_16x16x32_bf16 v[48:51], v[160:163], v[104:107], v[48:51]
  s_mov_b32 s15, 0
  buffer_load_dwordx4 a[220:223], v1, s[16:19], s56 offen offset:3072 sc1
  ds_read_b128 v[96:99], v113 offset:5120
  v_permlane16_swap_b32 v115, v117
  v_mfma_f32_16x16x32_bf16 v[52:55], v[164:167], v[104:107], v[52:55]
  s_add_u32 s56, s77, 36864
  buffer_store_dwordx4 v[114:117], v136, s[16:19], s15 offen
  ds_read_b128 v[100:103], v112 offset:5120
  v_max_f32 v72, 0, v72
  v_max_f32 v73, 0, v73
  v_max_f32 v74, 0, v74
  v_mfma_f32_16x16x32_bf16 v[40:43], v[160:163], v[108:111], v[40:43]
  v_max_f32 v75, 0, v75
  v_mul_f32 v72, v72, v84
  v_mul_f32 v73, v73, v85
  v_mul_f32 v74, v74, v86
  v_mul_f32 v75, v75, v87
  v_mfma_f32_16x16x32_bf16 v[44:47], v[164:167], v[108:111], v[44:47]
  v_cvt_pk_bf16_f32 v118, v72, v73
  v_cvt_pk_bf16_f32 v119, v74, v75
  v_mov_b32 v120, v118
  v_mov_b32 v121, v119
  s_nop 0
  s_waitcnt lgkmcnt(4)
  v_mfma_f32_16x16x32_bf16 v[48:51], v[168:171], v[88:91], v[48:51]
  buffer_load_dwordx4 a[224:227], v1, s[16:19], s56 offen offset:0 sc1
  ds_read_b128 v[104:107], v113 offset:6144
  v_permlane32_swap_b32 v118, v120
  v_mfma_f32_16x16x32_bf16 v[52:55], v[172:175], v[88:91], v[52:55]
  v_permlane32_swap_b32 v119, v121
  buffer_store_dwordx4 v[118:121], v138, s[16:19], s15 offen
  ds_read_b128 v[108:111], v112 offset:6144
  v_max3_u32 v124, v140, v141, v142
  v_mfma_f32_16x16x32_bf16 v[40:43], v[168:171], v[92:95], v[40:43]
  s_add_u32 s22, s23, 557824
  v_max_u32 v124, v124, v143
  v_cmp_eq_u32 vcc, -1, v124
  s_cbranch_vccnz LF_s5r_25
LF_s5b_27:
  v_mfma_f32_16x16x32_bf16 v[44:47], v[172:175], v[92:95], v[44:47]
  s_waitcnt lgkmcnt(4)
  v_add_f32 v140, v140, v141
  v_add_f32 v142, v142, v143
  v_mfma_f32_16x16x32_bf16 v[48:51], v[176:179], v[56:59], v[48:51]
  ds_read_b128 v[88:91], v113 offset:7168
  v_add_f32 v140, v140, v142
  v_mfma_f32_16x16x32_bf16 v[52:55], v[180:183], v[56:59], v[52:55]
  v_mov_b32 v141, v140
  s_nop 0
  ds_read_b128 v[92:95], v112 offset:7168
  v_mfma_f32_16x16x32_bf16 v[40:43], v[176:179], v[60:63], v[40:43]
  v_permlane32_swap_b32 v140, v141
  v_mfma_f32_16x16x32_bf16 v[44:47], v[180:183], v[60:63], v[44:47]
  s_waitcnt lgkmcnt(4)
  buffer_load_dwordx4 a[228:231], v1, s[16:19], s56 offen offset:1024 sc1
  v_add_f32 v140, v140, v141
  v_mfma_f32_16x16x32_bf16 v[48:51], v[184:187], v[96:99], v[48:51]
  s_waitcnt vmcnt(16)
  s_barrier
  ds_read_b128 v[56:59], v113 offset:32768
  v_mfma_f32_16x16x32_bf16 v[52:55], v[188:191], v[96:99], v[52:55]
  s_waitcnt vmcnt(7)
  v_cmp_ne_u32 vcc, s13, v123
  s_cbranch_vccnz LF_hfr_43
LF_hfb_45:
  ds_read_b128 v[60:63], v112 offset:32768
  v_mfma_f32_16x16x32_bf16 v[40:43], v[184:187], v[100:103], v[40:43]
  s_add_u32 m0, s54, 65536
  s_add_u32 s63, s52, 196608
  buffer_load_dwordx4 v9, s[16:19], s63 offen offset:0 sc1 lds
  v_mfma_f32_16x16x32_bf16 v[44:47], v[188:191], v[100:103], v[44:47]
  v_mov_b32 v141, v140
  s_nop 0
  s_waitcnt lgkmcnt(4)
  v_mfma_f32_16x16x32_bf16 v[48:51], v[192:195], v[104:107], v[48:51]
  ds_read_b128 v[96:99], v113 offset:33792
  v_mfma_f32_16x16x32_bf16 v[52:55], v[196:199], v[104:107], v[52:55]
  ds_read_b128 v[100:103], v112 offset:33792
  v_mfma_f32_16x16x32_bf16 v[40:43], v[192:195], v[108:111], v[40:43]
  buffer_load_dwordx4 a[232:235], v1, s[16:19], s56 offen offset:2048 sc1
  v_mfma_f32_16x16x32_bf16 v[44:47], v[196:199], v[108:111], v[44:47]
  s_waitcnt lgkmcnt(4)
  v_permlane16_swap_b32 v140, v141
  v_mfma_f32_16x16x32_bf16 v[48:51], v[200:203], v[88:91], v[48:51]
  ds_read_b128 v[104:107], v113 offset:34816
  v_add_f32 v140, v140, v141
  v_mfma_f32_16x16x32_bf16 v[52:55], v[204:207], v[88:91], v[52:55]
  ds_read_b128 v[108:111], v112 offset:34816
  v_mul_f32 v140, 0x3b000000, v140
  v_mfma_f32_16x16x32_bf16 v[40:43], v[200:203], v[92:95], v[40:43]
  buffer_load_dwordx4 a[236:239], v1, s[16:19], s56 offen offset:3072 sc1
  s_add_u32 s56, s77, 40960
  v_add_f32 v140, 0x3727c5ac, v140
  v_mfma_f32_16x16x32_bf16 v[44:47], v[204:207], v[92:95], v[44:47]
  s_add_u32 s3, s65, 137216
  s_waitcnt lgkmcnt(4)
  v_rcp_f32 v15, v140
  v_mfma_f32_16x16x32_bf16 v[48:51], v[208:211], v[56:59], v[48:51]
  ds_read_b128 v[88:91], v113 offset:35840
  v_add_u32 v114, s3, v1
  v_mfma_f32_16x16x32_bf16 v[52:55], v[212:215], v[56:59], v[52:55]
  s_xor_b32 s3, s65, 16384
  buffer_load_dwordx4 a[240:243], v1, s[16:19], s56 offen offset:0 sc1
  ds_read_b128 v[92:95], v112 offset:35840
  v_mfma_f32_16x16x32_bf16 v[40:43], v[208:211], v[60:63], v[40:43]
  s_add_u32 s3, s3, 137216
  v_add_u32 v115, s3, v1
  v_lshlrev_b32 v80, 16, v32
  v_mfma_f32_16x16x32_bf16 v[44:47], v[212:215], v[60:63], v[44:47]
  s_waitcnt lgkmcnt(4)
  v_and_b32 v81, 0xffff0000, v32
  v_lshlrev_b32 v82, 16, v33
  v_mfma_f32_16x16x32_bf16 v[48:51], v[216:219], v[96:99], v[48:51]
  ds_read_b128 v[56:59], v113 offset:36864
  v_and_b32 v83, 0xffff0000, v33
  v_mfma_f32_16x16x32_bf16 v[52:55], v[220:223], v[96:99], v[52:55]
  buffer_load_dwordx4 a[244:247], v1, s[16:19], s56 offen offset:1024 sc1
  ds_read_b128 v[60:63], v112 offset:36864
  v_mfma_f32_16x16x32_bf16 v[40:43], v[216:219], v[100:103], v[40:43]
  v_lshlrev_b32 v84, 16, v34
  v_and_b32 v85, 0xffff0000, v34
  v_mfma_f32_16x16x32_bf16 v[44:47], v[220:223], v[100:103], v[44:47]
  s_waitcnt lgkmcnt(4)
  v_lshlrev_b32 v86, 16, v35
  v_and_b32 v87, 0xffff0000, v35
  v_mfma_f32_16x16x32_bf16 v[48:51], v[224:227], v[104:107], v[48:51]
  s_add_u32 s24, s73, 65536
  ds_read_b128 v[96:99], v113 offset:37888
  v_mfma_f32_16x16x32_bf16 v[52:55], v[228:231], v[104:107], v[52:55]
  buffer_load_dwordx4 a[248:251], v1, s[16:19], s56 offen offset:2048 sc1
  ds_read_b128 v[100:103], v112 offset:37888
  v_mfma_f32_16x16x32_bf16 v[40:43], v[224:227], v[108:111], v[40:43]
  buffer_load_dwordx4 v[140:143], v7, s[16:19], s24 offen sc1
  v_mfma_f32_16x16x32_bf16 v[44:47], v[228:231], v[108:111], v[44:47]
  s_waitcnt lgkmcnt(4)
  buffer_load_dwordx4 a[252:255], v1, s[16:19], s56 offen offset:3072 sc1
  v_mfma_f32_16x16x32_bf16 v[48:51], v[232:235], v[88:91], v[48:51]
  s_waitcnt vmcnt(9)
  ds_read_b128 v[104:107], v113 offset:38912
  v_mfma_f32_16x16x32_bf16 v[52:55], v[236:239], v[88:91], v[52:55]
  buffer_store_dword v14, v2, s[16:19], s22 offen
  ds_read_b128 v[108:111], v112 offset:38912
  v_mfma_f32_16x16x32_bf16 v[40:43], v[232:235], v[92:95], v[40:43]
  v_mfma_f32_16x16x32_bf16 v[44:47], v[236:239], v[92:95], v[44:47]
  s_waitcnt lgkmcnt(4)
  v_mfma_f32_16x16x32_bf16 v[48:51], v[240:243], v[56:59], v[48:51]
  buffer_load_dwordx4 v9, s[16:19], s63 offen offset:1024 sc1 lds
  ds_read_b128 v[88:91], v113 offset:39936
  v_mfma_f32_16x16x32_bf16 v[52:55], v[244:247], v[56:59], v[52:55]
  ds_read_b128 v[92:95], v112 offset:39936
  v_mfma_f32_16x16x32_bf16 v[40:43], v[240:243], v[60:63], v[40:43]
  v_mfma_f32_16x16x32_bf16 v[44:47], v[244:247], v[60:63], v[44:47]
  s_waitcnt lgkmcnt(4)
  v_mfma_f32_16x16x32_bf16 v[48:51], v[248:251], v[96:99], v[48:51]
  s_add_u32 s25, s66, 131072
  v_add_u32 v112, s25, v1
  s_add_u32 s25, s67, 131072
  v_add_u32 v113, s25, v1
  s_barrier
  ds_read_b128 v[56:59], v113 offset:0
  v_mfma_f32_16x16x32_bf16 v[52:55], v[252:255], v[96:99], v[52:55]
  buffer_load_dwordx4 v9, s[16:19], s63 offen offset:2048 sc1 lds
  ds_read_b128 v[60:63], v112 offset:0
  buffer_load_dwordx4 v9, s[16:19], s63 offen offset:3072 sc1 lds
  v_mfma_f32_16x16x32_bf16 v[40:43], v[248:251], v[100:103], v[40:43]
  s_add_u32 m0, s54, 98304
  s_add_u32 s63, s52, 204800
  v_mfma_f32_16x16x32_bf16 v[44:47], v[252:255], v[100:103], v[44:47]
  s_waitcnt lgkmcnt(4)
  v_mfma_f32_16x16x32_bf16 v[48:51], a[192:195], v[104:107], v[48:51]
  ds_read_b128 v[96:99], v113 offset:1024
  v_mfma_f32_16x16x32_bf16 v[52:55], a[196:199], v[104:107], v[52:55]
  ds_read_b128 v[100:103], v112 offset:1024
  buffer_load_dwordx4 v9, s[16:19], s63 offen offset:0 sc1 lds
  buffer_load_dwordx4 v9, s[16:19], s63 offen offset:1024 sc1 lds
  buffer_load_dwordx4 v9, s[16:19], s63 offen offset:2048 sc1 lds
  buffer_load_dwordx4 v9, s[16:19], s63 offen offset:3072 sc1 lds
  v_mfma_f32_16x16x32_bf16 v[40:43], a[192:195], v[108:111], v[40:43]
  s_add_u32 m0, s55, 0
  s_add_u32 s63, s53, 212992
  v_mfma_f32_16x16x32_bf16 v[44:47], a[196:199], v[108:111], v[44:47]
  s_waitcnt lgkmcnt(4)
  v_mfma_f32_16x16x32_bf16 v[48:51], a[200:203], v[88:91], v[48:51]
  s_waitcnt vmcnt(16)
  ds_read_b128 v[104:107], v113 offset:2048
  v_mfma_f32_16x16x32_bf16 v[52:55], a[204:207], v[88:91], v[52:55]
  s_lshl_b32 s20, s69, 1
  s_add_u32 s20, s20, 557824
  ds_read_b128 v[108:111], v112 offset:2048
  v_mfma_f32_16x16x32_bf16 v[40:43], a[200:203], v[92:95], v[40:43]
  buffer_load_dword v123, v13, s[16:19], s20 offen sc1
  v_mfma_f32_16x16x32_bf16 v[44:47], a[204:207], v[92:95], v[44:47]
  s_waitcnt lgkmcnt(4)
  v_mfma_f32_16x16x32_bf16 v[48:51], a[208:211], v[56:59], v[48:51]
  s_waitcnt vmcnt(14)
  ds_read_b128 v[88:91], v113 offset:3072
  v_mfma_f32_16x16x32_bf16 v[52:55], a[212:215], v[56:59], v[52:55]
  ds_read_b128 v[92:95], v112 offset:3072
  v_mfma_f32_16x16x32_bf16 v[40:43], a[208:211], v[60:63], v[40:43]
  v_mfma_f32_16x16x32_bf16 v[44:47], a[212:215], v[60:63], v[44:47]
  s_waitcnt lgkmcnt(4)
  v_mfma_f32_16x16x32_bf16 v[48:51], a[216:219], v[96:99], v[48:51]
  s_waitcnt vmcnt(12)
  ds_read_b128 v[56:59], v113 offset:4096
  v_mfma_f32_16x16x32_bf16 v[52:55], a[220:223], v[96:99], v[52:55]
  ds_read_b128 v[60:63], v112 offset:4096
  v_mfma_f32_16x16x32_bf16 v[40:43], a[216:219], v[100:103], v[40:43]
  buffer_load_dwordx4 v9, s[16:19], s63 offen offset:0 sc1 lds
  v_mfma_f32_16x16x32_bf16 v[44:47], a[220:223], v[100:103], v[44:47]
  s_waitcnt lgkmcnt(4)
  v_mfma_f32_16x16x32_bf16 v[48:51], a[224:227], v[104:107], v[48:51]
  s_waitcnt vmcnt(10)
  ds_read_b128 v[96:99], v113 offset:5120
  v_mfma_f32_16x16x32_bf16 v[52:55], a[228:231], v[104:107], v[52:55]
  ds_read_b128 v[100:103], v112 offset:5120
  v_mfma_f32_16x16x32_bf16 v[40:43], a[224:227], v[108:111], v[40:43]
  v_mfma_f32_16x16x32_bf16 v[44:47], a[228:231], v[108:111], v[44:47]
  s_waitcnt lgkmcnt(4)
  v_mfma_f32_16x16x32_bf16 v[48:51], a[232:235], v[88:91], v[48:51]
  s_lshl_b32 s25, s11, 14
  s_add_u32 s25, s25, 65536
  s_waitcnt vmcnt(2)
  v_add_u32 v112, s25, v1
  s_barrier
  ds_read_b128 v[104:107], v112 offset:0
  v_mfma_f32_16x16x32_bf16 v[52:55], a[236:239], v[88:91], v[52:55]
  s_waitcnt vmcnt(1)
  v_cmp_ne_u32 vcc, s13, v123
  s_cbranch_vccnz LF_hfr_46
LF_hfb_48:
  v_mfma_f32_16x16x32_bf16 v[40:43], a[232:235], v[92:95], v[40:43]
  buffer_load_dwordx4 v9, s[16:19], s63 offen offset:1024 sc1 lds
  ds_read_b128 v[108:111], v112 offset:1024
  v_mfma_f32_16x16x32_bf16 v[44:47], a[236:239], v[92:95], v[44:47]
  s_waitcnt lgkmcnt(4)
  v_mfma_f32_16x16x32_bf16 v[48:51], a[240:243], v[56:59], v[48:51]
  ds_read_b128 v[88:91], v112 offset:2048
  v_mfma_f32_16x16x32_bf16 v[52:55], a[244:247], v[56:59], v[52:55]
  buffer_load_dwordx4 v9, s[16:19], s63 offen offset:2048 sc1 lds
  s_add_u32 m0, s54, 73728
  s_add_u32 s63, s52, 0
  v_mfma_f32_16x16x32_bf16 v[40:43], a[240:243], v[60:63], v[40:43]
  ds_read_b128 v[92:95], v112 offset:3072
  v_mfma_f32_16x16x32_bf16 v[44:47], a[244:247], v[60:63], v[44:47]
  s_waitcnt lgkmcnt(4)
  v_mfma_f32_16x16x32_bf16 v[48:51], a[248:251], v[96:99], v[48:51]
  ds_read_b128 v[56:59], v112 offset:4096
  v_mfma_f32_16x16x32_bf16 v[52:55], a[252:255], v[96:99], v[52:55]
  v_mfma_f32_16x16x32_bf16 v[40:43], a[248:251], v[100:103], v[40:43]
  buffer_load_dwordx4 v135, s[16:19], s63 offen offset:0 sc1 lds
  ds_read_b128 v[60:63], v112 offset:5120
  v_mfma_f32_16x16x32_bf16 v[44:47], a[252:255], v[100:103], v[44:47]
  s_waitcnt lgkmcnt(5)
  v_mfma_f32_16x16x32_bf16 v[64:67], v[144:147], v[104:107], 0
  ds_write_b128 v114, v[48:51]
  s_nop 0
  ds_write_b128 v114, v[52:55] offset:1024
  ds_read_b128 v[96:99], v112 offset:6144
  v_fmac_f32 v16, v15, v40
  v_fmac_f32 v17, v15, v41
  v_mfma_f32_16x16x32_bf16 v[68:71], v[148:151], v[104:107], 0
  s_waitcnt lgkmcnt(7)
  v_fmac_f32 v18, v15, v42
  v_fmac_f32 v19, v15, v43
  v_fmac_f32 v20, v15, v44
  v_fmac_f32 v21, v15, v45
  v_fmac_f32 v22, v15, v46
  v_mfma_f32_16x16x32_bf16 v[64:67], v[152:155], v[108:111], v[64:67]
  buffer_load_dwordx4 v135, s[16:19], s63 offen offset:1024 sc1 lds
  ds_read_b128 v[100:103], v112 offset:7168
  v_fmac_f32 v23, v15, v47
  v_mfma_f32_16x16x32_bf16 v[68:71], v[156:159], v[108:111], v[68:71]
  s_waitcnt lgkmcnt(7)
  v_mfma_f32_16x16x32_bf16 v[64:67], v[160:163], v[88:91], v[64:67]
  s_waitcnt lgkmcnt(2)
  s_barrier
  ds_read_b128 v[48:51], v115
  ds_read_b128 v[52:55], v115 offset:1024
  ds_read_b128 v[104:107], v112 offset:32768
  v_mfma_f32_16x16x32_bf16 v[68:71], v[164:167], v[88:91], v[68:71]
  buffer_load_dwordx4 v135, s[16:19], s63 offen offset:2048 sc1 lds
  v_mfma_f32_16x16x32_bf16 v[64:67], v[168:171], v[92:95], v[64:67]
  ds_read_b128 v[108:111], v112 offset:33792
  v_mfma_f32_16x16x32_bf16 v[68:71], v[172:175], v[92:95], v[68:71]
  v_mfma_f32_16x16x32_bf16 v[64:67], v[176:179], v[56:59], v[64:67]
  ds_read_b128 v[88:91], v112 offset:34816
  s_waitcnt lgkmcnt(4)
  v_fmac_f32 v16, v15, v48
  v_fmac_f32 v17, v15, v49
  v_fmac_f32 v18, v15, v50
  v_fmac_f32 v19, v15, v51
  v_mfma_f32_16x16x32_bf16 v[68:71], v[180:183], v[56:59], v[68:71]
  buffer_load_dwordx4 v135, s[16:19], s63 offen offset:3072 sc1 lds
  s_add_u32 m0, s54, 106496
  s_add_u32 s63, s52, 8192
  s_waitcnt lgkmcnt(3)
  v_fmac_f32 v20, v15, v52
  v_fmac_f32 v21, v15, v53
  v_fmac_f32 v22, v15, v54
  v_mfma_f32_16x16x32_bf16 v[64:67], v[184:187], v[60:63], v[64:67]
  ds_read_b128 v[92:95], v112 offset:35840
  v_fmac_f32 v23, v15, v55
  v_add_f32 v40, v16, v17
  v_mul_f32 v42, v16, v80
  v_mul_f32 v41, v16, v16
  v_mfma_f32_16x16x32_bf16 v[68:71], v[188:191], v[60:63], v[68:71]
  v_add_f32 v43, v80, v81
  v_fmac_f32 v41, v17, v17
  v_fmac_f32 v42, v17, v81
  v_add_f32 v40, v40, v18
  v_fmac_f32 v42, v18, v82
  v_mfma_f32_16x16x32_bf16 v[64:67], v[192:195], v[96:99], v[64:67]
  buffer_load_dwordx4 v135, s[16:19], s63 offen offset:0 sc1 lds
  ds_read_b128 v[56:59], v112 offset:36864
  v_fmac_f32 v41, v18, v18
  v_add_f32 v43, v43, v82
  v_add_f32 v40, v40, v19
  v_mfma_f32_16x16x32_bf16 v[68:71], v[196:199], v[96:99], v[68:71]
  v_fmac_f32 v42, v19, v83
  v_fmac_f32 v41, v19, v19
  v_add_f32 v43, v43, v83
  v_add_f32 v40, v40, v20
  v_fmac_f32 v42, v20, v84
  v_mfma_f32_16x16x32_bf16 v[64:67], v[200:203], v[100:103], v[64:67]
  buffer_load_dwordx4 v135, s[16:19], s63 offen offset:1024 sc1 lds
  ds_read_b128 v[60:63], v112 offset:37888
  v_fmac_f32 v41, v20, v20
  v_add_f32 v43, v43, v84
  v_add_f32 v40, v40, v21
  v_mfma_f32_16x16x32_bf16 v[68:71], v[204:207], v[100:103], v[68:71]
  s_waitcnt lgkmcnt(5)
  v_fmac_f32 v42, v21, v85
  v_fmac_f32 v41, v21, v21
  v_add_f32 v43, v43, v85
  v_add_f32 v40, v40, v22
  v_fmac_f32 v42, v22, v86
  v_mfma_f32_16x16x32_bf16 v[64:67], v[208:211], v[104:107], v[64:67]
  ds_read_b128 v[96:99], v112 offset:38912
  v_fmac_f32 v41, v22, v22
  v_add_f32 v43, v43, v86
  v_add_f32 v40, v40, v23
  v_fmac_f32 v42, v23, v87
  v_mfma_f32_16x16x32_bf16 v[68:71], v[212:215], v[104:107], v[68:71]
  s_waitcnt lgkmcnt(5)
  buffer_load_dwordx4 v135, s[16:19], s63 offen offset:2048 sc1 lds
  v_fmac_f32 v41, v23, v23
  v_add_f32 v43, v43, v87
  v_permlane32_swap_b32 v40, v42
  v_mfma_f32_16x16x32_bf16 v[64:67], v[216:219], v[108:111], v[64:67]
  s_add_u32 s3, s70, 524288
  ds_read_b128 v[100:103], v112 offset:39936
  v_permlane32_swap_b32 v41, v43
  v_add_f32 v40, v40, v42
  v_add_f32 v41, v41, v43
  v_mfma_f32_16x16x32_bf16 v[68:71], v[220:223], v[108:111], v[68:71]
  s_waitcnt lgkmcnt(5)
  v_permlane16_swap_b32 v40, v41
  v_add_f32 v40, v40, v41
  buffer_store_dword v40, v4, s[16:19], s3 offen
  v_mfma_f32_16x16x32_bf16 v[64:67], v[224:227], v[88:91], v[64:67]
  s_lshl_b32 s25, s11, 14
  s_add_u32 s25, s25, 0
  s_waitcnt vmcnt(8)
  v_add_u32 v112, s25, v1
  s_barrier
  ds_read_b128 v[104:107], v112 offset:0
  v_mfma_f32_16x16x32_bf16 v[68:71], v[228:231], v[88:91], v[68:71]
  buffer_load_dwordx4 v135, s[16:19], s63 offen offset:3072 sc1 lds
  s_add_u32 m0, s55, 8192
  s_add_u32 s63, s53, 16384
  s_waitcnt lgkmcnt(5)
  v_mfma_f32_16x16x32_bf16 v[64:67], v[232:235], v[92:95], v[64:67]
  ds_read_b128 v[108:111], v112 offset:1024
  v_max3_u32 v124, v140, v141, v142
  v_mfma_f32_16x16x32_bf16 v[68:71], v[236:239], v[92:95], v[68:71]
  s_waitcnt lgkmcnt(5)
  buffer_load_dwordx4 v135, s[16:19], s63 offen offset:0 sc1 lds
  v_max_u32 v124, v124, v143
  v_mfma_f32_16x16x32_bf16 v[64:67], v[240:243], v[56:59], v[64:67]
  v_cmp_eq_u32 vcc, -1, v124
  s_cbranch_vccnz LF_s5r_28
LF_s5b_30:
  ds_read_b128 v[88:91], v112 offset:2048
  v_mfma_f32_16x16x32_bf16 v[68:71], v[244:247], v[56:59], v[68:71]
  s_waitcnt lgkmcnt(5)
  v_add_f32 v140, v140, v141
  v_add_f32 v142, v142, v143
  v_mfma_f32_16x16x32_bf16 v[64:67], v[248:251], v[60:63], v[64:67]
  ds_read_b128 v[92:95], v112 offset:3072
  v_add_f32 v140, v140, v142
  v_mfma_f32_16x16x32_bf16 v[68:71], v[252:255], v[60:63], v[68:71]
  v_mov_b32 v141, v140
  s_nop 0
  s_waitcnt lgkmcnt(5)
  v_mfma_f32_16x16x32_bf16 v[64:67], a[192:195], v[96:99], v[64:67]
  buffer_load_dwordx4 v135, s[16:19], s63 offen offset:1024 sc1 lds
  ds_read_b128 v[56:59], v112 offset:4096
  v_mfma_f32_16x16x32_bf16 v[68:71], a[196:199], v[96:99], v[68:71]
  s_waitcnt lgkmcnt(5)
  v_permlane32_swap_b32 v140, v141
  v_mfma_f32_16x16x32_bf16 v[64:67], a[200:203], v[100:103], v[64:67]
  ds_read_b128 v[60:63], v112 offset:5120
  v_add_f32 v140, v140, v141
  v_mfma_f32_16x16x32_bf16 v[68:71], a[204:207], v[100:103], v[68:71]
  v_mov_b32 v141, v140
  s_nop 0
  s_waitcnt lgkmcnt(5)
  v_mfma_f32_16x16x32_bf16 v[64:67], a[208:211], v[104:107], v[64:67]
  s_lshl_b32 s25, s11, 14
  s_add_u32 s25, s25, 73728
  s_waitcnt vmcnt(7)
  v_add_u32 v112, s25, v1
  s_barrier
  ds_read_b128 v[96:99], v112 offset:0
  v_mfma_f32_16x16x32_bf16 v[68:71], a[212:215], v[104:107], v[68:71]
  s_waitcnt lgkmcnt(5)
  buffer_load_dwordx4 v135, s[16:19], s63 offen offset:2048 sc1 lds
  v_mfma_f32_16x16x32_bf16 v[64:67], a[216:219], v[108:111], v[64:67]
  ds_read_b128 v[100:103], v112 offset:1024
  v_mfma_f32_16x16x32_bf16 v[68:71], a[220:223], v[108:111], v[68:71]
  s_waitcnt lgkmcnt(5)
  v_permlane16_swap_b32 v140, v141
  v_mfma_f32_16x16x32_bf16 v[64:67], a[224:227], v[88:91], v[64:67]
  ds_read_b128 v[104:107], v112 offset:2048
  v_add_f32 v140, v140, v141
  v_mfma_f32_16x16x32_bf16 v[68:71], a[228:231], v[88:91], v[68:71]
  s_waitcnt lgkmcnt(5)
  v_mul_f32 v140, 0x3b000000, v140
  v_add_f32 v140, 0x3727c5ac, v140
  v_mfma_f32_16x16x32_bf16 v[64:67], a[232:235], v[92:95], v[64:67]
  s_add_u32 s3, s65, 6144
  ds_read_b128 v[108:111], v112 offset:3072
  v_rcp_f32 v15, v140
  v_mfma_f32_16x16x32_bf16 v[68:71], a[236:239], v[92:95], v[68:71]
  v_add_u32 v114, s3, v1
  s_xor_b32 s3, s65, 16384
  s_add_u32 s3, s3, 6144
  s_waitcnt lgkmcnt(5)
  v_mfma_f32_16x16x32_bf16 v[64:67], a[240:243], v[56:59], v[64:67]
  s_add_u32 s21, s72, 524288
  ds_read_b128 v[88:91], v112 offset:4096
  v_add_u32 v115, s3, v1
  v_mfma_f32_16x16x32_bf16 v[68:71], a[244:247], v[56:59], v[68:71]
  s_waitcnt lgkmcnt(5)
  buffer_load_dwordx4 v[40:43], v5, s[16:19], s21 offen offset:0 sc1
  buffer_load_dwordx4 v[44:47], v5, s[16:19], s21 offen offset:256 sc1
  v_mfma_f32_16x16x32_bf16 v[64:67], a[248:251], v[60:63], v[64:67]
  buffer_load_dwordx4 v[48:51], v5, s[16:19], s21 offen offset:512 sc1
  ds_read_b128 v[92:95], v112 offset:5120
  v_mfma_f32_16x16x32_bf16 v[68:71], a[252:255], v[60:63], v[68:71]
  s_waitcnt lgkmcnt(5)
  buffer_load_dwordx4 v[52:55], v5, s[16:19], s21 offen offset:768 sc1
  v_mfma_f32_16x16x32_bf16 v[72:75], v[144:147], v[96:99], 0
  ds_read_b128 v[56:59], v112 offset:6144
  v_mfma_f32_16x16x32_bf16 v[76:79], v[148:151], v[96:99], 0
  s_waitcnt lgkmcnt(5)
  v_mfma_f32_16x16x32_bf16 v[72:75], v[152:155], v[100:103], v[72:75]
  ds_read_b128 v[60:63], v112 offset:7168
  v_mfma_f32_16x16x32_bf16 v[76:79], v[156:159], v[100:103], v[76:79]
  s_waitcnt lgkmcnt(5)
  v_mfma_f32_16x16x32_bf16 v[72:75], v[160:163], v[104:107], v[72:75]
  s_waitcnt vmcnt(7)
  s_barrier
  ds_read_b128 v[96:99], v112 offset:32768
  v_mfma_f32_16x16x32_bf16 v[76:79], v[164:167], v[104:107], v[76:79]
  s_waitcnt lgkmcnt(5)
  v_mfma_f32_16x16x32_bf16 v[72:75], v[168:171], v[108:111], v[72:75]
  ds_read_b128 v[100:103], v112 offset:33792
  v_mfma_f32_16x16x32_bf16 v[76:79], v[172:175], v[108:111], v[76:79]
  s_waitcnt lgkmcnt(5)
  v_mfma_f32_16x16x32_bf16 v[72:75], v[176:179], v[88:91], v[72:75]
  ds_read_b128 v[104:107], v112 offset:34816
  v_mfma_f32_16x16x32_bf16 v[76:79], v[180:183], v[88:91], v[76:79]
  s_waitcnt lgkmcnt(5)
  v_mfma_f32_16x16x32_bf16 v[72:75], v[184:187], v[92:95], v[72:75]
  ds_read_b128 v[108:111], v112 offset:35840
  v_mfma_f32_16x16x32_bf16 v[76:79], v[188:191], v[92:95], v[76:79]
  s_waitcnt lgkmcnt(5)
  v_mfma_f32_16x16x32_bf16 v[72:75], v[192:195], v[56:59], v[72:75]
  ds_read_b128 v[88:91], v112 offset:36864
  v_mfma_f32_16x16x32_bf16 v[76:79], v[196:199], v[56:59], v[76:79]
  s_waitcnt lgkmcnt(5)
  v_mfma_f32_16x16x32_bf16 v[72:75], v[200:203], v[60:63], v[72:75]
  ds_read_b128 v[92:95], v112 offset:37888
  v_mfma_f32_16x16x32_bf16 v[76:79], v[204:207], v[60:63], v[76:79]
  s_waitcnt lgkmcnt(5)
  v_mfma_f32_16x16x32_bf16 v[72:75], v[208:211], v[96:99], v[72:75]
  ds_read_b128 v[56:59], v112 offset:38912
  v_mfma_f32_16x16x32_bf16 v[76:79], v[212:215], v[96:99], v[76:79]
  s_waitcnt lgkmcnt(5)
  v_mfma_f32_16x16x32_bf16 v[72:75], v[216:219], v[100:103], v[72:75]
  ds_read_b128 v[60:63], v112 offset:39936
  v_mfma_f32_16x16x32_bf16 v[76:79], v[220:223], v[100:103], v[76:79]
  s_waitcnt lgkmcnt(5)
  v_mfma_f32_16x16x32_bf16 v[72:75], v[224:227], v[104:107], v[72:75]
  s_lshl_b32 s25, s11, 14
  s_add_u32 s25, s25, 8192
  s_waitcnt vmcnt(4)
  v_add_u32 v112, s25, v1
  s_barrier
  ds_read_b128 v[96:99], v112 offset:0
  v_mfma_f32_16x16x32_bf16 v[76:79], v[228:231], v[104:107], v[76:79]
  s_waitcnt vmcnt(0)
  v_max3_u32 v122, v40, v41, v42
  v_max3_u32 v122, v122, v43, v44
  v_max3_u32 v122, v122, v45, v46
  v_max3_u32 v122, v122, v47, v48
  v_max3_u32 v122, v122, v49, v50
  v_max3_u32 v122, v122, v51, v52
  v_max3_u32 v122, v122, v53, v54
  s_waitcnt lgkmcnt(5)
  v_mfma_f32_16x16x32_bf16 v[72:75], v[232:235], v[108:111], v[72:75]
  v_max_u32 v122, v122, v55
  v_cmp_eq_u32 vcc, -1, v122
  s_cbranch_vccnz LF_grr_31
LF_grb_33:
  v_add_f32 v40, v40, v44
  v_add_f32 v48, v48, v52
  v_add_f32 v41, v41, v45
  v_add_f32 v49, v49, v53
  ds_read_b128 v[100:103], v112 offset:1024
  v_mfma_f32_16x16x32_bf16 v[76:79], v[236:239], v[108:111], v[76:79]
  v_add_f32 v42, v42, v46
  v_add_f32 v50, v50, v54
  v_add_f32 v43, v43, v47
  v_add_f32 v51, v51, v55
  v_add_f32 v40, v40, v48
  v_add_f32 v42, v42, v50
  v_add_f32 v41, v41, v49
  v_add_f32 v43, v43, v51
  s_waitcnt lgkmcnt(5)
  v_mfma_f32_16x16x32_bf16 v[72:75], v[240:243], v[88:91], v[72:75]
  ds_read_b128 v[104:107], v112 offset:2048
  v_permlane32_swap_b32 v40, v42
  v_permlane32_swap_b32 v41, v43
  v_add_f32 v40, v40, v42
  v_add_f32 v41, v41, v43
  v_mfma_f32_16x16x32_bf16 v[76:79], v[244:247], v[88:91], v[76:79]
  s_waitcnt lgkmcnt(5)
  v_permlane16_swap_b32 v40, v41
  v_add_f32 v40, v40, v41
  v_mov_b32 v41, v40
  s_nop 1
  v_permlane16_swap_b32 v40, v41
  v_mov_b32 v42, v40
  v_mov_b32 v43, v41
  v_mfma_f32_16x16x32_bf16 v[72:75], v[248:251], v[92:95], v[72:75]
  ds_read_b128 v[108:111], v112 offset:3072
  v_permlane32_swap_b32 v40, v42
  v_permlane32_swap_b32 v41, v43
  v_mul_f32 v40, 0x3b000000, v40
  v_mul_f32 v41, 0x3b000000, v41
  v_fma_f32 v41, -v40, v40, v41
  v_mfma_f32_16x16x32_bf16 v[76:79], v[252:255], v[92:95], v[76:79]
  v_max_f32 v41, 0, v41
  v_add_f32 v41, 0x3727c5ac, v41
  v_rsq_f32 v41, v41
  v_fma_f32 v42, -v40, v43, v42
  v_mul_f32 v42, 0x3b000000, v42
  v_fma_f32 v42, v41, v42, v40
  v_mul_f32 v40, v40, v41
  v_fma_f32 v44, v16, v41, -v40
  s_waitcnt lgkmcnt(5)
  v_mfma_f32_16x16x32_bf16 v[72:75], a[192:195], v[56:59], v[72:75]
  ds_read_b128 v[88:91], v112 offset:4096
  v_fma_f32 v45, v17, v41, -v40
  v_fma_f32 v46, v18, v41, -v40
  v_fma_f32 v47, v19, v41, -v40
  v_fma_f32 v48, v20, v41, -v40
  v_fma_f32 v49, v21, v41, -v40
  v_fma_f32 v50, v22, v41, -v40
  v_fma_f32 v51, v23, v41, -v40
  v_mfma_f32_16x16x32_bf16 v[76:79], a[196:199], v[56:59], v[76:79]
  v_fmac_f32 v16, v44, v80
  v_fmac_f32 v17, v45, v81
  v_fmac_f32 v18, v46, v82
  v_fmac_f32 v19, v47, v83
  v_fmac_f32 v20, v48, v84
  v_fmac_f32 v21, v49, v85
  v_fmac_f32 v22, v50, v86
  v_fmac_f32 v23, v51, v87
  s_waitcnt lgkmcnt(5)
  v_mfma_f32_16x16x32_bf16 v[72:75], a[200:203], v[60:63], v[72:75]
  ds_read_b128 v[92:95], v112 offset:5120
  v_sub_f32 v80, v16, v42
  v_sub_f32 v81, v17, v42
  v_sub_f32 v82, v18, v42
  v_sub_f32 v83, v19, v42
  v_sub_f32 v84, v20, v42
  v_sub_f32 v85, v21, v42
  v_sub_f32 v86, v22, v42
  v_mfma_f32_16x16x32_bf16 v[76:79], a[204:207], v[60:63], v[76:79]
  v_sub_f32 v87, v23, v42
  s_add_u32 s3, s68, 0
  v_cvt_pk_bf16_f32 v44, v80, v81
  v_cvt_pk_bf16_f32 v45, v82, v83
  v_cvt_pk_bf16_f32 v46, v84, v85
  v_cvt_pk_bf16_f32 v47, v86, v87
  buffer_store_dwordx4 v[44:47], v1, s[16:19], s3 offen nt
  v_mul_f32 v40, v80, v80
  s_waitcnt lgkmcnt(5)
  v_mfma_f32_16x16x32_bf16 v[72:75], a[208:211], v[96:99], v[72:75]
  v_fmac_f32 v40, v81, v81
  v_fmac_f32 v40, v82, v82
  v_mfma_f32_16x16x32_bf16 v[76:79], a[212:215], v[96:99], v[76:79]
  s_waitcnt lgkmcnt(4)
  v_fmac_f32 v40, v83, v83
  v_fmac_f32 v40, v84, v84
  v_mfma_f32_16x16x32_bf16 v[72:75], a[216:219], v[100:103], v[72:75]
  v_fmac_f32 v40, v85, v85
  v_fmac_f32 v40, v86, v86
  v_mfma_f32_16x16x32_bf16 v[76:79], a[220:223], v[100:103], v[76:79]
  s_waitcnt lgkmcnt(3)
  v_fmac_f32 v40, v87, v87
  v_mov_b32 v41, v40
  v_mfma_f32_16x16x32_bf16 v[72:75], a[224:227], v[104:107], v[72:75]
  s_nop 0
  s_add_u32 s15, s71, 131072
  v_mfma_f32_16x16x32_bf16 v[76:79], a[228:231], v[104:107], v[76:79]
  s_waitcnt lgkmcnt(2)
  v_permlane32_swap_b32 v40, v41
  v_mfma_f32_16x16x32_bf16 v[72:75], a[232:235], v[108:111], v[72:75]
  v_add_f32 v40, v40, v41
  v_mov_b32 v41, v40
  v_mfma_f32_16x16x32_bf16 v[76:79], a[236:239], v[108:111], v[76:79]
  s_waitcnt lgkmcnt(1)
  v_permlane16_swap_b32 v40, v41
  v_mfma_f32_16x16x32_bf16 v[72:75], a[240:243], v[88:91], v[72:75]
  v_add_f32 v40, v40, v41
  buffer_store_dword v40, v6, s[16:19], s15 offen
  v_mfma_f32_16x16x32_bf16 v[76:79], a[244:247], v[88:91], v[76:79]
  s_waitcnt lgkmcnt(0)
  v_lshlrev_b32 v80, 16, v36
  v_and_b32 v81, 0xffff0000, v36
  v_mfma_f32_16x16x32_bf16 v[72:75], a[248:251], v[92:95], v[72:75]
  v_lshlrev_b32 v82, 16, v37
  v_and_b32 v83, 0xffff0000, v37
  v_mfma_f32_16x16x32_bf16 v[76:79], a[252:255], v[92:95], v[76:79]
  v_lshlrev_b32 v84, 16, v38
  v_and_b32 v85, 0xffff0000, v38
  v_lshlrev_b32 v86, 16, v39
  v_and_b32 v87, 0xffff0000, v39
  s_nop 7
  s_cmp_eq_u32 s11, 0
  s_cbranch_scc1 LF_sw_49
  v_swap_b32 v64, v72
  v_swap_b32 v65, v73
  v_swap_b32 v66, v74
  v_swap_b32 v67, v75
  v_swap_b32 v68, v76
  v_swap_b32 v69, v77
  v_swap_b32 v70, v78
  v_swap_b32 v71, v79
LF_sw_49:
  ds_write_b128 v114, v[72:75]
  ds_write_b128 v114, v[76:79] offset:1024
  v_fmac_f32 v24, v15, v64
  v_fmac_f32 v25, v15, v65
  v_fmac_f32 v26, v15, v66
  v_fmac_f32 v27, v15, v67
  v_fmac_f32 v28, v15, v68
  v_fmac_f32 v29, v15, v69
  v_fmac_f32 v30, v15, v70
  v_fmac_f32 v31, v15, v71
  s_add_u32 s22, s23, 540672
  s_waitcnt vmcnt(1)
  buffer_store_dword v14, v2, s[16:19], s22 offen
  s_waitcnt lgkmcnt(0)
  s_barrier
  ds_read_b128 v[72:75], v115
  ds_read_b128 v[76:79], v115 offset:1024
  s_waitcnt lgkmcnt(1)
  v_fmac_f32 v24, v15, v72
  v_fmac_f32 v25, v15, v73
  v_fmac_f32 v26, v15, v74
  v_fmac_f32 v27, v15, v75
  s_waitcnt lgkmcnt(0)
  v_fmac_f32 v28, v15, v76
  v_fmac_f32 v29, v15, v77
  v_fmac_f32 v30, v15, v78
  v_fmac_f32 v31, v15, v79
  v_add_f32 v64, v24, v25
  v_mul_f32 v66, v24, v80
  v_mul_f32 v65, v24, v24
  v_add_f32 v67, v80, v81
  v_fmac_f32 v65, v25, v25
  v_fmac_f32 v66, v25, v81
  v_add_f32 v64, v64, v26
  v_fmac_f32 v66, v26, v82
  v_fmac_f32 v65, v26, v26
  v_add_f32 v67, v67, v82
  v_add_f32 v64, v64, v27
  v_fmac_f32 v66, v27, v83
  v_fmac_f32 v65, v27, v27
  v_add_f32 v67, v67, v83
  v_add_f32 v64, v64, v28
  v_fmac_f32 v66, v28, v84
  v_fmac_f32 v65, v28, v28
  v_add_f32 v67, v67, v84
  v_add_f32 v64, v64, v29
  v_fmac_f32 v66, v29, v85
  v_fmac_f32 v65, v29, v29
  v_add_f32 v67, v67, v85
  v_add_f32 v64, v64, v30
  v_fmac_f32 v66, v30, v86
  v_fmac_f32 v65, v30, v30
  v_add_f32 v67, v67, v86
  v_add_f32 v64, v64, v31
  v_fmac_f32 v66, v31, v87
  v_fmac_f32 v65, v31, v31
  v_add_f32 v67, v67, v87
  v_permlane32_swap_b32 v64, v66
  s_nop 0
  v_permlane32_swap_b32 v65, v67
  v_add_f32 v64, v64, v66
  v_add_f32 v65, v65, v67
  s_add_u32 s3, s70, 786432
  s_nop 0
  v_permlane16_swap_b32 v64, v65
  v_add_f32 v64, v64, v65
  buffer_store_dword v64, v4, s[16:19], s3 offen
  s_lshl_b32 s20, s69, 1
  s_add_u32 s20, s20, 540672
  buffer_load_dword v123, v12, s[16:19], s20 offen sc1
  s_waitcnt vmcnt(0)
  v_cmp_ne_u32 vcc, s13, v123
  s_cbranch_vccnz LF_xfr_34
LF_xfb_36:
  s_add_u32 m0, s64, 32768
  s_mov_b32 s63, 0
  buffer_load_dwordx4 v8, s[16:19], s63 offen offset:0 sc1 lds
  buffer_load_dwordx4 v8, s[16:19], s63 offen offset:1024 sc1 lds
  buffer_load_dwordx4 v8, s[16:19], s63 offen offset:2048 sc1 lds
  buffer_load_dwordx4 v8, s[16:19], s63 offen offset:3072 sc1 lds
  s_add_u32 m0, s64, 40960
  s_mov_b32 s63, 8192
  buffer_load_dwordx4 v8, s[16:19], s63 offen offset:0 sc1 lds
  buffer_load_dwordx4 v8, s[16:19], s63 offen offset:1024 sc1 lds
  buffer_load_dwordx4 v8, s[16:19], s63 offen offset:2048 sc1 lds
  buffer_load_dwordx4 v8, s[16:19], s63 offen offset:3072 sc1 lds
  v_add_u32 v112, 0, v1
  s_waitcnt vmcnt(4)
  s_barrier
  ds_read_b128 v[88:91], v112 offset:32768
  ds_read_b128 v[92:95], v112 offset:49152
  ds_read_b128 v[96:99], v112 offset:33792
  ds_read_b128 v[100:103], v112 offset:50176
  s_waitcnt lgkmcnt(2)
  v_mfma_f32_16x16x32_bf16 v[40:43], a[0:3], v[88:91], 0
  s_add_u32 s21, s72, 786432
  buffer_load_dwordx4 v[64:67], v5, s[16:19], s21 offen offset:0 sc1
  ds_read_b128 v[104:107], v112 offset:34816
  v_mfma_f32_16x16x32_bf16 v[44:47], a[4:7], v[88:91], 0
  buffer_load_dwordx4 v[68:71], v5, s[16:19], s21 offen offset:256 sc1
  ds_read_b128 v[108:111], v112 offset:51200
  v_mfma_f32_16x16x32_bf16 v[48:51], a[8:11], v[88:91], 0
  buffer_load_dwordx4 v[72:75], v5, s[16:19], s21 offen offset:512 sc1
  buffer_load_dwordx4 v[76:79], v5, s[16:19], s21 offen offset:768 sc1
  v_mfma_f32_16x16x32_bf16 v[52:55], a[0:3], v[92:95], 0
  s_add_u32 m0, s64, 131072
  s_mov_b32 s63, 32768
  v_mfma_f32_16x16x32_bf16 v[56:59], a[4:7], v[92:95], 0
  buffer_load_dwordx4 v8, s[16:19], s63 offen offset:0 sc1 lds
  v_mfma_f32_16x16x32_bf16 v[60:63], a[8:11], v[92:95], 0
  s_waitcnt lgkmcnt(2)
  v_mfma_f32_16x16x32_bf16 v[40:43], a[12:15], v[96:99], v[40:43]
  ds_read_b128 v[88:91], v112 offset:35840
  v_mfma_f32_16x16x32_bf16 v[44:47], a[16:19], v[96:99], v[44:47]
  ds_read_b128 v[92:95], v112 offset:52224
  v_mfma_f32_16x16x32_bf16 v[48:51], a[20:23], v[96:99], v[48:51]
  v_mfma_f32_16x16x32_bf16 v[52:55], a[12:15], v[100:103], v[52:55]
  buffer_load_dwordx4 v8, s[16:19], s63 offen offset:1024 sc1 lds
  v_mfma_f32_16x16x32_bf16 v[56:59], a[16:19], v[100:103], v[56:59]
  v_mfma_f32_16x16x32_bf16 v[60:63], a[20:23], v[100:103], v[60:63]
  s_waitcnt lgkmcnt(2)
  v_mfma_f32_16x16x32_bf16 v[40:43], a[24:27], v[104:107], v[40:43]
  ds_read_b128 v[96:99], v112 offset:36864
  v_mfma_f32_16x16x32_bf16 v[44:47], a[28:31], v[104:107], v[44:47]
  buffer_load_dwordx4 v8, s[16:19], s63 offen offset:2048 sc1 lds
  ds_read_b128 v[100:103], v112 offset:53248
  v_mfma_f32_16x16x32_bf16 v[48:51], a[32:35], v[104:107], v[48:51]
  v_mfma_f32_16x16x32_bf16 v[52:55], a[24:27], v[108:111], v[52:55]
  v_mfma_f32_16x16x32_bf16 v[56:59], a[28:31], v[108:111], v[56:59]
  v_mfma_f32_16x16x32_bf16 v[60:63], a[32:35], v[108:111], v[60:63]
  s_waitcnt lgkmcnt(2)
  v_mfma_f32_16x16x32_bf16 v[40:43], a[36:39], v[88:91], v[40:43]
  buffer_load_dwordx4 v8, s[16:19], s63 offen offset:3072 sc1 lds
  s_add_u32 m0, s64, 139264
  ds_read_b128 v[104:107], v112 offset:37888
  v_mfma_f32_16x16x32_bf16 v[44:47], a[40:43], v[88:91], v[44:47]
  s_mov_b32 s63, 40960
  ds_read_b128 v[108:111], v112 offset:54272
  v_mfma_f32_16x16x32_bf16 v[48:51], a[44:47], v[88:91], v[48:51]
  v_mfma_f32_16x16x32_bf16 v[52:55], a[36:39], v[92:95], v[52:55]
  v_mfma_f32_16x16x32_bf16 v[56:59], a[40:43], v[92:95], v[56:59]
  v_mfma_f32_16x16x32_bf16 v[60:63], a[44:47], v[92:95], v[60:63]
  s_waitcnt lgkmcnt(2)
  buffer_load_dwordx4 v8, s[16:19], s63 offen offset:0 sc1 lds
  v_mfma_f32_16x16x32_bf16 v[40:43], a[48:51], v[96:99], v[40:43]
  ds_read_b128 v[88:91], v112 offset:38912
  v_mfma_f32_16x16x32_bf16 v[44:47], a[52:55], v[96:99], v[44:47]
  ds_read_b128 v[92:95], v112 offset:55296
  v_mfma_f32_16x16x32_bf16 v[48:51], a[56:59], v[96:99], v[48:51]
  v_mfma_f32_16x16x32_bf16 v[52:55], a[48:51], v[100:103], v[52:55]
  s_waitcnt vmcnt(5)
  v_max3_u32 v122, v64, v65, v66
  v_max3_u32 v122, v122, v67, v68
  v_max3_u32 v122, v122, v69, v70
  v_max3_u32 v122, v122, v71, v72
  v_mfma_f32_16x16x32_bf16 v[56:59], a[52:55], v[100:103], v[56:59]
  buffer_load_dwordx4 v8, s[16:19], s63 offen offset:1024 sc1 lds
  v_max3_u32 v122, v122, v73, v74
  v_max3_u32 v122, v122, v75, v76
  v_max3_u32 v122, v122, v77, v78
  v_mfma_f32_16x16x32_bf16 v[60:63], a[56:59], v[100:103], v[60:63]
  v_max_u32 v122, v122, v79
  v_cmp_eq_u32 vcc, -1, v122
  s_cbranch_vccnz LF_grr_50
LF_grb_52:
  s_waitcnt lgkmcnt(2)
  v_add_f32 v64, v64, v68
  v_mfma_f32_16x16x32_bf16 v[40:43], a[60:63], v[104:107], v[40:43]
  ds_read_b128 v[96:99], v112 offset:39936
  v_add_f32 v72, v72, v76
  v_add_f32 v65, v65, v69
  v_add_f32 v73, v73, v77
  v_mfma_f32_16x16x32_bf16 v[44:47], a[64:67], v[104:107], v[44:47]
  buffer_load_dwordx4 v8, s[16:19], s63 offen offset:2048 sc1 lds
  ds_read_b128 v[100:103], v112 offset:56320
  v_add_f32 v66, v66, v70
  v_add_f32 v74, v74, v78
  v_mfma_f32_16x16x32_bf16 v[48:51], a[68:71], v[104:107], v[48:51]
  v_add_f32 v67, v67, v71
  v_add_f32 v75, v75, v79
  v_add_f32 v64, v64, v72
  v_add_f32 v66, v66, v74
  v_mfma_f32_16x16x32_bf16 v[52:55], a[60:63], v[108:111], v[52:55]
  v_add_f32 v65, v65, v73
  v_add_f32 v67, v67, v75
  v_permlane32_swap_b32 v64, v66
  v_mfma_f32_16x16x32_bf16 v[56:59], a[64:67], v[108:111], v[56:59]
  v_permlane32_swap_b32 v65, v67
  v_add_f32 v64, v64, v66
  v_add_f32 v65, v65, v67
  v_mfma_f32_16x16x32_bf16 v[60:63], a[68:71], v[108:111], v[60:63]
  s_waitcnt lgkmcnt(2)
  buffer_load_dwordx4 v8, s[16:19], s63 offen offset:3072 sc1 lds
  v_permlane16_swap_b32 v64, v65
  v_add_f32 v64, v64, v65
  v_mfma_f32_16x16x32_bf16 v[40:43], a[72:75], v[88:91], v[40:43]
  v_mov_b32 v65, v64
  s_barrier
  ds_read_b128 v[104:107], v112 offset:40960
  v_mfma_f32_16x16x32_bf16 v[44:47], a[76:79], v[88:91], v[44:47]
  ds_read_b128 v[108:111], v112 offset:57344
  v_permlane16_swap_b32 v64, v65
  v_mov_b32 v66, v64
  v_mfma_f32_16x16x32_bf16 v[48:51], a[80:83], v[88:91], v[48:51]
  v_mov_b32 v67, v65
  v_permlane32_swap_b32 v64, v66
  v_mfma_f32_16x16x32_bf16 v[52:55], a[72:75], v[92:95], v[52:55]
  v_permlane32_swap_b32 v65, v67
  v_mul_f32 v64, 0x3b000000, v64
  v_mul_f32 v65, 0x3b000000, v65
  v_mfma_f32_16x16x32_bf16 v[56:59], a[76:79], v[92:95], v[56:59]
  v_fma_f32 v65, -v64, v64, v65
  v_max_f32 v65, 0, v65
  v_add_f32 v65, 0x3727c5ac, v65
  v_rsq_f32 v65, v65
  v_mfma_f32_16x16x32_bf16 v[60:63], a[80:83], v[92:95], v[60:63]
  s_waitcnt lgkmcnt(2)
  v_fma_f32 v66, -v64, v67, v66
  v_mul_f32 v66, 0x3b000000, v66
  v_fma_f32 v66, v65, v66, v64
  v_mul_f32 v64, v64, v65
  v_mfma_f32_16x16x32_bf16 v[40:43], a[84:87], v[96:99], v[40:43]
  ds_read_b128 v[88:91], v112 offset:41984
  v_fma_f32 v68, v24, v65, -v64
  v_fma_f32 v69, v25, v65, -v64
  v_fma_f32 v70, v26, v65, -v64
  v_mfma_f32_16x16x32_bf16 v[44:47], a[88:91], v[96:99], v[44:47]
  ds_read_b128 v[92:95], v112 offset:58368
  v_fma_f32 v71, v27, v65, -v64
  v_fma_f32 v72, v28, v65, -v64
  v_fma_f32 v73, v29, v65, -v64
  v_mfma_f32_16x16x32_bf16 v[48:51], a[92:95], v[96:99], v[48:51]
  v_fma_f32 v74, v30, v65, -v64
  v_fma_f32 v75, v31, v65, -v64
  v_fmac_f32 v24, v68, v80
  v_fmac_f32 v25, v69, v81
  v_mfma_f32_16x16x32_bf16 v[52:55], a[84:87], v[100:103], v[52:55]
  v_fmac_f32 v26, v70, v82
  v_fmac_f32 v27, v71, v83
  v_fmac_f32 v28, v72, v84
  v_fmac_f32 v29, v73, v85
  v_mfma_f32_16x16x32_bf16 v[56:59], a[88:91], v[100:103], v[56:59]
  v_fmac_f32 v30, v74, v86
  v_fmac_f32 v31, v75, v87
  v_sub_f32 v80, v24, v66
  v_sub_f32 v81, v25, v66
  v_mfma_f32_16x16x32_bf16 v[60:63], a[92:95], v[100:103], v[60:63]
  s_waitcnt lgkmcnt(2)
  v_sub_f32 v82, v26, v66
  v_sub_f32 v83, v27, v66
  v_sub_f32 v84, v28, v66
  v_sub_f32 v85, v29, v66
  v_mfma_f32_16x16x32_bf16 v[40:43], a[96:99], v[104:107], v[40:43]
  s_add_u32 s3, s68, 65536
  ds_read_b128 v[96:99], v112 offset:43008
  v_sub_f32 v86, v30, v66
  v_sub_f32 v87, v31, v66
  v_cvt_pk_bf16_f32 v68, v80, v81
  v_mfma_f32_16x16x32_bf16 v[44:47], a[100:103], v[104:107], v[44:47]
  ds_read_b128 v[100:103], v112 offset:59392
  v_cvt_pk_bf16_f32 v69, v82, v83
  v_cvt_pk_bf16_f32 v70, v84, v85
  v_cvt_pk_bf16_f32 v71, v86, v87
  v_mfma_f32_16x16x32_bf16 v[48:51], a[104:107], v[104:107], v[48:51]
  buffer_store_dwordx4 v[68:71], v1, s[16:19], s3 offen nt
  v_mul_f32 v64, v80, v80
  v_fmac_f32 v64, v81, v81
  v_fmac_f32 v64, v82, v82
  v_mfma_f32_16x16x32_bf16 v[52:55], a[96:99], v[108:111], v[52:55]
  s_add_u32 s22, s23, 540928
  v_fmac_f32 v64, v83, v83
  v_fmac_f32 v64, v84, v84
  v_mfma_f32_16x16x32_bf16 v[56:59], a[100:103], v[108:111], v[56:59]
  v_fmac_f32 v64, v85, v85
  v_fmac_f32 v64, v86, v86
  v_mfma_f32_16x16x32_bf16 v[60:63], a[104:107], v[108:111], v[60:63]
  s_waitcnt lgkmcnt(2)
  v_fmac_f32 v64, v87, v87
  v_mov_b32 v65, v64
  v_mfma_f32_16x16x32_bf16 v[40:43], a[108:111], v[88:91], v[40:43]
  s_nop 0
  s_add_u32 s15, s71, 196608
  ds_read_b128 v[104:107], v112 offset:44032
  v_mfma_f32_16x16x32_bf16 v[44:47], a[112:115], v[88:91], v[44:47]
  ds_read_b128 v[108:111], v112 offset:60416
  v_mfma_f32_16x16x32_bf16 v[48:51], a[116:119], v[88:91], v[48:51]
  v_permlane32_swap_b32 v64, v65
  v_mfma_f32_16x16x32_bf16 v[52:55], a[108:111], v[92:95], v[52:55]
  v_add_f32 v64, v64, v65
  v_mov_b32 v65, v64
  v_mfma_f32_16x16x32_bf16 v[56:59], a[112:115], v[92:95], v[56:59]
  s_nop 0
  v_permlane16_swap_b32 v64, v65
  v_mfma_f32_16x16x32_bf16 v[60:63], a[116:119], v[92:95], v[60:63]
  s_waitcnt lgkmcnt(2)
  v_add_f32 v64, v64, v65
  buffer_store_dword v64, v6, s[16:19], s15 offen
  v_mfma_f32_16x16x32_bf16 v[40:43], a[120:123], v[96:99], v[40:43]
  ds_read_b128 v[88:91], v112 offset:45056
  v_mfma_f32_16x16x32_bf16 v[44:47], a[124:127], v[96:99], v[44:47]
  ds_read_b128 v[92:95], v112 offset:61440
  v_mfma_f32_16x16x32_bf16 v[48:51], a[128:131], v[96:99], v[48:51]
  v_mfma_f32_16x16x32_bf16 v[52:55], a[120:123], v[100:103], v[52:55]
  v_mfma_f32_16x16x32_bf16 v[56:59], a[124:127], v[100:103], v[56:59]
  v_mfma_f32_16x16x32_bf16 v[60:63], a[128:131], v[100:103], v[60:63]
  s_waitcnt lgkmcnt(2)
  v_mfma_f32_16x16x32_bf16 v[40:43], a[132:135], v[104:107], v[40:43]
  ds_read_b128 v[96:99], v112 offset:46080
  v_mfma_f32_16x16x32_bf16 v[44:47], a[136:139], v[104:107], v[44:47]
  ds_read_b128 v[100:103], v112 offset:62464
  v_mfma_f32_16x16x32_bf16 v[48:51], a[140:143], v[104:107], v[48:51]
  v_mfma_f32_16x16x32_bf16 v[52:55], a[132:135], v[108:111], v[52:55]
  v_mfma_f32_16x16x32_bf16 v[56:59], a[136:139], v[108:111], v[56:59]
  v_mfma_f32_16x16x32_bf16 v[60:63], a[140:143], v[108:111], v[60:63]
  s_waitcnt lgkmcnt(2)
  v_mfma_f32_16x16x32_bf16 v[40:43], a[144:147], v[88:91], v[40:43]
  ds_read_b128 v[104:107], v112 offset:47104
  v_mfma_f32_16x16x32_bf16 v[44:47], a[148:151], v[88:91], v[44:47]
  ds_read_b128 v[108:111], v112 offset:63488
  v_mfma_f32_16x16x32_bf16 v[48:51], a[152:155], v[88:91], v[48:51]
  v_mfma_f32_16x16x32_bf16 v[52:55], a[144:147], v[92:95], v[52:55]
  v_mfma_f32_16x16x32_bf16 v[56:59], a[148:151], v[92:95], v[56:59]
  v_mfma_f32_16x16x32_bf16 v[60:63], a[152:155], v[92:95], v[60:63]
  s_waitcnt lgkmcnt(2)
  v_mfma_f32_16x16x32_bf16 v[40:43], a[156:159], v[96:99], v[40:43]
  ds_read_b128 v[88:91], v112 offset:48128
  v_mfma_f32_16x16x32_bf16 v[44:47], a[160:163], v[96:99], v[44:47]
  ds_read_b128 v[92:95], v112 offset:64512
  v_mfma_f32_16x16x32_bf16 v[48:51], a[164:167], v[96:99], v[48:51]
  v_mfma_f32_16x16x32_bf16 v[52:55], a[156:159], v[100:103], v[52:55]
  v_mfma_f32_16x16x32_bf16 v[56:59], a[160:163], v[100:103], v[56:59]
  v_mfma_f32_16x16x32_bf16 v[60:63], a[164:167], v[100:103], v[60:63]
  s_waitcnt lgkmcnt(2)
  v_mfma_f32_16x16x32_bf16 v[40:43], a[168:171], v[104:107], v[40:43]
  s_waitcnt vmcnt(2)
  v_add_u32 v112, 131072, v1
  s_barrier
  ds_read_b128 v[96:99], v112 offset:0
  v_mfma_f32_16x16x32_bf16 v[44:47], a[172:175], v[104:107], v[44:47]
  s_waitcnt vmcnt(1)
  buffer_store_dword v14, v2, s[16:19], s22 offen
  ds_read_b128 v[100:103], v112 offset:16384
  v_mfma_f32_16x16x32_bf16 v[48:51], a[176:179], v[104:107], v[48:51]
  v_mfma_f32_16x16x32_bf16 v[52:55], a[168:171], v[108:111], v[52:55]
  v_mfma_f32_16x16x32_bf16 v[56:59], a[172:175], v[108:111], v[56:59]
  v_mfma_f32_16x16x32_bf16 v[60:63], a[176:179], v[108:111], v[60:63]
  s_waitcnt lgkmcnt(2)
  v_mfma_f32_16x16x32_bf16 v[40:43], a[180:183], v[88:91], v[40:43]
  ds_read_b128 v[104:107], v112 offset:1024
  v_mfma_f32_16x16x32_bf16 v[44:47], a[184:187], v[88:91], v[44:47]
  ds_read_b128 v[108:111], v112 offset:17408
  v_mfma_f32_16x16x32_bf16 v[48:51], a[188:191], v[88:91], v[48:51]
  v_mfma_f32_16x16x32_bf16 v[52:55], a[180:183], v[92:95], v[52:55]
  v_mfma_f32_16x16x32_bf16 v[56:59], a[184:187], v[92:95], v[56:59]
  v_mfma_f32_16x16x32_bf16 v[60:63], a[188:191], v[92:95], v[60:63]
  s_waitcnt lgkmcnt(2)
  v_mfma_f32_16x16x32_bf16 v[64:67], a[0:3], v[96:99], 0
  ds_read_b128 v[88:91], v112 offset:2048
  v_mfma_f32_16x16x32_bf16 v[68:71], a[4:7], v[96:99], 0
  ds_read_b128 v[92:95], v112 offset:18432
  v_mfma_f32_16x16x32_bf16 v[72:75], a[8:11], v[96:99], 0
  v_mfma_f32_16x16x32_bf16 v[76:79], a[0:3], v[100:103], 0
  v_mfma_f32_16x16x32_bf16 v[80:83], a[4:7], v[100:103], 0
  v_mfma_f32_16x16x32_bf16 v[84:87], a[8:11], v[100:103], 0
  s_waitcnt lgkmcnt(2)
  v_mfma_f32_16x16x32_bf16 v[64:67], a[12:15], v[104:107], v[64:67]
  ds_read_b128 v[96:99], v112 offset:3072
  v_mfma_f32_16x16x32_bf16 v[68:71], a[16:19], v[104:107], v[68:71]
  s_lshl_b32 s20, s69, 1
  s_add_u32 s20, s20, 540928
  ds_read_b128 v[100:103], v112 offset:19456
  v_mfma_f32_16x16x32_bf16 v[72:75], a[20:23], v[104:107], v[72:75]
  buffer_load_dword v123, v12, s[16:19], s20 offen sc1
  v_max_f32 v40, 0, v40
  v_mfma_f32_16x16x32_bf16 v[76:79], a[12:15], v[108:111], v[76:79]
  v_max_f32 v41, 0, v41
  v_max_f32 v42, 0, v42
  v_mfma_f32_16x16x32_bf16 v[80:83], a[16:19], v[108:111], v[80:83]
  v_max_f32 v43, 0, v43
  v_mul_f32 v40, v40, v44
  v_mfma_f32_16x16x32_bf16 v[84:87], a[20:23], v[108:111], v[84:87]
  s_waitcnt lgkmcnt(2)
  v_mul_f32 v41, v41, v45
  v_mul_f32 v42, v42, v46
  v_mfma_f32_16x16x32_bf16 v[64:67], a[24:27], v[88:91], v[64:67]
  ds_read_b128 v[104:107], v112 offset:4096
  v_mul_f32 v43, v43, v47
  v_mfma_f32_16x16x32_bf16 v[68:71], a[28:31], v[88:91], v[68:71]
  ds_read_b128 v[108:111], v112 offset:20480
  v_cvt_pk_bf16_f32 v114, v40, v41
  v_mfma_f32_16x16x32_bf16 v[72:75], a[32:35], v[88:91], v[72:75]
  v_cvt_pk_bf16_f32 v115, v42, v43
  v_max_f32 v52, 0, v52
  v_mfma_f32_16x16x32_bf16 v[76:79], a[24:27], v[92:95], v[76:79]
  v_max_f32 v53, 0, v53
  v_max_f32 v54, 0, v54
  v_mfma_f32_16x16x32_bf16 v[80:83], a[28:31], v[92:95], v[80:83]
  v_max_f32 v55, 0, v55
  v_mul_f32 v52, v52, v56
  v_mfma_f32_16x16x32_bf16 v[84:87], a[32:35], v[92:95], v[84:87]
  s_waitcnt lgkmcnt(2)
  v_mul_f32 v53, v53, v57
  v_mul_f32 v54, v54, v58
  v_mfma_f32_16x16x32_bf16 v[64:67], a[36:39], v[96:99], v[64:67]
  ds_read_b128 v[88:91], v112 offset:5120
  v_mul_f32 v55, v55, v59
  v_mfma_f32_16x16x32_bf16 v[68:71], a[40:43], v[96:99], v[68:71]
  ds_read_b128 v[92:95], v112 offset:21504
  v_cvt_pk_bf16_f32 v116, v52, v53
  v_mfma_f32_16x16x32_bf16 v[72:75], a[44:47], v[96:99], v[72:75]
  v_cvt_pk_bf16_f32 v117, v54, v55
  v_mfma_f32_16x16x32_bf16 v[76:79], a[36:39], v[100:103], v[76:79]
  v_permlane16_swap_b32 v48, v60
  v_mfma_f32_16x16x32_bf16 v[80:83], a[40:43], v[100:103], v[80:83]
  v_permlane16_swap_b32 v49, v61
  v_mfma_f32_16x16x32_bf16 v[84:87], a[44:47], v[100:103], v[84:87]
  s_waitcnt lgkmcnt(2)
  v_permlane16_swap_b32 v50, v62
  v_mfma_f32_16x16x32_bf16 v[64:67], a[48:51], v[104:107], v[64:67]
  ds_read_b128 v[96:99], v112 offset:6144
  v_mfma_f32_16x16x32_bf16 v[68:71], a[52:55], v[104:107], v[68:71]
  ds_read_b128 v[100:103], v112 offset:22528
  v_mfma_f32_16x16x32_bf16 v[72:75], a[56:59], v[104:107], v[72:75]
  v_permlane16_swap_b32 v51, v63
  v_mfma_f32_16x16x32_bf16 v[76:79], a[48:51], v[108:111], v[76:79]
  v_permlane16_swap_b32 v114, v116
  v_mfma_f32_16x16x32_bf16 v[80:83], a[52:55], v[108:111], v[80:83]
  s_mov_b32 s15, 0
  v_permlane16_swap_b32 v115, v117
  v_mfma_f32_16x16x32_bf16 v[84:87], a[56:59], v[108:111], v[84:87]
  s_waitcnt lgkmcnt(2)
  buffer_store_dwordx4 v[114:117], v10, s[16:19], s15 offen nt
  v_max_f32 v48, 0, v48
  v_mfma_f32_16x16x32_bf16 v[64:67], a[60:63], v[88:91], v[64:67]
  s_waitcnt vmcnt(1)
  v_cmp_ne_u32 vcc, s13, v123
  s_cbranch_vccnz LF_xfr_53
LF_xfb_55:
  ds_read_b128 v[104:107], v112 offset:7168
  v_mfma_f32_16x16x32_bf16 v[68:71], a[64:67], v[88:91], v[68:71]
  s_add_u32 m0, s64, 65536
  s_mov_b32 s63, 65536
  ds_read_b128 v[108:111], v112 offset:23552
  v_mfma_f32_16x16x32_bf16 v[72:75], a[68:71], v[88:91], v[72:75]
  buffer_load_dwordx4 v8, s[16:19], s63 offen offset:0 sc1 lds
  v_max_f32 v49, 0, v49
  v_mfma_f32_16x16x32_bf16 v[76:79], a[60:63], v[92:95], v[76:79]
  v_max_f32 v50, 0, v50
  v_max_f32 v51, 0, v51
  v_mfma_f32_16x16x32_bf16 v[80:83], a[64:67], v[92:95], v[80:83]
  v_mul_f32 v48, v48, v60
  v_mul_f32 v49, v49, v61
  v_mfma_f32_16x16x32_bf16 v[84:87], a[68:71], v[92:95], v[84:87]
  s_waitcnt lgkmcnt(2)
  buffer_load_dwordx4 v8, s[16:19], s63 offen offset:1024 sc1 lds
  v_mul_f32 v50, v50, v62
  v_mfma_f32_16x16x32_bf16 v[64:67], a[72:75], v[96:99], v[64:67]
  ds_read_b128 v[88:91], v112 offset:8192
  v_mul_f32 v51, v51, v63
  v_mfma_f32_16x16x32_bf16 v[68:71], a[76:79], v[96:99], v[68:71]
  ds_read_b128 v[92:95], v112 offset:24576
  v_cvt_pk_bf16_f32 v118, v48, v49
  v_mfma_f32_16x16x32_bf16 v[72:75], a[80:83], v[96:99], v[72:75]
  v_cvt_pk_bf16_f32 v119, v50, v51
  v_mov_b32 v120, v118
  v_mfma_f32_16x16x32_bf16 v[76:79], a[72:75], v[100:103], v[76:79]
  v_mov_b32 v121, v119
  s_nop 0
  v_mfma_f32_16x16x32_bf16 v[80:83], a[76:79], v[100:103], v[80:83]
  buffer_load_dwordx4 v8, s[16:19], s63 offen offset:2048 sc1 lds
  v_mfma_f32_16x16x32_bf16 v[84:87], a[80:83], v[100:103], v[84:87]
  s_waitcnt lgkmcnt(2)
  v_permlane32_swap_b32 v118, v120
  v_mfma_f32_16x16x32_bf16 v[64:67], a[84:87], v[104:107], v[64:67]
  ds_read_b128 v[96:99], v112 offset:9216
  v_mfma_f32_16x16x32_bf16 v[68:71], a[88:91], v[104:107], v[68:71]
  ds_read_b128 v[100:103], v112 offset:25600
  v_mfma_f32_16x16x32_bf16 v[72:75], a[92:95], v[104:107], v[72:75]
  buffer_load_dwordx4 v8, s[16:19], s63 offen offset:3072 sc1 lds
  s_add_u32 m0, s64, 73728
  s_mov_b32 s63, 73728
  v_mfma_f32_16x16x32_bf16 v[76:79], a[84:87], v[108:111], v[76:79]
  v_permlane32_swap_b32 v119, v121
  v_mfma_f32_16x16x32_bf16 v[80:83], a[88:91], v[108:111], v[80:83]
  buffer_store_dwordx4 v[118:121], v11, s[16:19], s15 offen nt
  v_mfma_f32_16x16x32_bf16 v[84:87], a[92:95], v[108:111], v[84:87]
  s_add_u32 s22, s23, 573440
  s_waitcnt lgkmcnt(2)
  v_mfma_f32_16x16x32_bf16 v[64:67], a[96:99], v[88:91], v[64:67]
  ds_read_b128 v[104:107], v112 offset:10240
  v_mfma_f32_16x16x32_bf16 v[68:71], a[100:103], v[88:91], v[68:71]
  ds_read_b128 v[108:111], v112 offset:26624
  v_mfma_f32_16x16x32_bf16 v[72:75], a[104:107], v[88:91], v[72:75]
  v_mfma_f32_16x16x32_bf16 v[76:79], a[96:99], v[92:95], v[76:79]
  v_mfma_f32_16x16x32_bf16 v[80:83], a[100:103], v[92:95], v[80:83]
  v_mfma_f32_16x16x32_bf16 v[84:87], a[104:107], v[92:95], v[84:87]
  s_waitcnt lgkmcnt(2)
  buffer_load_dwordx4 v8, s[16:19], s63 offen offset:0 sc1 lds
  v_mfma_f32_16x16x32_bf16 v[64:67], a[108:111], v[96:99], v[64:67]
  ds_read_b128 v[88:91], v112 offset:11264
  v_mfma_f32_16x16x32_bf16 v[68:71], a[112:115], v[96:99], v[68:71]
  ds_read_b128 v[92:95], v112 offset:27648
  v_mfma_f32_16x16x32_bf16 v[72:75], a[116:119], v[96:99], v[72:75]
  v_mfma_f32_16x16x32_bf16 v[76:79], a[108:111], v[100:103], v[76:79]
  v_mfma_f32_16x16x32_bf16 v[80:83], a[112:115], v[100:103], v[80:83]
  buffer_load_dwordx4 v8, s[16:19], s63 offen offset:1024 sc1 lds
  v_mfma_f32_16x16x32_bf16 v[84:87], a[116:119], v[100:103], v[84:87]
  s_waitcnt lgkmcnt(2)
  v_mfma_f32_16x16x32_bf16 v[64:67], a[120:123], v[104:107], v[64:67]
  ds_read_b128 v[96:99], v112 offset:12288
  v_mfma_f32_16x16x32_bf16 v[68:71], a[124:127], v[104:107], v[68:71]
  ds_read_b128 v[100:103], v112 offset:28672
  v_mfma_f32_16x16x32_bf16 v[72:75], a[128:131], v[104:107], v[72:75]
  v_mfma_f32_16x16x32_bf16 v[76:79], a[120:123], v[108:111], v[76:79]
  buffer_load_dwordx4 v8, s[16:19], s63 offen offset:2048 sc1 lds
  v_mfma_f32_16x16x32_bf16 v[80:83], a[124:127], v[108:111], v[80:83]
  v_mfma_f32_16x16x32_bf16 v[84:87], a[128:131], v[108:111], v[84:87]
  s_waitcnt lgkmcnt(2)
  buffer_load_dwordx4 v8, s[16:19], s63 offen offset:3072 sc1 lds
  v_mfma_f32_16x16x32_bf16 v[64:67], a[132:135], v[88:91], v[64:67]
  s_add_u32 m0, s64, 98304
  s_mov_b32 s63, 98304
  ds_read_b128 v[104:107], v112 offset:13312
  v_mfma_f32_16x16x32_bf16 v[68:71], a[136:139], v[88:91], v[68:71]
  ds_read_b128 v[108:111], v112 offset:29696
  v_mfma_f32_16x16x32_bf16 v[72:75], a[140:143], v[88:91], v[72:75]
  v_mfma_f32_16x16x32_bf16 v[76:79], a[132:135], v[92:95], v[76:79]
  v_mfma_f32_16x16x32_bf16 v[80:83], a[136:139], v[92:95], v[80:83]
  v_mfma_f32_16x16x32_bf16 v[84:87], a[140:143], v[92:95], v[84:87]
  s_waitcnt lgkmcnt(2)
  v_mfma_f32_16x16x32_bf16 v[64:67], a[144:147], v[96:99], v[64:67]
  buffer_load_dwordx4 v8, s[16:19], s63 offen offset:0 sc1 lds
  ds_read_b128 v[88:91], v112 offset:14336
  v_mfma_f32_16x16x32_bf16 v[68:71], a[148:151], v[96:99], v[68:71]
  ds_read_b128 v[92:95], v112 offset:30720
  v_mfma_f32_16x16x32_bf16 v[72:75], a[152:155], v[96:99], v[72:75]
  v_mfma_f32_16x16x32_bf16 v[76:79], a[144:147], v[100:103], v[76:79]
  v_mfma_f32_16x16x32_bf16 v[80:83], a[148:151], v[100:103], v[80:83]
  v_mfma_f32_16x16x32_bf16 v[84:87], a[152:155], v[100:103], v[84:87]
  s_waitcnt lgkmcnt(2)
  buffer_load_dwordx4 v8, s[16:19], s63 offen offset:1024 sc1 lds
  v_mfma_f32_16x16x32_bf16 v[64:67], a[156:159], v[104:107], v[64:67]
  ds_read_b128 v[96:99], v112 offset:15360
  v_mfma_f32_16x16x32_bf16 v[68:71], a[160:163], v[104:107], v[68:71]
  ds_read_b128 v[100:103], v112 offset:31744
  v_mfma_f32_16x16x32_bf16 v[72:75], a[164:167], v[104:107], v[72:75]
  v_mfma_f32_16x16x32_bf16 v[76:79], a[156:159], v[108:111], v[76:79]
  v_mfma_f32_16x16x32_bf16 v[80:83], a[160:163], v[108:111], v[80:83]
  buffer_load_dwordx4 v8, s[16:19], s63 offen offset:2048 sc1 lds
  v_mfma_f32_16x16x32_bf16 v[84:87], a[164:167], v[108:111], v[84:87]
  s_waitcnt lgkmcnt(2)
  v_mfma_f32_16x16x32_bf16 v[64:67], a[168:171], v[88:91], v[64:67]
  s_waitcnt vmcnt(3)
  v_add_u32 v112, 65536, v1
  s_barrier
  ds_read_b128 v[104:107], v112 offset:0
  v_mfma_f32_16x16x32_bf16 v[68:71], a[172:175], v[88:91], v[68:71]
  buffer_store_dword v14, v2, s[16:19], s22 offen
  ds_read_b128 v[108:111], v112 offset:16384
  v_mfma_f32_16x16x32_bf16 v[72:75], a[176:179], v[88:91], v[72:75]
  buffer_load_dwordx4 v8, s[16:19], s63 offen offset:3072 sc1 lds
  s_add_u32 m0, s64, 106496
  s_mov_b32 s63, 106496
  v_mfma_f32_16x16x32_bf16 v[76:79], a[168:171], v[92:95], v[76:79]
  v_mfma_f32_16x16x32_bf16 v[80:83], a[172:175], v[92:95], v[80:83]
  buffer_load_dwordx4 v8, s[16:19], s63 offen offset:0 sc1 lds
  v_mfma_f32_16x16x32_bf16 v[84:87], a[176:179], v[92:95], v[84:87]
  s_waitcnt lgkmcnt(2)
  v_mfma_f32_16x16x32_bf16 v[64:67], a[180:183], v[96:99], v[64:67]
  ds_read_b128 v[88:91], v112 offset:1024
  v_mfma_f32_16x16x32_bf16 v[68:71], a[184:187], v[96:99], v[68:71]
  ds_read_b128 v[92:95], v112 offset:17408
  v_mfma_f32_16x16x32_bf16 v[72:75], a[188:191], v[96:99], v[72:75]
  v_mfma_f32_16x16x32_bf16 v[76:79], a[180:183], v[100:103], v[76:79]
  buffer_load_dwordx4 v8, s[16:19], s63 offen offset:1024 sc1 lds
  v_mfma_f32_16x16x32_bf16 v[80:83], a[184:187], v[100:103], v[80:83]
  v_mfma_f32_16x16x32_bf16 v[84:87], a[188:191], v[100:103], v[84:87]
  s_waitcnt lgkmcnt(2)
  v_mfma_f32_16x16x32_bf16 v[40:43], a[0:3], v[104:107], 0
  ds_read_b128 v[96:99], v112 offset:2048
  v_mfma_f32_16x16x32_bf16 v[44:47], a[4:7], v[104:107], 0
  buffer_load_dwordx4 v8, s[16:19], s63 offen offset:2048 sc1 lds
  ds_read_b128 v[100:103], v112 offset:18432
  v_mfma_f32_16x16x32_bf16 v[48:51], a[8:11], v[104:107], 0
  v_max_f32 v64, 0, v64
  v_max_f32 v65, 0, v65
  v_mfma_f32_16x16x32_bf16 v[52:55], a[0:3], v[108:111], 0
  v_max_f32 v66, 0, v66
  v_max_f32 v67, 0, v67
  v_mfma_f32_16x16x32_bf16 v[56:59], a[4:7], v[108:111], 0
  v_mul_f32 v64, v64, v68
  v_mul_f32 v65, v65, v69
  v_mfma_f32_16x16x32_bf16 v[60:63], a[8:11], v[108:111], 0
  s_waitcnt lgkmcnt(2)
  v_mul_f32 v66, v66, v70
  v_mul_f32 v67, v67, v71
  v_mfma_f32_16x16x32_bf16 v[40:43], a[12:15], v[88:91], v[40:43]
  buffer_load_dwordx4 v8, s[16:19], s63 offen offset:3072 sc1 lds
  ds_read_b128 v[104:107], v112 offset:3072
  v_mfma_f32_16x16x32_bf16 v[44:47], a[16:19], v[88:91], v[44:47]
  s_lshl_b32 s20, s69, 1
  s_add_u32 s20, s20, 573440
  ds_read_b128 v[108:111], v112 offset:19456
  v_mfma_f32_16x16x32_bf16 v[48:51], a[20:23], v[88:91], v[48:51]
  buffer_load_dword v123, v13, s[16:19], s20 offen sc1
  v_cvt_pk_bf16_f32 v114, v64, v65
  v_mfma_f32_16x16x32_bf16 v[52:55], a[12:15], v[92:95], v[52:55]
  v_cvt_pk_bf16_f32 v115, v66, v67
  v_max_f32 v76, 0, v76
  v_mfma_f32_16x16x32_bf16 v[56:59], a[16:19], v[92:95], v[56:59]
  v_max_f32 v77, 0, v77
  v_max_f32 v78, 0, v78
  v_mfma_f32_16x16x32_bf16 v[60:63], a[20:23], v[92:95], v[60:63]
  s_waitcnt lgkmcnt(2)
  v_max_f32 v79, 0, v79
  v_mul_f32 v76, v76, v80
  v_mfma_f32_16x16x32_bf16 v[40:43], a[24:27], v[96:99], v[40:43]
  ds_read_b128 v[88:91], v112 offset:4096
  v_mul_f32 v77, v77, v81
  v_mfma_f32_16x16x32_bf16 v[44:47], a[28:31], v[96:99], v[44:47]
  ds_read_b128 v[92:95], v112 offset:20480
  v_mul_f32 v78, v78, v82
  v_mfma_f32_16x16x32_bf16 v[48:51], a[32:35], v[96:99], v[48:51]
  v_mul_f32 v79, v79, v83
  v_cvt_pk_bf16_f32 v116, v76, v77
  v_mfma_f32_16x16x32_bf16 v[52:55], a[24:27], v[100:103], v[52:55]
  v_cvt_pk_bf16_f32 v117, v78, v79
  v_mfma_f32_16x16x32_bf16 v[56:59], a[28:31], v[100:103], v[56:59]
  v_permlane16_swap_b32 v72, v84
  v_mfma_f32_16x16x32_bf16 v[60:63], a[32:35], v[100:103], v[60:63]
  s_waitcnt lgkmcnt(2)
  v_permlane16_swap_b32 v73, v85
  v_mfma_f32_16x16x32_bf16 v[40:43], a[36:39], v[104:107], v[40:43]
  ds_read_b128 v[96:99], v112 offset:5120
  v_mfma_f32_16x16x32_bf16 v[44:47], a[40:43], v[104:107], v[44:47]
  ds_read_b128 v[100:103], v112 offset:21504
  v_mfma_f32_16x16x32_bf16 v[48:51], a[44:47], v[104:107], v[48:51]
  v_permlane16_swap_b32 v74, v86
  v_mfma_f32_16x16x32_bf16 v[52:55], a[36:39], v[108:111], v[52:55]
  v_permlane16_swap_b32 v75, v87
  v_mfma_f32_16x16x32_bf16 v[56:59], a[40:43], v[108:111], v[56:59]
  v_permlane16_swap_b32 v114, v116
  v_mfma_f32_16x16x32_bf16 v[60:63], a[44:47], v[108:111], v[60:63]
  s_waitcnt lgkmcnt(2)
  v_permlane16_swap_b32 v115, v117
  v_mfma_f32_16x16x32_bf16 v[40:43], a[48:51], v[88:91], v[40:43]
  s_mov_b32 s15, 98304
  buffer_store_dwordx4 v[114:117], v10, s[16:19], s15 offen nt
  ds_read_b128 v[104:107], v112 offset:6144
  v_mfma_f32_16x16x32_bf16 v[44:47], a[52:55], v[88:91], v[44:47]
  ds_read_b128 v[108:111], v112 offset:22528
  v_max_f32 v72, 0, v72
  v_mfma_f32_16x16x32_bf16 v[48:51], a[56:59], v[88:91], v[48:51]
  v_max_f32 v73, 0, v73
  v_max_f32 v74, 0, v74
  v_mfma_f32_16x16x32_bf16 v[52:55], a[48:51], v[92:95], v[52:55]
  v_max_f32 v75, 0, v75
  v_mul_f32 v72, v72, v84
  v_mfma_f32_16x16x32_bf16 v[56:59], a[52:55], v[92:95], v[56:59]
  v_mul_f32 v73, v73, v85
  v_mul_f32 v74, v74, v86
  v_mfma_f32_16x16x32_bf16 v[60:63], a[56:59], v[92:95], v[60:63]
  s_waitcnt lgkmcnt(2)
  v_mul_f32 v75, v75, v87
  v_cvt_pk_bf16_f32 v118, v72, v73
  v_mfma_f32_16x16x32_bf16 v[40:43], a[60:63], v[96:99], v[40:43]
  ds_read_b128 v[88:91], v112 offset:7168
  v_cvt_pk_bf16_f32 v119, v74, v75
  v_mfma_f32_16x16x32_bf16 v[44:47], a[64:67], v[96:99], v[44:47]
  ds_read_b128 v[92:95], v112 offset:23552
  v_mov_b32 v120, v118
  v_mfma_f32_16x16x32_bf16 v[48:51], a[68:71], v[96:99], v[48:51]
  v_mov_b32 v121, v119
  s_nop 0
  v_mfma_f32_16x16x32_bf16 v[52:55], a[60:63], v[100:103], v[52:55]
  v_permlane32_swap_b32 v118, v120
  v_mfma_f32_16x16x32_bf16 v[56:59], a[64:67], v[100:103], v[56:59]
  v_permlane32_swap_b32 v119, v121
  v_mfma_f32_16x16x32_bf16 v[60:63], a[68:71], v[100:103], v[60:63]
  s_waitcnt lgkmcnt(2)
  buffer_store_dwordx4 v[118:121], v11, s[16:19], s15 offen nt
  v_mfma_f32_16x16x32_bf16 v[40:43], a[72:75], v[104:107], v[40:43]
  s_add_u32 s22, s23, 573696
  s_waitcnt vmcnt(2)
  v_cmp_ne_u32 vcc, s13, v123
  s_cbranch_vccnz LF_hfr_62
LF_hfb_64:
  ds_read_b128 v[96:99], v112 offset:8192
  v_mfma_f32_16x16x32_bf16 v[44:47], a[76:79], v[104:107], v[44:47]
  s_add_u32 m0, s54, 32768
  s_add_u32 s63, s52, 0
  ds_read_b128 v[100:103], v112 offset:24576
  v_mfma_f32_16x16x32_bf16 v[48:51], a[80:83], v[104:107], v[48:51]
  buffer_load_dwordx4 v9, s[16:19], s63 offen offset:0 sc1 lds
  v_mfma_f32_16x16x32_bf16 v[52:55], a[72:75], v[108:111], v[52:55]
  v_mfma_f32_16x16x32_bf16 v[56:59], a[76:79], v[108:111], v[56:59]
  v_mfma_f32_16x16x32_bf16 v[60:63], a[80:83], v[108:111], v[60:63]
  s_waitcnt lgkmcnt(2)
  buffer_load_dwordx4 v9, s[16:19], s63 offen offset:1024 sc1 lds
  v_mfma_f32_16x16x32_bf16 v[40:43], a[84:87], v[88:91], v[40:43]
  ds_read_b128 v[104:107], v112 offset:9216
  v_mfma_f32_16x16x32_bf16 v[44:47], a[88:91], v[88:91], v[44:47]
  ds_read_b128 v[108:111], v112 offset:25600
  v_mfma_f32_16x16x32_bf16 v[48:51], a[92:95], v[88:91], v[48:51]
  v_mfma_f32_16x16x32_bf16 v[52:55], a[84:87], v[92:95], v[52:55]
  buffer_load_dwordx4 v9, s[16:19], s63 offen offset:2048 sc1 lds
  v_mfma_f32_16x16x32_bf16 v[56:59], a[88:91], v[92:95], v[56:59]
  v_mfma_f32_16x16x32_bf16 v[60:63], a[92:95], v[92:95], v[60:63]
  s_waitcnt lgkmcnt(2)
  v_mfma_f32_16x16x32_bf16 v[40:43], a[96:99], v[96:99], v[40:43]
  ds_read_b128 v[88:91], v112 offset:10240
  v_mfma_f32_16x16x32_bf16 v[44:47], a[100:103], v[96:99], v[44:47]
  ds_read_b128 v[92:95], v112 offset:26624
  v_mfma_f32_16x16x32_bf16 v[48:51], a[104:107], v[96:99], v[48:51]
  buffer_load_dwordx4 v9, s[16:19], s63 offen offset:3072 sc1 lds
  s_add_u32 m0, s54, 131072
  s_add_u32 s63, s52, 8192
  v_mfma_f32_16x16x32_bf16 v[52:55], a[96:99], v[100:103], v[52:55]
  v_mfma_f32_16x16x32_bf16 v[56:59], a[100:103], v[100:103], v[56:59]
  v_mfma_f32_16x16x32_bf16 v[60:63], a[104:107], v[100:103], v[60:63]
  s_waitcnt lgkmcnt(2)
  v_mfma_f32_16x16x32_bf16 v[40:43], a[108:111], v[104:107], v[40:43]
  ds_read_b128 v[96:99], v112 offset:11264
  v_mfma_f32_16x16x32_bf16 v[44:47], a[112:115], v[104:107], v[44:47]
  buffer_load_dwordx4 v9, s[16:19], s63 offen offset:0 sc1 lds
  ds_read_b128 v[100:103], v112 offset:27648
  v_mfma_f32_16x16x32_bf16 v[48:51], a[116:119], v[104:107], v[48:51]
  v_mfma_f32_16x16x32_bf16 v[52:55], a[108:111], v[108:111], v[52:55]
  v_mfma_f32_16x16x32_bf16 v[56:59], a[112:115], v[108:111], v[56:59]
  v_mfma_f32_16x16x32_bf16 v[60:63], a[116:119], v[108:111], v[60:63]
  s_waitcnt lgkmcnt(2)
  v_mfma_f32_16x16x32_bf16 v[40:43], a[120:123], v[88:91], v[40:43]
  buffer_load_dwordx4 v9, s[16:19], s63 offen offset:1024 sc1 lds
  ds_read_b128 v[104:107], v112 offset:12288
  v_mfma_f32_16x16x32_bf16 v[44:47], a[124:127], v[88:91], v[44:47]
  ds_read_b128 v[108:111], v112 offset:28672
  v_mfma_f32_16x16x32_bf16 v[48:51], a[128:131], v[88:91], v[48:51]
  v_mfma_f32_16x16x32_bf16 v[52:55], a[120:123], v[92:95], v[52:55]
  v_mfma_f32_16x16x32_bf16 v[56:59], a[124:127], v[92:95], v[56:59]
  v_mfma_f32_16x16x32_bf16 v[60:63], a[128:131], v[92:95], v[60:63]
  s_waitcnt lgkmcnt(2)
  buffer_load_dwordx4 v9, s[16:19], s63 offen offset:2048 sc1 lds
  v_mfma_f32_16x16x32_bf16 v[40:43], a[132:135], v[96:99], v[40:43]
  ds_read_b128 v[88:91], v112 offset:13312
  v_mfma_f32_16x16x32_bf16 v[44:47], a[136:139], v[96:99], v[44:47]
  ds_read_b128 v[92:95], v112 offset:29696
  v_mfma_f32_16x16x32_bf16 v[48:51], a[140:143], v[96:99], v[48:51]
  v_mfma_f32_16x16x32_bf16 v[52:55], a[132:135], v[100:103], v[52:55]
  v_mfma_f32_16x16x32_bf16 v[56:59], a[136:139], v[100:103], v[56:59]
  buffer_load_dwordx4 v9, s[16:19], s63 offen offset:3072 sc1 lds
  s_add_u32 m0, s55, 0
  s_add_u32 s63, s53, 16384
  v_mfma_f32_16x16x32_bf16 v[60:63], a[140:143], v[100:103], v[60:63]
  s_waitcnt vmcnt(8)
  s_waitcnt lgkmcnt(2)
  buffer_store_dword v14, v2, s[16:19], s22 offen
  v_mfma_f32_16x16x32_bf16 v[40:43], a[144:147], v[104:107], v[40:43]
  ds_read_b128 v[96:99], v112 offset:14336
  v_mfma_f32_16x16x32_bf16 v[44:47], a[148:151], v[104:107], v[44:47]
  ds_read_b128 v[100:103], v112 offset:30720
  v_mfma_f32_16x16x32_bf16 v[48:51], a[152:155], v[104:107], v[48:51]
  v_mfma_f32_16x16x32_bf16 v[52:55], a[144:147], v[108:111], v[52:55]
  buffer_load_dwordx4 v9, s[16:19], s63 offen offset:0 sc1 lds
  v_mfma_f32_16x16x32_bf16 v[56:59], a[148:151], v[108:111], v[56:59]
  v_mfma_f32_16x16x32_bf16 v[60:63], a[152:155], v[108:111], v[60:63]
  s_waitcnt lgkmcnt(2)
  v_mfma_f32_16x16x32_bf16 v[40:43], a[156:159], v[88:91], v[40:43]
  ds_read_b128 v[104:107], v112 offset:15360
  v_mfma_f32_16x16x32_bf16 v[44:47], a[160:163], v[88:91], v[44:47]
  ds_read_b128 v[108:111], v112 offset:31744
  v_mfma_f32_16x16x32_bf16 v[48:51], a[164:167], v[88:91], v[48:51]
  buffer_load_dwordx4 v9, s[16:19], s63 offen offset:1024 sc1 lds
  v_mfma_f32_16x16x32_bf16 v[52:55], a[156:159], v[92:95], v[52:55]
  v_mfma_f32_16x16x32_bf16 v[56:59], a[160:163], v[92:95], v[56:59]
  v_mfma_f32_16x16x32_bf16 v[60:63], a[164:167], v[92:95], v[60:63]
  s_waitcnt lgkmcnt(2)
  v_mfma_f32_16x16x32_bf16 v[40:43], a[168:171], v[96:99], v[40:43]
  v_add_u32 v112, 65536, v1
  s_barrier
  ds_read_b128 v[88:91], v112 offset:32768
  v_mfma_f32_16x16x32_bf16 v[44:47], a[172:175], v[96:99], v[44:47]
  buffer_load_dwordx4 v9, s[16:19], s63 offen offset:2048 sc1 lds
  ds_read_b128 v[92:95], v112 offset:49152
  v_mfma_f32_16x16x32_bf16 v[48:51], a[176:179], v[96:99], v[48:51]
  v_mfma_f32_16x16x32_bf16 v[52:55], a[168:171], v[100:103], v[52:55]
  v_mfma_f32_16x16x32_bf16 v[56:59], a[172:175], v[100:103], v[56:59]
  v_mfma_f32_16x16x32_bf16 v[60:63], a[176:179], v[100:103], v[60:63]
  s_lshl_b32 s20, s69, 1
  s_add_u32 s20, s20, 573696
  s_waitcnt lgkmcnt(2)
  buffer_load_dword v123, v13, s[16:19], s20 offen sc1
  v_mfma_f32_16x16x32_bf16 v[40:43], a[180:183], v[104:107], v[40:43]
  ds_read_b128 v[96:99], v112 offset:33792
  v_mfma_f32_16x16x32_bf16 v[44:47], a[184:187], v[104:107], v[44:47]
  ds_read_b128 v[100:103], v112 offset:50176
  v_mfma_f32_16x16x32_bf16 v[48:51], a[188:191], v[104:107], v[48:51]
  v_mfma_f32_16x16x32_bf16 v[52:55], a[180:183], v[108:111], v[52:55]
  v_mfma_f32_16x16x32_bf16 v[56:59], a[184:187], v[108:111], v[56:59]
  v_mfma_f32_16x16x32_bf16 v[60:63], a[188:191], v[108:111], v[60:63]
  s_waitcnt lgkmcnt(2)
  v_mfma_f32_16x16x32_bf16 v[64:67], a[0:3], v[88:91], 0
  ds_read_b128 v[104:107], v112 offset:34816
  v_mfma_f32_16x16x32_bf16 v[68:71], a[4:7], v[88:91], 0
  ds_read_b128 v[108:111], v112 offset:51200
  v_max_f32 v40, 0, v40
  v_mfma_f32_16x16x32_bf16 v[72:75], a[8:11], v[88:91], 0
  v_max_f32 v41, 0, v41
  v_max_f32 v42, 0, v42
  v_mfma_f32_16x16x32_bf16 v[76:79], a[0:3], v[92:95], 0
  v_max_f32 v43, 0, v43
  v_mul_f32 v40, v40, v44
  v_mfma_f32_16x16x32_bf16 v[80:83], a[4:7], v[92:95], 0
  v_mul_f32 v41, v41, v45
  v_mul_f32 v42, v42, v46
  v_mfma_f32_16x16x32_bf16 v[84:87], a[8:11], v[92:95], 0
  s_waitcnt lgkmcnt(2)
  v_mul_f32 v43, v43, v47
  v_cvt_pk_bf16_f32 v114, v40, v41
  v_mfma_f32_16x16x32_bf16 v[64:67], a[12:15], v[96:99], v[64:67]
  ds_read_b128 v[88:91], v112 offset:35840
  v_cvt_pk_bf16_f32 v115, v42, v43
  v_mfma_f32_16x16x32_bf16 v[68:71], a[16:19], v[96:99], v[68:71]
  ds_read_b128 v[92:95], v112 offset:52224
  v_max_f32 v52, 0, v52
  v_mfma_f32_16x16x32_bf16 v[72:75], a[20:23], v[96:99], v[72:75]
  v_max_f32 v53, 0, v53
  v_max_f32 v54, 0, v54
  v_mfma_f32_16x16x32_bf16 v[76:79], a[12:15], v[100:103], v[76:79]
  v_max_f32 v55, 0, v55
  v_mul_f32 v52, v52, v56
  v_mfma_f32_16x16x32_bf16 v[80:83], a[16:19], v[100:103], v[80:83]
  v_mul_f32 v53, v53, v57
  v_mul_f32 v54, v54, v58
  v_mfma_f32_16x16x32_bf16 v[84:87], a[20:23], v[100:103], v[84:87]
  s_waitcnt lgkmcnt(2)
  v_mul_f32 v55, v55, v59
  v_cvt_pk_bf16_f32 v116, v52, v53
  v_mfma_f32_16x16x32_bf16 v[64:67], a[24:27], v[104:107], v[64:67]
  ds_read_b128 v[96:99], v112 offset:36864
  v_cvt_pk_bf16_f32 v117, v54, v55
  v_mfma_f32_16x16x32_bf16 v[68:71], a[28:31], v[104:107], v[68:71]
  ds_read_b128 v[100:103], v112 offset:53248
  v_mfma_f32_16x16x32_bf16 v[72:75], a[32:35], v[104:107], v[72:75]
  v_permlane16_swap_b32 v48, v60
  v_mfma_f32_16x16x32_bf16 v[76:79], a[24:27], v[108:111], v[76:79]
  v_permlane16_swap_b32 v49, v61
  v_mfma_f32_16x16x32_bf16 v[80:83], a[28:31], v[108:111], v[80:83]
  s_waitcnt vmcnt(0)
  v_cmp_ne_u32 vcc, s13, v123
  s_cbranch_vccnz LF_hfr_65
LF_hfb_67:
  v_mfma_f32_16x16x32_bf16 v[84:87], a[32:35], v[108:111], v[84:87]
  s_add_u32 m0, s54, 40960
  s_add_u32 s63, s52, 98304
  s_waitcnt lgkmcnt(2)
  buffer_load_dwordx4 v9, s[16:19], s63 offen offset:0 sc1 lds
  v_mfma_f32_16x16x32_bf16 v[64:67], a[36:39], v[88:91], v[64:67]
  ds_read_b128 v[104:107], v112 offset:37888
  v_mfma_f32_16x16x32_bf16 v[68:71], a[40:43], v[88:91], v[68:71]
  buffer_load_dwordx4 v9, s[16:19], s63 offen offset:1024 sc1 lds
  ds_read_b128 v[108:111], v112 offset:54272
  v_mfma_f32_16x16x32_bf16 v[72:75], a[44:47], v[88:91], v[72:75]
  v_permlane16_swap_b32 v50, v62
  v_mfma_f32_16x16x32_bf16 v[76:79], a[36:39], v[92:95], v[76:79]
  v_permlane16_swap_b32 v51, v63
  v_mfma_f32_16x16x32_bf16 v[80:83], a[40:43], v[92:95], v[80:83]
  v_permlane16_swap_b32 v114, v116
  v_mfma_f32_16x16x32_bf16 v[84:87], a[44:47], v[92:95], v[84:87]
  s_waitcnt lgkmcnt(2)
  v_permlane16_swap_b32 v115, v117
  v_mfma_f32_16x16x32_bf16 v[64:67], a[48:51], v[96:99], v[64:67]
  s_mov_b32 s15, 196608
  buffer_load_dwordx4 v9, s[16:19], s63 offen offset:2048 sc1 lds
  ds_read_b128 v[88:91], v112 offset:38912
  v_mfma_f32_16x16x32_bf16 v[68:71], a[52:55], v[96:99], v[68:71]
  buffer_store_dwordx4 v[114:117], v10, s[16:19], s15 offen nt
  ds_read_b128 v[92:95], v112 offset:55296
  v_mfma_f32_16x16x32_bf16 v[72:75], a[56:59], v[96:99], v[72:75]
  v_max_f32 v48, 0, v48
  v_max_f32 v49, 0, v49
  v_mfma_f32_16x16x32_bf16 v[76:79], a[48:51], v[100:103], v[76:79]
  v_max_f32 v50, 0, v50
  v_max_f32 v51, 0, v51
  v_mfma_f32_16x16x32_bf16 v[80:83], a[52:55], v[100:103], v[80:83]
  v_mul_f32 v48, v48, v60
  v_mul_f32 v49, v49, v61
  v_mfma_f32_16x16x32_bf16 v[84:87], a[56:59], v[100:103], v[84:87]
  s_waitcnt lgkmcnt(2)
  v_mul_f32 v50, v50, v62
  v_mul_f32 v51, v51, v63
  v_mfma_f32_16x16x32_bf16 v[64:67], a[60:63], v[104:107], v[64:67]
  ds_read_b128 v[96:99], v112 offset:39936
  v_cvt_pk_bf16_f32 v118, v48, v49
  v_mfma_f32_16x16x32_bf16 v[68:71], a[64:67], v[104:107], v[68:71]
  ds_read_b128 v[100:103], v112 offset:56320
  v_cvt_pk_bf16_f32 v119, v50, v51
  v_mfma_f32_16x16x32_bf16 v[72:75], a[68:71], v[104:107], v[72:75]
  v_mov_b32 v120, v118
  v_mov_b32 v121, v119
  s_nop 0
  v_mfma_f32_16x16x32_bf16 v[76:79], a[60:63], v[108:111], v[76:79]
  buffer_load_dwordx4 v9, s[16:19], s63 offen offset:3072 sc1 lds
  s_add_u32 m0, s54, 139264
  s_add_u32 s63, s52, 106496
  v_mfma_f32_16x16x32_bf16 v[80:83], a[64:67], v[108:111], v[80:83]
  v_permlane32_swap_b32 v118, v120
  v_mfma_f32_16x16x32_bf16 v[84:87], a[68:71], v[108:111], v[84:87]
  s_waitcnt lgkmcnt(2)
  v_permlane32_swap_b32 v119, v121
  v_mfma_f32_16x16x32_bf16 v[64:67], a[72:75], v[88:91], v[64:67]
  s_add_u32 s24, s73, 131072
  buffer_store_dwordx4 v[118:121], v11, s[16:19], s15 offen nt
  ds_read_b128 v[104:107], v112 offset:40960
  v_mfma_f32_16x16x32_bf16 v[68:71], a[76:79], v[88:91], v[68:71]
  s_add_u32 s22, s23, 573952
  buffer_load_dwordx4 v[140:143], v7, s[16:19], s24 offen sc1
  ds_read_b128 v[108:111], v112 offset:57344
  v_mfma_f32_16x16x32_bf16 v[72:75], a[80:83], v[88:91], v[72:75]
  v_mfma_f32_16x16x32_bf16 v[76:79], a[72:75], v[92:95], v[76:79]
  v_mfma_f32_16x16x32_bf16 v[80:83], a[76:79], v[92:95], v[80:83]
  v_mfma_f32_16x16x32_bf16 v[84:87], a[80:83], v[92:95], v[84:87]
  s_waitcnt lgkmcnt(2)
  v_mfma_f32_16x16x32_bf16 v[64:67], a[84:87], v[96:99], v[64:67]
  ds_read_b128 v[88:91], v112 offset:41984
  v_mfma_f32_16x16x32_bf16 v[68:71], a[88:91], v[96:99], v[68:71]
  buffer_load_dwordx4 v9, s[16:19], s63 offen offset:0 sc1 lds
  ds_read_b128 v[92:95], v112 offset:58368
  v_mfma_f32_16x16x32_bf16 v[72:75], a[92:95], v[96:99], v[72:75]
  v_mfma_f32_16x16x32_bf16 v[76:79], a[84:87], v[100:103], v[76:79]
  v_mfma_f32_16x16x32_bf16 v[80:83], a[88:91], v[100:103], v[80:83]
  v_mfma_f32_16x16x32_bf16 v[84:87], a[92:95], v[100:103], v[84:87]
  s_waitcnt lgkmcnt(2)
  v_mfma_f32_16x16x32_bf16 v[64:67], a[96:99], v[104:107], v[64:67]
  buffer_load_dwordx4 v9, s[16:19], s63 offen offset:1024 sc1 lds
  ds_read_b128 v[96:99], v112 offset:43008
  v_mfma_f32_16x16x32_bf16 v[68:71], a[100:103], v[104:107], v[68:71]
  ds_read_b128 v[100:103], v112 offset:59392
  v_mfma_f32_16x16x32_bf16 v[72:75], a[104:107], v[104:107], v[72:75]
  v_mfma_f32_16x16x32_bf16 v[76:79], a[96:99], v[108:111], v[76:79]
  v_mfma_f32_16x16x32_bf16 v[80:83], a[100:103], v[108:111], v[80:83]
  v_mfma_f32_16x16x32_bf16 v[84:87], a[104:107], v[108:111], v[84:87]
  s_waitcnt lgkmcnt(2)
  buffer_load_dwordx4 v9, s[16:19], s63 offen offset:2048 sc1 lds
  v_mfma_f32_16x16x32_bf16 v[64:67], a[108:111], v[88:91], v[64:67]
  ds_read_b128 v[104:107], v112 offset:44032
  v_mfma_f32_16x16x32_bf16 v[68:71], a[112:115], v[88:91], v[68:71]
  ds_read_b128 v[108:111], v112 offset:60416
  v_mfma_f32_16x16x32_bf16 v[72:75], a[116:119], v[88:91], v[72:75]
  v_mfma_f32_16x16x32_bf16 v[76:79], a[108:111], v[92:95], v[76:79]
  v_mfma_f32_16x16x32_bf16 v[80:83], a[112:115], v[92:95], v[80:83]
  buffer_load_dwordx4 v9, s[16:19], s63 offen offset:3072 sc1 lds
  s_add_u32 m0, s55, 8192
  s_add_u32 s63, s53, 114688
  v_mfma_f32_16x16x32_bf16 v[84:87], a[116:119], v[92:95], v[84:87]
  s_waitcnt lgkmcnt(2)
  v_mfma_f32_16x16x32_bf16 v[64:67], a[120:123], v[96:99], v[64:67]
  ds_read_b128 v[88:91], v112 offset:45056
  v_mfma_f32_16x16x32_bf16 v[68:71], a[124:127], v[96:99], v[68:71]
  ds_read_b128 v[92:95], v112 offset:61440
  v_mfma_f32_16x16x32_bf16 v[72:75], a[128:131], v[96:99], v[72:75]
  buffer_load_dwordx4 v9, s[16:19], s63 offen offset:0 sc1 lds
  v_mfma_f32_16x16x32_bf16 v[76:79], a[120:123], v[100:103], v[76:79]
  v_mfma_f32_16x16x32_bf16 v[80:83], a[124:127], v[100:103], v[80:83]
  v_mfma_f32_16x16x32_bf16 v[84:87], a[128:131], v[100:103], v[84:87]
  s_waitcnt lgkmcnt(2)
  v_mfma_f32_16x16x32_bf16 v[64:67], a[132:135], v[104:107], v[64:67]
  ds_read_b128 v[96:99], v112 offset:46080
  v_mfma_f32_16x16x32_bf16 v[68:71], a[136:139], v[104:107], v[68:71]
  buffer_load_dwordx4 v9, s[16:19], s63 offen offset:1024 sc1 lds
  ds_read_b128 v[100:103], v112 offset:62464
  v_mfma_f32_16x16x32_bf16 v[72:75], a[140:143], v[104:107], v[72:75]
  v_mfma_f32_16x16x32_bf16 v[76:79], a[132:135], v[108:111], v[76:79]
  v_mfma_f32_16x16x32_bf16 v[80:83], a[136:139], v[108:111], v[80:83]
  v_mfma_f32_16x16x32_bf16 v[84:87], a[140:143], v[108:111], v[84:87]
  s_waitcnt lgkmcnt(2)
  v_mfma_f32_16x16x32_bf16 v[64:67], a[144:147], v[88:91], v[64:67]
  buffer_load_dwordx4 v9, s[16:19], s63 offen offset:2048 sc1 lds
  ds_read_b128 v[104:107], v112 offset:47104
  v_mfma_f32_16x16x32_bf16 v[68:71], a[148:151], v[88:91], v[68:71]
  ds_read_b128 v[108:111], v112 offset:63488
  v_mfma_f32_16x16x32_bf16 v[72:75], a[152:155], v[88:91], v[72:75]
  v_mfma_f32_16x16x32_bf16 v[76:79], a[144:147], v[92:95], v[76:79]
  v_mfma_f32_16x16x32_bf16 v[80:83], a[148:151], v[92:95], v[80:83]
  v_mfma_f32_16x16x32_bf16 v[84:87], a[152:155], v[92:95], v[84:87]
  s_waitcnt vmcnt(8)
  s_waitcnt lgkmcnt(2)
  buffer_store_dword v14, v2, s[16:19], s22 offen
  v_mfma_f32_16x16x32_bf16 v[64:67], a[156:159], v[96:99], v[64:67]
  ds_read_b128 v[88:91], v112 offset:48128
  v_mfma_f32_16x16x32_bf16 v[68:71], a[160:163], v[96:99], v[68:71]
  ds_read_b128 v[92:95], v112 offset:64512
  v_mfma_f32_16x16x32_bf16 v[72:75], a[164:167], v[96:99], v[72:75]
  v_mfma_f32_16x16x32_bf16 v[76:79], a[156:159], v[100:103], v[76:79]
  v_mfma_f32_16x16x32_bf16 v[80:83], a[160:163], v[100:103], v[80:83]
  v_mfma_f32_16x16x32_bf16 v[84:87], a[164:167], v[100:103], v[84:87]
  s_waitcnt lgkmcnt(2)
  v_mfma_f32_16x16x32_bf16 v[64:67], a[168:171], v[104:107], v[64:67]
  s_add_u32 s25, s66, 0
  v_add_u32 v112, s25, v1
  s_add_u32 s25, s67, 0
  v_add_u32 v113, s25, v1
  s_barrier
  ds_read_b128 v[56:59], v113 offset:32768
  v_mfma_f32_16x16x32_bf16 v[68:71], a[172:175], v[104:107], v[68:71]
  ds_read_b128 v[60:63], v112 offset:32768
  v_mfma_f32_16x16x32_bf16 v[72:75], a[176:179], v[104:107], v[72:75]
  v_mfma_f32_16x16x32_bf16 v[76:79], a[168:171], v[108:111], v[76:79]
  v_mfma_f32_16x16x32_bf16 v[80:83], a[172:175], v[108:111], v[80:83]
  ds_read_b128 v[96:99], v113 offset:33792
  v_mfma_f32_16x16x32_bf16 v[84:87], a[176:179], v[108:111], v[84:87]
  s_waitcnt lgkmcnt(3)
  ds_read_b128 v[100:103], v112 offset:33792
  v_mfma_f32_16x16x32_bf16 v[64:67], a[180:183], v[88:91], v[64:67]
  v_mfma_f32_16x16x32_bf16 v[68:71], a[184:187], v[88:91], v[68:71]
  v_mfma_f32_16x16x32_bf16 v[72:75], a[188:191], v[88:91], v[72:75]
  ds_read_b128 v[104:107], v113 offset:34816
  v_mfma_f32_16x16x32_bf16 v[76:79], a[180:183], v[92:95], v[76:79]
  ds_read_b128 v[108:111], v112 offset:34816
  v_mfma_f32_16x16x32_bf16 v[80:83], a[184:187], v[92:95], v[80:83]
  v_mfma_f32_16x16x32_bf16 v[84:87], a[188:191], v[92:95], v[84:87]
  s_lshl_b32 s20, s69, 1
  s_add_u32 s20, s20, 573952
  s_waitcnt lgkmcnt(4)
  buffer_load_dword v123, v13, s[16:19], s20 offen sc1
  v_mfma_f32_16x16x32_bf16 v[48:51], v[144:147], v[56:59], 0
  ds_read_b128 v[88:91], v113 offset:35840
  v_max_f32 v64, 0, v64
  v_max_f32 v65, 0, v65
  v_max_f32 v66, 0, v66
  v_max_f32 v67, 0, v67
  v_mfma_f32_16x16x32_bf16 v[52:55], v[148:151], v[56:59], 0
  ds_read_b128 v[92:95], v112 offset:35840
  v_mul_f32 v64, v64, v68
  v_mul_f32 v65, v65, v69
  v_mul_f32 v66, v66, v70
  v_mul_f32 v67, v67, v71
  v_mfma_f32_16x16x32_bf16 v[40:43], v[144:147], v[60:63], 0
  v_cvt_pk_bf16_f32 v114, v64, v65
  v_cvt_pk_bf16_f32 v115, v66, v67
  v_max_f32 v76, 0, v76
  v_max_f32 v77, 0, v77
  v_max_f32 v78, 0, v78
  v_mfma_f32_16x16x32_bf16 v[44:47], v[148:151], v[60:63], 0
  s_waitcnt lgkmcnt(4)
  v_max_f32 v79, 0, v79
  v_mul_f32 v76, v76, v80
  v_mul_f32 v77, v77, v81
  v_mul_f32 v78, v78, v82
  v_mul_f32 v79, v79, v83
  v_mfma_f32_16x16x32_bf16 v[48:51], v[152:155], v[96:99], v[48:51]
  ds_read_b128 v[56:59], v113 offset:36864
  v_cvt_pk_bf16_f32 v116, v76, v77
  v_cvt_pk_bf16_f32 v117, v78, v79
  v_permlane16_swap_b32 v72, v84
  v_mfma_f32_16x16x32_bf16 v[52:55], v[156:159], v[96:99], v[52:55]
  ds_read_b128 v[60:63], v112 offset:36864
  v_permlane16_swap_b32 v73, v85
  v_permlane16_swap_b32 v74, v86
  v_mfma_f32_16x16x32_bf16 v[40:43], v[152:155], v[100:103], v[40:43]
  v_permlane16_swap_b32 v75, v87
  v_permlane16_swap_b32 v114, v116
  v_mfma_f32_16x16x32_bf16 v[44:47], v[156:159], v[100:103], v[44:47]
  s_mov_b32 s15, 0
  s_waitcnt lgkmcnt(4)
  v_permlane16_swap_b32 v115, v117
  buffer_store_dwordx4 v[114:117], v136, s[16:19], s15 offen nt
  v_max_f32 v72, 0, v72
  v_mfma_f32_16x16x32_bf16 v[48:51], v[160:163], v[104:107], v[48:51]
  ds_read_b128 v[96:99], v113 offset:37888
  v_max_f32 v73, 0, v73
  v_max_f32 v74, 0, v74
  v_max_f32 v75, 0, v75
  v_mul_f32 v72, v72, v84
  v_mfma_f32_16x16x32_bf16 v[52:55], v[164:167], v[104:107], v[52:55]
  ds_read_b128 v[100:103], v112 offset:37888
  v_mul_f32 v73, v73, v85
  v_mul_f32 v74, v74, v86
  v_mul_f32 v75, v75, v87
  v_cvt_pk_bf16_f32 v118, v72, v73
  v_mfma_f32_16x16x32_bf16 v[40:43], v[160:163], v[108:111], v[40:43]
  v_cvt_pk_bf16_f32 v119, v74, v75
  v_mov_b32 v120, v118
  v_mov_b32 v121, v119
  s_nop 0
  v_permlane32_swap_b32 v118, v120
  v_mfma_f32_16x16x32_bf16 v[44:47], v[164:167], v[108:111], v[44:47]
  s_waitcnt vmcnt(10)
  s_waitcnt lgkmcnt(4)
  v_permlane32_swap_b32 v119, v121
  buffer_store_dwordx4 v[118:121], v138, s[16:19], s15 offen nt
  v_max3_u32 v124, v140, v141, v142
  v_mfma_f32_16x16x32_bf16 v[48:51], v[168:171], v[88:91], v[48:51]
  s_add_u32 s22, s23, 574208
  ds_read_b128 v[104:107], v113 offset:38912
  v_max_u32 v124, v124, v143
  v_mfma_f32_16x16x32_bf16 v[52:55], v[172:175], v[88:91], v[52:55]
  s_waitcnt vmcnt(2)
  v_cmp_ne_u32 vcc, s13, v123
  s_cbranch_vccnz LF_hfr_68
LF_hfb_70:
  ds_read_b128 v[108:111], v112 offset:38912
  v_mfma_f32_16x16x32_bf16 v[40:43], v[168:171], v[92:95], v[40:43]
  s_add_u32 m0, s54, 65536
  s_add_u32 s63, s52, 196608
  buffer_load_dwordx4 v9, s[16:19], s63 offen offset:0 sc1 lds
  v_cmp_eq_u32 vcc, -1, v124
  s_cbranch_vccnz LF_s5r_56
LF_s5b_58:
  v_mfma_f32_16x16x32_bf16 v[44:47], v[172:175], v[92:95], v[44:47]
  s_waitcnt lgkmcnt(4)
  v_add_f32 v140, v140, v141
  v_add_f32 v142, v142, v143
  v_mfma_f32_16x16x32_bf16 v[48:51], v[176:179], v[56:59], v[48:51]
  buffer_load_dwordx4 v9, s[16:19], s63 offen offset:1024 sc1 lds
  ds_read_b128 v[88:91], v113 offset:39936
  v_mfma_f32_16x16x32_bf16 v[52:55], v[180:183], v[56:59], v[52:55]
  ds_read_b128 v[92:95], v112 offset:39936
  v_add_f32 v140, v140, v142
  v_mfma_f32_16x16x32_bf16 v[40:43], v[176:179], v[60:63], v[40:43]
  v_mov_b32 v141, v140
  s_nop 0
  v_mfma_f32_16x16x32_bf16 v[44:47], v[180:183], v[60:63], v[44:47]
  s_waitcnt lgkmcnt(4)
  v_permlane32_swap_b32 v140, v141
  v_mfma_f32_16x16x32_bf16 v[48:51], v[184:187], v[96:99], v[48:51]
  s_add_u32 s25, s66, 131072
  v_add_u32 v112, s25, v1
  s_add_u32 s25, s67, 131072
  v_add_u32 v113, s25, v1
  s_barrier
  ds_read_b128 v[56:59], v113 offset:0
  v_mfma_f32_16x16x32_bf16 v[52:55], v[188:191], v[96:99], v[52:55]
  buffer_load_dwordx4 v9, s[16:19], s63 offen offset:2048 sc1 lds
  ds_read_b128 v[60:63], v112 offset:0
  v_mfma_f32_16x16x32_bf16 v[40:43], v[184:187], v[100:103], v[40:43]
  v_add_f32 v140, v140, v141
  v_mov_b32 v141, v140
  s_nop 0
  v_mfma_f32_16x16x32_bf16 v[44:47], v[188:191], v[100:103], v[44:47]
  buffer_load_dwordx4 v9, s[16:19], s63 offen offset:3072 sc1 lds
  s_add_u32 m0, s54, 98304
  s_add_u32 s63, s52, 204800
  s_waitcnt lgkmcnt(4)
  v_mfma_f32_16x16x32_bf16 v[48:51], v[192:195], v[104:107], v[48:51]
  ds_read_b128 v[96:99], v113 offset:1024
  v_mfma_f32_16x16x32_bf16 v[52:55], v[196:199], v[104:107], v[52:55]
  ds_read_b128 v[100:103], v112 offset:1024
  v_mfma_f32_16x16x32_bf16 v[40:43], v[192:195], v[108:111], v[40:43]
  v_permlane16_swap_b32 v140, v141
  v_mfma_f32_16x16x32_bf16 v[44:47], v[196:199], v[108:111], v[44:47]
  s_waitcnt lgkmcnt(4)
  v_add_f32 v140, v140, v141
  v_mul_f32 v140, 0x3b000000, v140
  v_mfma_f32_16x16x32_bf16 v[48:51], v[200:203], v[88:91], v[48:51]
  buffer_load_dwordx4 v9, s[16:19], s63 offen offset:0 sc1 lds
  ds_read_b128 v[104:107], v113 offset:2048
  v_mfma_f32_16x16x32_bf16 v[52:55], v[204:207], v[88:91], v[52:55]
  ds_read_b128 v[108:111], v112 offset:2048
  v_add_f32 v140, 0x3727c5ac, v140
  v_mfma_f32_16x16x32_bf16 v[40:43], v[200:203], v[92:95], v[40:43]
  s_add_u32 s3, s65, 6144
  v_rcp_f32 v15, v140
  v_add_u32 v114, s3, v1
  v_mfma_f32_16x16x32_bf16 v[44:47], v[204:207], v[92:95], v[44:47]
  s_xor_b32 s3, s65, 16384
  s_add_u32 s3, s3, 6144
  s_waitcnt lgkmcnt(4)
  v_add_u32 v115, s3, v1
  v_mfma_f32_16x16x32_bf16 v[48:51], v[208:211], v[56:59], v[48:51]
  s_add_u32 s24, s73, 196608
  buffer_load_dwordx4 v9, s[16:19], s63 offen offset:1024 sc1 lds
  ds_read_b128 v[88:91], v113 offset:3072
  v_mfma_f32_16x16x32_bf16 v[52:55], v[212:215], v[56:59], v[52:55]
  buffer_load_dwordx4 v[140:143], v7, s[16:19], s24 offen sc1
  ds_read_b128 v[92:95], v112 offset:3072
  v_mfma_f32_16x16x32_bf16 v[40:43], v[208:211], v[60:63], v[40:43]
  v_mfma_f32_16x16x32_bf16 v[44:47], v[212:215], v[60:63], v[44:47]
  s_waitcnt lgkmcnt(4)
  v_mfma_f32_16x16x32_bf16 v[48:51], v[216:219], v[96:99], v[48:51]
  ds_read_b128 v[56:59], v113 offset:4096
  v_mfma_f32_16x16x32_bf16 v[52:55], v[220:223], v[96:99], v[52:55]
  ds_read_b128 v[60:63], v112 offset:4096
  v_mfma_f32_16x16x32_bf16 v[40:43], v[216:219], v[100:103], v[40:43]
  v_mfma_f32_16x16x32_bf16 v[44:47], v[220:223], v[100:103], v[44:47]
  s_waitcnt lgkmcnt(4)
  buffer_load_dwordx4 v9, s[16:19], s63 offen offset:2048 sc1 lds
  v_mfma_f32_16x16x32_bf16 v[48:51], v[224:227], v[104:107], v[48:51]
  ds_read_b128 v[96:99], v113 offset:5120
  v_mfma_f32_16x16x32_bf16 v[52:55], v[228:231], v[104:107], v[52:55]
  ds_read_b128 v[100:103], v112 offset:5120
  v_mfma_f32_16x16x32_bf16 v[40:43], v[224:227], v[108:111], v[40:43]
  v_mfma_f32_16x16x32_bf16 v[44:47], v[228:231], v[108:111], v[44:47]
  s_waitcnt lgkmcnt(4)
  buffer_load_dwordx4 v9, s[16:19], s63 offen offset:3072 sc1 lds
  v_mfma_f32_16x16x32_bf16 v[48:51], v[232:235], v[88:91], v[48:51]
  s_waitcnt vmcnt(9)
  buffer_store_dword v14, v2, s[16:19], s22 offen
  ds_read_b128 v[104:107], v113 offset:6144
  v_mfma_f32_16x16x32_bf16 v[52:55], v[236:239], v[88:91], v[52:55]
  ds_read_b128 v[108:111], v112 offset:6144
  v_mfma_f32_16x16x32_bf16 v[40:43], v[232:235], v[92:95], v[40:43]
  v_mfma_f32_16x16x32_bf16 v[44:47], v[236:239], v[92:95], v[44:47]
  s_waitcnt lgkmcnt(4)
  v_mfma_f32_16x16x32_bf16 v[48:51], v[240:243], v[56:59], v[48:51]
  ds_read_b128 v[88:91], v113 offset:7168
  v_mfma_f32_16x16x32_bf16 v[52:55], v[244:247], v[56:59], v[52:55]
  ds_read_b128 v[92:95], v112 offset:7168
  v_mfma_f32_16x16x32_bf16 v[40:43], v[240:243], v[60:63], v[40:43]
  v_mfma_f32_16x16x32_bf16 v[44:47], v[244:247], v[60:63], v[44:47]
  s_waitcnt lgkmcnt(4)
  v_mfma_f32_16x16x32_bf16 v[48:51], v[248:251], v[96:99], v[48:51]
  s_add_u32 s25, s66, 0
  v_add_u32 v112, s25, v1
  s_add_u32 s25, s67, 0
  v_add_u32 v113, s25, v1
  s_barrier
  ds_read_b128 v[56:59], v113 offset:0
  v_mfma_f32_16x16x32_bf16 v[52:55], v[252:255], v[96:99], v[52:55]
  s_add_u32 m0, s55, 32768
  s_add_u32 s63, s53, 212992
  ds_read_b128 v[60:63], v112 offset:0
  v_mfma_f32_16x16x32_bf16 v[40:43], v[248:251], v[100:103], v[40:43]
  buffer_load_dwordx4 v9, s[16:19], s63 offen offset:0 sc1 lds
  v_mfma_f32_16x16x32_bf16 v[44:47], v[252:255], v[100:103], v[44:47]
  s_waitcnt lgkmcnt(4)
  v_mfma_f32_16x16x32_bf16 v[48:51], a[192:195], v[104:107], v[48:51]
  buffer_load_dwordx4 v9, s[16:19], s63 offen offset:1024 sc1 lds
  ds_read_b128 v[96:99], v113 offset:1024
  v_mfma_f32_16x16x32_bf16 v[52:55], a[196:199], v[104:107], v[52:55]
  ds_read_b128 v[100:103], v112 offset:1024
  v_mfma_f32_16x16x32_bf16 v[40:43], a[192:195], v[108:111], v[40:43]
  v_mfma_f32_16x16x32_bf16 v[44:47], a[196:199], v[108:111], v[44:47]
  s_waitcnt lgkmcnt(4)
  v_mfma_f32_16x16x32_bf16 v[48:51], a[200:203], v[88:91], v[48:51]
  s_lshl_b32 s20, s69, 1
  s_add_u32 s20, s20, 574208
  ds_read_b128 v[104:107], v113 offset:2048
  v_mfma_f32_16x16x32_bf16 v[52:55], a[204:207], v[88:91], v[52:55]
  buffer_load_dword v123, v13, s[16:19], s20 offen sc1
  ds_read_b128 v[108:111], v112 offset:2048
  v_mfma_f32_16x16x32_bf16 v[40:43], a[200:203], v[92:95], v[40:43]
  buffer_load_dwordx4 v9, s[16:19], s63 offen offset:2048 sc1 lds
  v_mfma_f32_16x16x32_bf16 v[44:47], a[204:207], v[92:95], v[44:47]
  s_waitcnt lgkmcnt(4)
  v_mfma_f32_16x16x32_bf16 v[48:51], a[208:211], v[56:59], v[48:51]
  ds_read_b128 v[88:91], v113 offset:3072
  v_mfma_f32_16x16x32_bf16 v[52:55], a[212:215], v[56:59], v[52:55]
  ds_read_b128 v[92:95], v112 offset:3072
  v_mfma_f32_16x16x32_bf16 v[40:43], a[208:211], v[60:63], v[40:43]
  v_mfma_f32_16x16x32_bf16 v[44:47], a[212:215], v[60:63], v[44:47]
  s_waitcnt lgkmcnt(4)
  v_mfma_f32_16x16x32_bf16 v[48:51], a[216:219], v[96:99], v[48:51]
  ds_read_b128 v[56:59], v113 offset:4096
  v_mfma_f32_16x16x32_bf16 v[52:55], a[220:223], v[96:99], v[52:55]
  ds_read_b128 v[60:63], v112 offset:4096
  v_mfma_f32_16x16x32_bf16 v[40:43], a[216:219], v[100:103], v[40:43]
  v_mfma_f32_16x16x32_bf16 v[44:47], a[220:223], v[100:103], v[44:47]
  s_waitcnt lgkmcnt(4)
  v_mfma_f32_16x16x32_bf16 v[48:51], a[224:227], v[104:107], v[48:51]
  ds_read_b128 v[96:99], v113 offset:5120
  v_mfma_f32_16x16x32_bf16 v[52:55], a[228:231], v[104:107], v[52:55]
  ds_read_b128 v[100:103], v112 offset:5120
  v_mfma_f32_16x16x32_bf16 v[40:43], a[224:227], v[108:111], v[40:43]
  v_mfma_f32_16x16x32_bf16 v[44:47], a[228:231], v[108:111], v[44:47]
  s_waitcnt lgkmcnt(4)
  v_mfma_f32_16x16x32_bf16 v[48:51], a[232:235], v[88:91], v[48:51]
  s_lshl_b32 s25, s11, 14
  s_add_u32 s25, s25, 65536
  s_waitcnt vmcnt(5)
  v_add_u32 v112, s25, v1
  s_barrier
  ds_read_b128 v[104:107], v112 offset:0
  v_mfma_f32_16x16x32_bf16 v[52:55], a[236:239], v[88:91], v[52:55]
  v_mfma_f32_16x16x32_bf16 v[40:43], a[232:235], v[92:95], v[40:43]
  ds_read_b128 v[108:111], v112 offset:1024
  v_mfma_f32_16x16x32_bf16 v[44:47], a[236:239], v[92:95], v[44:47]
  s_waitcnt lgkmcnt(4)
  v_mfma_f32_16x16x32_bf16 v[48:51], a[240:243], v[56:59], v[48:51]
  ds_read_b128 v[88:91], v112 offset:2048
  v_mfma_f32_16x16x32_bf16 v[52:55], a[244:247], v[56:59], v[52:55]
  v_mfma_f32_16x16x32_bf16 v[40:43], a[240:243], v[60:63], v[40:43]
  ds_read_b128 v[92:95], v112 offset:3072
  v_mfma_f32_16x16x32_bf16 v[44:47], a[244:247], v[60:63], v[44:47]
  s_waitcnt vmcnt(1)
  v_cmp_ne_u32 vcc, s13, v123
  s_cbranch_vccnz LF_hfr_71
LF_hfb_73:
  s_waitcnt lgkmcnt(4)
  v_mfma_f32_16x16x32_bf16 v[48:51], a[248:251], v[96:99], v[48:51]
  s_add_u32 m0, s54, 73728
  s_add_u32 s63, s52, 0
  ds_read_b128 v[56:59], v112 offset:4096
  v_mfma_f32_16x16x32_bf16 v[52:55], a[252:255], v[96:99], v[52:55]
  buffer_load_dwordx4 v135, s[16:19], s63 offen offset:0 sc1 lds
  v_mfma_f32_16x16x32_bf16 v[40:43], a[248:251], v[100:103], v[40:43]
  ds_read_b128 v[60:63], v112 offset:5120
  v_mfma_f32_16x16x32_bf16 v[44:47], a[252:255], v[100:103], v[44:47]
  s_waitcnt lgkmcnt(5)
  buffer_load_dwordx4 v135, s[16:19], s63 offen offset:1024 sc1 lds
  v_mfma_f32_16x16x32_bf16 v[64:67], v[144:147], v[104:107], 0
  ds_write_b128 v114, v[48:51]
  ds_read_b128 v[96:99], v112 offset:6144
  v_mfma_f32_16x16x32_bf16 v[68:71], v[148:151], v[104:107], 0
  s_waitcnt lgkmcnt(6)
  ds_write_b128 v114, v[52:55] offset:1024
  v_fmac_f32 v16, v15, v40
  v_mfma_f32_16x16x32_bf16 v[64:67], v[152:155], v[108:111], v[64:67]
  ds_read_b128 v[100:103], v112 offset:7168
  v_fmac_f32 v17, v15, v41
  v_mfma_f32_16x16x32_bf16 v[68:71], v[156:159], v[108:111], v[68:71]
  s_waitcnt lgkmcnt(7)
  v_fmac_f32 v18, v15, v42
  v_fmac_f32 v19, v15, v43
  v_mfma_f32_16x16x32_bf16 v[64:67], v[160:163], v[88:91], v[64:67]
  buffer_load_dwordx4 v135, s[16:19], s63 offen offset:2048 sc1 lds
  ds_read_b128 v[104:107], v112 offset:32768
  v_mfma_f32_16x16x32_bf16 v[68:71], v[164:167], v[88:91], v[68:71]
  s_waitcnt lgkmcnt(7)
  v_fmac_f32 v20, v15, v44
  v_fmac_f32 v21, v15, v45
  v_mfma_f32_16x16x32_bf16 v[64:67], v[168:171], v[92:95], v[64:67]
  ds_read_b128 v[108:111], v112 offset:33792
  v_fmac_f32 v22, v15, v46
  v_mfma_f32_16x16x32_bf16 v[68:71], v[172:175], v[92:95], v[68:71]
  s_waitcnt lgkmcnt(7)
  v_fmac_f32 v23, v15, v47
  v_mfma_f32_16x16x32_bf16 v[64:67], v[176:179], v[56:59], v[64:67]
  buffer_load_dwordx4 v135, s[16:19], s63 offen offset:3072 sc1 lds
  s_add_u32 m0, s54, 106496
  ds_read_b128 v[88:91], v112 offset:34816
  v_mfma_f32_16x16x32_bf16 v[68:71], v[180:183], v[56:59], v[68:71]
  s_add_u32 s63, s52, 8192
  s_waitcnt lgkmcnt(4)
  s_barrier
  v_mfma_f32_16x16x32_bf16 v[64:67], v[184:187], v[60:63], v[64:67]
  ds_read_b128 v[48:51], v115
  ds_read_b128 v[92:95], v112 offset:35840
  v_mfma_f32_16x16x32_bf16 v[68:71], v[188:191], v[60:63], v[68:71]
  buffer_load_dwordx4 v135, s[16:19], s63 offen offset:0 sc1 lds
  ds_read_b128 v[52:55], v115 offset:1024
  v_mfma_f32_16x16x32_bf16 v[64:67], v[192:195], v[96:99], v[64:67]
  ds_read_b128 v[56:59], v112 offset:36864
  v_mfma_f32_16x16x32_bf16 v[68:71], v[196:199], v[96:99], v[68:71]
  s_waitcnt lgkmcnt(7)
  v_mfma_f32_16x16x32_bf16 v[64:67], v[200:203], v[100:103], v[64:67]
  ds_read_b128 v[60:63], v112 offset:37888
  v_mfma_f32_16x16x32_bf16 v[68:71], v[204:207], v[100:103], v[68:71]
  s_waitcnt lgkmcnt(7)
  s_waitcnt lgkmcnt(4)
  v_fmac_f32 v16, v15, v48
  v_fmac_f32 v17, v15, v49
  v_mfma_f32_16x16x32_bf16 v[64:67], v[208:211], v[104:107], v[64:67]
  buffer_load_dwordx4 v135, s[16:19], s63 offen offset:1024 sc1 lds
  ds_read_b128 v[96:99], v112 offset:38912
  v_mfma_f32_16x16x32_bf16 v[68:71], v[212:215], v[104:107], v[68:71]
  v_fmac_f32 v18, v15, v50
  v_fmac_f32 v19, v15, v51
  v_mfma_f32_16x16x32_bf16 v[64:67], v[216:219], v[108:111], v[64:67]
  ds_read_b128 v[100:103], v112 offset:39936
  s_waitcnt lgkmcnt(4)
  v_fmac_f32 v20, v15, v52
  v_mfma_f32_16x16x32_bf16 v[68:71], v[220:223], v[108:111], v[68:71]
  v_fmac_f32 v21, v15, v53
  v_fmac_f32 v22, v15, v54
  v_mfma_f32_16x16x32_bf16 v[64:67], v[224:227], v[88:91], v[64:67]
  s_lshl_b32 s25, s11, 14
  s_add_u32 s25, s25, 0
  s_waitcnt vmcnt(6)
  v_add_u32 v112, s25, v1
  s_barrier
  ds_read_b128 v[104:107], v112 offset:32768
  v_mfma_f32_16x16x32_bf16 v[68:71], v[228:231], v[88:91], v[68:71]
  buffer_load_dwordx4 v135, s[16:19], s63 offen offset:2048 sc1 lds
  v_fmac_f32 v23, v15, v55
  v_mfma_f32_16x16x32_bf16 v[64:67], v[232:235], v[92:95], v[64:67]
  ds_read_b128 v[108:111], v112 offset:33792
  v_cvt_pk_bf16_f32 v80, v16, v17
  v_mfma_f32_16x16x32_bf16 v[68:71], v[236:239], v[92:95], v[68:71]
  buffer_load_dwordx4 v135, s[16:19], s63 offen offset:3072 sc1 lds
  s_add_u32 m0, s55, 40960
  s_add_u32 s63, s53, 16384
  s_waitcnt lgkmcnt(5)
  v_mfma_f32_16x16x32_bf16 v[64:67], v[240:243], v[56:59], v[64:67]
  ds_read_b128 v[88:91], v112 offset:34816
  v_cvt_pk_bf16_f32 v81, v18, v19
  v_mfma_f32_16x16x32_bf16 v[68:71], v[244:247], v[56:59], v[68:71]
  s_waitcnt lgkmcnt(5)
  v_cvt_pk_bf16_f32 v82, v20, v21
  v_cvt_pk_bf16_f32 v83, v22, v23
  v_mfma_f32_16x16x32_bf16 v[64:67], v[248:251], v[60:63], v[64:67]
  buffer_store_dwordx4 v[80:83], v3, s[48:51], 0 offen nt
  ds_read_b128 v[92:95], v112 offset:35840
  v_mfma_f32_16x16x32_bf16 v[68:71], v[252:255], v[60:63], v[68:71]
  s_waitcnt lgkmcnt(5)
  v_max3_u32 v124, v140, v141, v142
  v_max_u32 v124, v124, v143
  v_mfma_f32_16x16x32_bf16 v[64:67], a[192:195], v[96:99], v[64:67]
  v_cmp_eq_u32 vcc, -1, v124
  s_cbranch_vccnz LF_s5r_59
LF_s5b_61:
  ds_read_b128 v[56:59], v112 offset:36864
  v_mfma_f32_16x16x32_bf16 v[68:71], a[196:199], v[96:99], v[68:71]
  s_waitcnt lgkmcnt(5)
  v_add_f32 v140, v140, v141
  v_add_f32 v142, v142, v143
  v_mfma_f32_16x16x32_bf16 v[64:67], a[200:203], v[100:103], v[64:67]
  ds_read_b128 v[60:63], v112 offset:37888
  v_add_f32 v140, v140, v142
  v_mfma_f32_16x16x32_bf16 v[68:71], a[204:207], v[100:103], v[68:71]
  v_mov_b32 v141, v140
  s_nop 0
  s_waitcnt lgkmcnt(5)
  v_mfma_f32_16x16x32_bf16 v[64:67], a[208:211], v[104:107], v[64:67]
  s_lshl_b32 s25, s11, 14
  s_add_u32 s25, s25, 73728
  s_waitcnt vmcnt(5)
  v_add_u32 v112, s25, v1
  s_barrier
  ds_read_b128 v[96:99], v112 offset:0
  v_mfma_f32_16x16x32_bf16 v[68:71], a[212:215], v[104:107], v[68:71]
  s_waitcnt lgkmcnt(5)
  buffer_load_dwordx4 v135, s[16:19], s63 offen offset:0 sc1 lds
  v_mfma_f32_16x16x32_bf16 v[64:67], a[216:219], v[108:111], v[64:67]
  ds_read_b128 v[100:103], v112 offset:1024
  v_mfma_f32_16x16x32_bf16 v[68:71], a[220:223], v[108:111], v[68:71]
  s_waitcnt lgkmcnt(5)
  buffer_load_dwordx4 v135, s[16:19], s63 offen offset:1024 sc1 lds
  v_mfma_f32_16x16x32_bf16 v[64:67], a[224:227], v[88:91], v[64:67]
  ds_read_b128 v[104:107], v112 offset:2048
  v_mfma_f32_16x16x32_bf16 v[68:71], a[228:231], v[88:91], v[68:71]
  s_waitcnt lgkmcnt(5)
  v_permlane32_swap_b32 v140, v141
  v_mfma_f32_16x16x32_bf16 v[64:67], a[232:235], v[92:95], v[64:67]
  ds_read_b128 v[108:111], v112 offset:3072
  v_add_f32 v140, v140, v141
  v_mfma_f32_16x16x32_bf16 v[68:71], a[236:239], v[92:95], v[68:71]
  v_mov_b32 v141, v140
  s_nop 0
  s_waitcnt lgkmcnt(5)
  v_mfma_f32_16x16x32_bf16 v[64:67], a[240:243], v[56:59], v[64:67]
  buffer_load_dwordx4 v135, s[16:19], s63 offen offset:2048 sc1 lds
  ds_read_b128 v[88:91], v112 offset:4096
  v_mfma_f32_16x16x32_bf16 v[68:71], a[244:247], v[56:59], v[68:71]
  s_waitcnt lgkmcnt(5)
  v_permlane16_swap_b32 v140, v141
  v_mfma_f32_16x16x32_bf16 v[64:67], a[248:251], v[60:63], v[64:67]
  ds_read_b128 v[92:95], v112 offset:5120
  v_add_f32 v140, v140, v141
  v_mfma_f32_16x16x32_bf16 v[68:71], a[252:255], v[60:63], v[68:71]
  s_waitcnt lgkmcnt(5)
  v_mul_f32 v140, 0x3b000000, v140
  v_add_f32 v140, 0x3727c5ac, v140
  v_mfma_f32_16x16x32_bf16 v[72:75], v[144:147], v[96:99], 0
  s_add_u32 s3, s65, 38912
  ds_read_b128 v[56:59], v112 offset:6144
  v_rcp_f32 v15, v140
  v_mfma_f32_16x16x32_bf16 v[76:79], v[148:151], v[96:99], 0
  v_add_u32 v114, s3, v1
  s_xor_b32 s3, s65, 16384
  s_add_u32 s3, s3, 38912
  s_waitcnt lgkmcnt(5)
  v_mfma_f32_16x16x32_bf16 v[72:75], v[152:155], v[100:103], v[72:75]
  ds_read_b128 v[60:63], v112 offset:7168
  v_add_u32 v115, s3, v1
  v_mfma_f32_16x16x32_bf16 v[76:79], v[156:159], v[100:103], v[76:79]
  s_waitcnt lgkmcnt(5)
  v_mfma_f32_16x16x32_bf16 v[72:75], v[160:163], v[104:107], v[72:75]
  s_waitcnt vmcnt(4)
  s_barrier
  ds_read_b128 v[96:99], v112 offset:32768
  v_mfma_f32_16x16x32_bf16 v[76:79], v[164:167], v[104:107], v[76:79]
  s_waitcnt lgkmcnt(5)
  v_mfma_f32_16x16x32_bf16 v[72:75], v[168:171], v[108:111], v[72:75]
  ds_read_b128 v[100:103], v112 offset:33792
  v_mfma_f32_16x16x32_bf16 v[76:79], v[172:175], v[108:111], v[76:79]
  s_waitcnt lgkmcnt(5)
  v_mfma_f32_16x16x32_bf16 v[72:75], v[176:179], v[88:91], v[72:75]
  ds_read_b128 v[104:107], v112 offset:34816
  v_mfma_f32_16x16x32_bf16 v[76:79], v[180:183], v[88:91], v[76:79]
  s_waitcnt lgkmcnt(5)
  v_mfma_f32_16x16x32_bf16 v[72:75], v[184:187], v[92:95], v[72:75]
  ds_read_b128 v[108:111], v112 offset:35840
  v_mfma_f32_16x16x32_bf16 v[76:79], v[188:191], v[92:95], v[76:79]
  s_waitcnt lgkmcnt(5)
  v_mfma_f32_16x16x32_bf16 v[72:75], v[192:195], v[56:59], v[72:75]
  ds_read_b128 v[88:91], v112 offset:36864
  v_mfma_f32_16x16x32_bf16 v[76:79], v[196:199], v[56:59], v[76:79]
  s_waitcnt lgkmcnt(5)
  v_mfma_f32_16x16x32_bf16 v[72:75], v[200:203], v[60:63], v[72:75]
  ds_read_b128 v[92:95], v112 offset:37888
  v_mfma_f32_16x16x32_bf16 v[76:79], v[204:207], v[60:63], v[76:79]
  s_waitcnt lgkmcnt(5)
  v_mfma_f32_16x16x32_bf16 v[72:75], v[208:211], v[96:99], v[72:75]
  ds_read_b128 v[56:59], v112 offset:38912
  v_mfma_f32_16x16x32_bf16 v[76:79], v[212:215], v[96:99], v[76:79]
  s_waitcnt lgkmcnt(5)
  v_mfma_f32_16x16x32_bf16 v[72:75], v[216:219], v[100:103], v[72:75]
  ds_read_b128 v[60:63], v112 offset:39936
  v_mfma_f32_16x16x32_bf16 v[76:79], v[220:223], v[100:103], v[76:79]
  s_waitcnt lgkmcnt(5)
  v_mfma_f32_16x16x32_bf16 v[72:75], v[224:227], v[104:107], v[72:75]
  s_lshl_b32 s25, s11, 14
  s_add_u32 s25, s25, 8192
  s_waitcnt vmcnt(0)
  v_add_u32 v112, s25, v1
  s_barrier
  ds_read_b128 v[96:99], v112 offset:32768
  v_mfma_f32_16x16x32_bf16 v[76:79], v[228:231], v[104:107], v[76:79]
  s_waitcnt lgkmcnt(5)
  v_mfma_f32_16x16x32_bf16 v[72:75], v[232:235], v[108:111], v[72:75]
  ds_read_b128 v[100:103], v112 offset:33792
  v_mfma_f32_16x16x32_bf16 v[76:79], v[236:239], v[108:111], v[76:79]
  s_waitcnt lgkmcnt(5)
  v_mfma_f32_16x16x32_bf16 v[72:75], v[240:243], v[88:91], v[72:75]
  ds_read_b128 v[104:107], v112 offset:34816
  v_mfma_f32_16x16x32_bf16 v[76:79], v[244:247], v[88:91], v[76:79]
  s_waitcnt lgkmcnt(5)
  v_mfma_f32_16x16x32_bf16 v[72:75], v[248:251], v[92:95], v[72:75]
  ds_read_b128 v[108:111], v112 offset:35840
  v_mfma_f32_16x16x32_bf16 v[76:79], v[252:255], v[92:95], v[76:79]
  s_waitcnt lgkmcnt(5)
  v_mfma_f32_16x16x32_bf16 v[72:75], a[192:195], v[56:59], v[72:75]
  ds_read_b128 v[88:91], v112 offset:36864
  v_mfma_f32_16x16x32_bf16 v[76:79], a[196:199], v[56:59], v[76:79]
  s_waitcnt lgkmcnt(5)
  v_mfma_f32_16x16x32_bf16 v[72:75], a[200:203], v[60:63], v[72:75]
  ds_read_b128 v[92:95], v112 offset:37888
  v_mfma_f32_16x16x32_bf16 v[76:79], a[204:207], v[60:63], v[76:79]
  s_waitcnt lgkmcnt(5)
  v_mfma_f32_16x16x32_bf16 v[72:75], a[208:211], v[96:99], v[72:75]
  v_mfma_f32_16x16x32_bf16 v[76:79], a[212:215], v[96:99], v[76:79]
  s_waitcnt lgkmcnt(4)
  v_mfma_f32_16x16x32_bf16 v[72:75], a[216:219], v[100:103], v[72:75]
  v_mfma_f32_16x16x32_bf16 v[76:79], a[220:223], v[100:103], v[76:79]
  s_waitcnt lgkmcnt(3)
  v_mfma_f32_16x16x32_bf16 v[72:75], a[224:227], v[104:107], v[72:75]
  v_mfma_f32_16x16x32_bf16 v[76:79], a[228:231], v[104:107], v[76:79]
  s_waitcnt lgkmcnt(2)
  v_mfma_f32_16x16x32_bf16 v[72:75], a[232:235], v[108:111], v[72:75]
  v_mfma_f32_16x16x32_bf16 v[76:79], a[236:239], v[108:111], v[76:79]
  s_waitcnt lgkmcnt(1)
  v_mfma_f32_16x16x32_bf16 v[72:75], a[240:243], v[88:91], v[72:75]
  v_mfma_f32_16x16x32_bf16 v[76:79], a[244:247], v[88:91], v[76:79]
  s_waitcnt lgkmcnt(0)
  v_mfma_f32_16x16x32_bf16 v[72:75], a[248:251], v[92:95], v[72:75]
  v_mfma_f32_16x16x32_bf16 v[76:79], a[252:255], v[92:95], v[76:79]
  s_nop 7
  s_cmp_eq_u32 s11, 0
  s_cbranch_scc1 LF_sw_74
  v_swap_b32 v64, v72
  v_swap_b32 v65, v73
  v_swap_b32 v66, v74
  v_swap_b32 v67, v75
  v_swap_b32 v68, v76
  v_swap_b32 v69, v77
  v_swap_b32 v70, v78
  v_swap_b32 v71, v79
LF_sw_74:
  ds_write_b128 v114, v[72:75]
  ds_write_b128 v114, v[76:79] offset:1024
  v_fmac_f32 v24, v15, v64
  v_fmac_f32 v25, v15, v65
  v_fmac_f32 v26, v15, v66
  v_fmac_f32 v27, v15, v67
  v_fmac_f32 v28, v15, v68
  v_fmac_f32 v29, v15, v69
  v_fmac_f32 v30, v15, v70
  v_fmac_f32 v31, v15, v71
  s_waitcnt lgkmcnt(0)
  s_barrier
  ds_read_b128 v[72:75], v115
  ds_read_b128 v[76:79], v115 offset:1024
  s_waitcnt lgkmcnt(1)
  v_fmac_f32 v24, v15, v72
  v_fmac_f32 v25, v15, v73
  v_fmac_f32 v26, v15, v74
  v_fmac_f32 v27, v15, v75
  s_waitcnt lgkmcnt(0)
  v_fmac_f32 v28, v15, v76
  v_fmac_f32 v29, v15, v77
  v_fmac_f32 v30, v15, v78
  v_fmac_f32 v31, v15, v79
  v_cvt_pk_bf16_f32 v80, v24, v25
  v_cvt_pk_bf16_f32 v81, v26, v27
  v_cvt_pk_bf16_f32 v82, v28, v29
  v_cvt_pk_bf16_f32 v83, v30, v31
  buffer_store_dwordx4 v[80:83], v3, s[48:51], s0 offen nt
  s_or_b32 s3, s2, s6
  s_cmp_eq_u32 s3, 0
  s_cselect_b32 s3, 0, 2147483392
  buffer_store_dword v14, v2, s[16:19], s3 offen sc1
  s_endpgm
L_f1r:
  s_mov_b32 s62, 0
L_f1l:
  buffer_load_dword v99, v97, s[16:19], s20 offen sc1
  s_waitcnt vmcnt(0)
  v_cmp_ne_u32 vcc, s14, v99
  s_cbranch_vccz L_f1b
  s_add_u32 s62, s62, 1
  s_cmp_lt_u32 s62, 2048
  s_cbranch_scc1 L_f1l
L_f1s:
  s_mov_b32 s34, 1
  s_mov_b32 s60, 32768
  buffer_store_dwordx4 v[84:87], v55, s[16:19], 0 offen sc1
  buffer_store_dwordx4 v[88:91], v55, s[16:19], s60 offen sc1
  s_lshl_b32 s60, s4, 2
  s_add_u32 s61, s60, s6
  s_lshl_b32 s61, s61, 5
  s_add_u32 s61, s61, s5
  s_lshl_b32 s61, s61, 7
  s_add_u32 s61, s61, 131072
  s_lshr_b32 s20, s5, 3
  s_add_u32 s20, s20, s60
  s_lshl_b32 s20, s20, 12
  s_add_u32 s20, s20, 131072
  v_lshlrev_b32 v97, 5, v97
  s_waitcnt vmcnt(0)
  buffer_store_dword v14, v2, s[16:19], s61 offen sc1
  s_mov_b32 s62, 0
L_f1g:
  buffer_load_dword v99, v97, s[16:19], s20 offen sc1
  s_waitcnt vmcnt(0)
  v_cmp_ne_u32 vcc, s13, v99
  s_cbranch_vccz L_f1b
  s_add_u32 s62, s62, 1
  s_cmp_lt_u32 s62, 65536
  s_cbranch_scc1 L_f1g
  s_branch L_f1b
LF_h2r_1:
  s_mov_b32 s62, 0
LF_h2l_2:
  buffer_load_dwordx4 v[112:115], v15, s[16:19], 0 offen sc1
  s_waitcnt vmcnt(0)
  v_xor_b32 v113, s13, v113
  v_xor_b32 v114, s13, v114
  v_xor_b32 v115, s13, v115
  v_or3_b32 v113, v113, v114, v115
  v_xor_b32 v114, s13, v112
  v_or_b32 v113, v113, v114
  v_cmp_lt_u32 vcc, 15, v113
  s_cbranch_vccz LF_h2b_3
  s_add_u32 s62, s62, 1
  s_cmp_lt_u32 s62, 65536
  s_cbranch_scc1 LF_h2l_2
  s_branch LF_h2b_3
LF_ytr_4:
  s_mov_b32 s62, 0
LF_ytl_5:
  buffer_load_dwordx4 v[184:187], v164, s[16:19], 0 offen sc1
  s_waitcnt vmcnt(0)
  v_max3_u32 v192, v184, v185, v186
  v_max_u32 v192, v192, v187
  v_cmp_eq_u32 vcc, -1, v192
  s_cbranch_vccz LF_ytb_6
  s_add_u32 s62, s62, 1
  s_cmp_lt_u32 s62, 65536
  s_cbranch_scc1 LF_ytl_5
  s_branch LF_ytb_6
LF_grr_7:
  s_mov_b32 s62, 0
LF_grl_8:
  buffer_load_dwordx4 v[40:43], v5, s[16:19], s21 offen offset:0 sc1
  buffer_load_dwordx4 v[44:47], v5, s[16:19], s21 offen offset:256 sc1
  buffer_load_dwordx4 v[48:51], v5, s[16:19], s21 offen offset:512 sc1
  buffer_load_dwordx4 v[52:55], v5, s[16:19], s21 offen offset:768 sc1
  s_waitcnt vmcnt(0)
  v_max3_u32 v122, v40, v41, v42
  v_max3_u32 v122, v122, v43, v44
  v_max3_u32 v122, v122, v45, v46
  v_max3_u32 v122, v122, v47, v48
  v_max3_u32 v122, v122, v49, v50
  v_max3_u32 v122, v122, v51, v52
  v_max3_u32 v122, v122, v53, v54
  v_max_u32 v122, v122, v55
  v_cmp_eq_u32 vcc, -1, v122
  s_cbranch_vccz LF_grb_9
  s_add_u32 s62, s62, 1
  s_cmp_lt_u32 s62, 65536
  s_cbranch_scc1 LF_grl_8
  s_branch LF_grb_9
LF_grr_10:
  s_mov_b32 s62, 0
LF_grl_11:
  buffer_load_dwordx4 v[232:235], v5, s[16:19], s21 offen offset:0 sc1
  buffer_load_dwordx4 v[236:239], v5, s[16:19], s21 offen offset:256 sc1
  buffer_load_dwordx4 v[240:243], v5, s[16:19], s21 offen offset:512 sc1
  buffer_load_dwordx4 v[244:247], v5, s[16:19], s21 offen offset:768 sc1
  s_waitcnt vmcnt(0)
  v_max3_u32 v122, v232, v233, v234
  v_max3_u32 v122, v122, v235, v236
  v_max3_u32 v122, v122, v237, v238
  v_max3_u32 v122, v122, v239, v240
  v_max3_u32 v122, v122, v241, v242
  v_max3_u32 v122, v122, v243, v244
  v_max3_u32 v122, v122, v245, v246
  v_max_u32 v122, v122, v247
  v_cmp_eq_u32 vcc, -1, v122
  s_cbranch_vccz LF_grb_12
  s_add_u32 s62, s62, 1
  s_cmp_lt_u32 s62, 65536
  s_cbranch_scc1 LF_grl_11
  s_branch LF_grb_12
LF_ytr_13:
  s_mov_b32 s62, 0
LF_ytl_14:
  buffer_load_dwordx4 v[188:191], v164, s[16:19], s0 offen sc1
  s_waitcnt vmcnt(0)
  v_max3_u32 v192, v188, v189, v190
  v_max_u32 v192, v192, v191
  v_cmp_eq_u32 vcc, -1, v192
  s_cbranch_vccz LF_ytb_15
  s_add_u32 s62, s62, 1
  s_cmp_lt_u32 s62, 65536
  s_cbranch_scc1 LF_ytl_14
  s_branch LF_ytb_15
LF_ppr_16:
  s_mov_b32 s62, 0
LF_ppl_17:
  buffer_load_dword v124, v125, s[16:19], s24 offen sc1
  s_waitcnt vmcnt(0)
  v_cmp_ne_u32 vcc, s13, v124
  s_cbranch_vccz LF_ppb_18
  s_add_u32 s62, s62, 1
  s_cmp_lt_u32 s62, 65536
  s_cbranch_scc1 LF_ppl_17
  s_branch LF_ppb_18
LF_xfr_19:
  s_mov_b32 s62, 0
LF_xfl_20:
  buffer_load_dword v123, v12, s[16:19], s20 offen sc1
  s_waitcnt vmcnt(0)
  v_cmp_ne_u32 vcc, s13, v123
  s_cbranch_vccz LF_xfb_21
  s_add_u32 s62, s62, 1
  s_cmp_lt_u32 s62, 65536
  s_cbranch_scc1 LF_xfl_20
  s_branch LF_xfb_21
LF_xfr_22:
  s_mov_b32 s62, 0
LF_xfl_23:
  buffer_load_dword v123, v12, s[16:19], s20 offen sc1
  s_waitcnt vmcnt(0)
  v_cmp_ne_u32 vcc, s13, v123
  s_cbranch_vccz LF_xfb_24
  s_add_u32 s62, s62, 1
  s_cmp_lt_u32 s62, 65536
  s_cbranch_scc1 LF_xfl_23
  s_branch LF_xfb_24
LF_s5r_25:
  s_mov_b32 s62, 0
LF_s5l_26:
  buffer_load_dwordx4 v[140:143], v7, s[16:19], s24 offen sc1
  s_waitcnt vmcnt(0)
  v_max3_u32 v124, v140, v141, v142
  v_max_u32 v124, v124, v143
  v_cmp_eq_u32 vcc, -1, v124
  s_cbranch_vccz LF_s5b_27
  s_add_u32 s62, s62, 1
  s_cmp_lt_u32 s62, 65536
  s_cbranch_scc1 LF_s5l_26
  s_branch LF_s5b_27
LF_s5r_28:
  s_mov_b32 s62, 0
LF_s5l_29:
  buffer_load_dwordx4 v[140:143], v7, s[16:19], s24 offen sc1
  s_waitcnt vmcnt(0)
  v_max3_u32 v124, v140, v141, v142
  v_max_u32 v124, v124, v143
  v_cmp_eq_u32 vcc, -1, v124
  s_cbranch_vccz LF_s5b_30
  s_add_u32 s62, s62, 1
  s_cmp_lt_u32 s62, 65536
  s_cbranch_scc1 LF_s5l_29
  s_branch LF_s5b_30
LF_grr_31:
  s_mov_b32 s62, 0
LF_grl_32:
  buffer_load_dwordx4 v[40:43], v5, s[16:19], s21 offen offset:0 sc1
  buffer_load_dwordx4 v[44:47], v5, s[16:19], s21 offen offset:256 sc1
  buffer_load_dwordx4 v[48:51], v5, s[16:19], s21 offen offset:512 sc1
  buffer_load_dwordx4 v[52:55], v5, s[16:19], s21 offen offset:768 sc1
  s_waitcnt vmcnt(0)
  v_max3_u32 v122, v40, v41, v42
  v_max3_u32 v122, v122, v43, v44
  v_max3_u32 v122, v122, v45, v46
  v_max3_u32 v122, v122, v47, v48
  v_max3_u32 v122, v122, v49, v50
  v_max3_u32 v122, v122, v51, v52
  v_max3_u32 v122, v122, v53, v54
  v_max_u32 v122, v122, v55
  v_cmp_eq_u32 vcc, -1, v122
  s_cbranch_vccz LF_grb_33
  s_add_u32 s62, s62, 1
  s_cmp_lt_u32 s62, 65536
  s_cbranch_scc1 LF_grl_32
  s_branch LF_grb_33
LF_xfr_34:
  s_mov_b32 s62, 0
LF_xfl_35:
  buffer_load_dword v123, v12, s[16:19], s20 offen sc1
  s_waitcnt vmcnt(0)
  v_cmp_ne_u32 vcc, s13, v123
  s_cbranch_vccz LF_xfb_36
  s_add_u32 s62, s62, 1
  s_cmp_lt_u32 s62, 65536
  s_cbranch_scc1 LF_xfl_35
  s_branch LF_xfb_36
LF_hfr_37:
  s_mov_b32 s62, 0
LF_hfl_38:
  buffer_load_dword v123, v13, s[16:19], s20 offen sc1
  s_waitcnt vmcnt(0)
  v_cmp_ne_u32 vcc, s13, v123
  s_cbranch_vccz LF_hfb_39
  s_add_u32 s62, s62, 1
  s_cmp_lt_u32 s62, 65536
  s_cbranch_scc1 LF_hfl_38
  s_branch LF_hfb_39
LF_hfr_40:
  s_mov_b32 s62, 0
LF_hfl_41:
  buffer_load_dword v123, v13, s[16:19], s20 offen sc1
  s_waitcnt vmcnt(0)
  v_cmp_ne_u32 vcc, s13, v123
  s_cbranch_vccz LF_hfb_42
  s_add_u32 s62, s62, 1
  s_cmp_lt_u32 s62, 65536
  s_cbranch_scc1 LF_hfl_41
  s_branch LF_hfb_42
LF_hfr_43:
  s_mov_b32 s62, 0
LF_hfl_44:
  buffer_load_dword v123, v13, s[16:19], s20 offen sc1
  s_waitcnt vmcnt(0)
  v_cmp_ne_u32 vcc, s13, v123
  s_cbranch_vccz LF_hfb_45
  s_add_u32 s62, s62, 1
  s_cmp_lt_u32 s62, 65536
  s_cbranch_scc1 LF_hfl_44
  s_branch LF_hfb_45
LF_hfr_46:
  s_mov_b32 s62, 0
LF_hfl_47:
  buffer_load_dword v123, v13, s[16:19], s20 offen sc1
  s_waitcnt vmcnt(0)
  v_cmp_ne_u32 vcc, s13, v123
  s_cbranch_vccz LF_hfb_48
  s_add_u32 s62, s62, 1
  s_cmp_lt_u32 s62, 65536
  s_cbranch_scc1 LF_hfl_47
  s_branch LF_hfb_48
LF_grr_50:
  s_mov_b32 s62, 0
LF_grl_51:
  buffer_load_dwordx4 v[64:67], v5, s[16:19], s21 offen offset:0 sc1
  buffer_load_dwordx4 v[68:71], v5, s[16:19], s21 offen offset:256 sc1
  buffer_load_dwordx4 v[72:75], v5, s[16:19], s21 offen offset:512 sc1
  buffer_load_dwordx4 v[76:79], v5, s[16:19], s21 offen offset:768 sc1
  s_waitcnt vmcnt(0)
  v_max3_u32 v122, v64, v65, v66
  v_max3_u32 v122, v122, v67, v68
  v_max3_u32 v122, v122, v69, v70
  v_max3_u32 v122, v122, v71, v72
  v_max3_u32 v122, v122, v73, v74
  v_max3_u32 v122, v122, v75, v76
  v_max3_u32 v122, v122, v77, v78
  v_max_u32 v122, v122, v79
  v_cmp_eq_u32 vcc, -1, v122
  s_cbranch_vccz LF_grb_52
  s_add_u32 s62, s62, 1
  s_cmp_lt_u32 s62, 65536
  s_cbranch_scc1 LF_grl_51
  s_branch LF_grb_52
LF_xfr_53:
  s_mov_b32 s62, 0
LF_xfl_54:
  buffer_load_dword v123, v12, s[16:19], s20 offen sc1
  s_waitcnt vmcnt(0)
  v_cmp_ne_u32 vcc, s13, v123
  s_cbranch_vccz LF_xfb_55
  s_add_u32 s62, s62, 1
  s_cmp_lt_u32 s62, 65536
  s_cbranch_scc1 LF_xfl_54
  s_branch LF_xfb_55
LF_s5r_56:
  s_mov_b32 s62, 0
LF_s5l_57:
  buffer_load_dwordx4 v[140:143], v7, s[16:19], s24 offen sc1
  s_waitcnt vmcnt(0)
  v_max3_u32 v124, v140, v141, v142
  v_max_u32 v124, v124, v143
  v_cmp_eq_u32 vcc, -1, v124
  s_cbranch_vccz LF_s5b_58
  s_add_u32 s62, s62, 1
  s_cmp_lt_u32 s62, 65536
  s_cbranch_scc1 LF_s5l_57
  s_branch LF_s5b_58
LF_s5r_59:
  s_mov_b32 s62, 0
LF_s5l_60:
  buffer_load_dwordx4 v[140:143], v7, s[16:19], s24 offen sc1
  s_waitcnt vmcnt(0)
  v_max3_u32 v124, v140, v141, v142
  v_max_u32 v124, v124, v143
  v_cmp_eq_u32 vcc, -1, v124
  s_cbranch_vccz LF_s5b_61
  s_add_u32 s62, s62, 1
  s_cmp_lt_u32 s62, 65536
  s_cbranch_scc1 LF_s5l_60
  s_branch LF_s5b_61
LF_hfr_62:
  s_mov_b32 s62, 0
LF_hfl_63:
  buffer_load_dword v123, v13, s[16:19], s20 offen sc1
  s_waitcnt vmcnt(0)
  v_cmp_ne_u32 vcc, s13, v123
  s_cbranch_vccz LF_hfb_64
  s_add_u32 s62, s62, 1
  s_cmp_lt_u32 s62, 65536
  s_cbranch_scc1 LF_hfl_63
  s_branch LF_hfb_64
LF_hfr_65:
  s_mov_b32 s62, 0
LF_hfl_66:
  buffer_load_dword v123, v13, s[16:19], s20 offen sc1
  s_waitcnt vmcnt(0)
  v_cmp_ne_u32 vcc, s13, v123
  s_cbranch_vccz LF_hfb_67
  s_add_u32 s62, s62, 1
  s_cmp_lt_u32 s62, 65536
  s_cbranch_scc1 LF_hfl_66
  s_branch LF_hfb_67
LF_hfr_68:
  s_mov_b32 s62, 0
LF_hfl_69:
  buffer_load_dword v123, v13, s[16:19], s20 offen sc1
  s_waitcnt vmcnt(0)
  v_cmp_ne_u32 vcc, s13, v123
  s_cbranch_vccz LF_hfb_70
  s_add_u32 s62, s62, 1
  s_cmp_lt_u32 s62, 65536
  s_cbranch_scc1 LF_hfl_69
  s_branch LF_hfb_70
LF_hfr_71:
  s_mov_b32 s62, 0
LF_hfl_72:
  buffer_load_dword v123, v13, s[16:19], s20 offen sc1
  s_waitcnt vmcnt(0)
  v_cmp_ne_u32 vcc, s13, v123
  s_cbranch_vccz LF_hfb_73
  s_add_u32 s62, s62, 1
  s_cmp_lt_u32 s62, 65536
  s_cbranch_scc1 LF_hfl_72
  s_branch LF_hfb_73
L_fast_end:
L_slow:
  s_nop 4
  s_waitcnt lgkmcnt(1)
  v_lshlrev_b32 v40, 16, v32
  v_and_b32 v41, 0xffff0000, v32
  v_lshlrev_b32 v42, 16, v33
  v_and_b32 v43, 0xffff0000, v33
  s_waitcnt lgkmcnt(0)
  v_lshlrev_b32 v44, 16, v34
  v_and_b32 v45, 0xffff0000, v34
  v_lshlrev_b32 v46, 16, v35
  v_and_b32 v47, 0xffff0000, v35
  v_mul_f32 v50, v16, v40
  v_add_f32 v51, v40, v41
  v_fmac_f32 v50, v17, v41
  v_fmac_f32 v50, v18, v42
  v_add_f32 v51, v51, v42
  v_fmac_f32 v50, v19, v43
  v_add_f32 v51, v51, v43
  v_fmac_f32 v50, v20, v44
  v_add_f32 v51, v51, v44
  v_fmac_f32 v50, v21, v45
  v_add_f32 v51, v51, v45
  v_fmac_f32 v50, v22, v46
  v_add_f32 v51, v51, v46
  v_fmac_f32 v50, v23, v47
  v_add_f32 v51, v51, v47
  s_nop 0
  v_permlane32_swap_b32 v104, v50
  v_permlane32_swap_b32 v105, v51
  v_add_f32 v104, v104, v50
  v_add_f32 v105, v105, v51
  s_add_u32 s3, s70, 0
  s_nop 0
  v_permlane16_swap_b32 v104, v105
  v_add_f32 v104, v104, v105
  buffer_store_dword v104, v4, s[16:19], s3 offen sc1
  s_mul_i32 s3, s10, 43
  s_mul_i32 s15, s11, 21
  s_add_u32 s3, s3, s15
  s_lshl_b32 s3, s3, 7
  s_add_u32 s24, s3, 589824
  s_waitcnt vmcnt(2)
  v_min_u32 v125, 21, v135
  v_lshlrev_b32 v125, 7, v125
  s_add_u32 s75, s4, 6
  s_and_b32 s75, s75, 7
  s_mul_i32 s75, s75, 176128
  s_add_u32 m0, s74, 8192
  s_nop 0
  buffer_load_dwordx4 v129, s[36:39], s75 offen offset:0 lds
  buffer_load_dwordx4 v130, s[36:39], s75 offen offset:1024 lds
  buffer_load_dwordx4 v131, s[36:39], s75 offen offset:2048 lds
  s_add_u32 m0, s74, 20480
  s_nop 0
  buffer_load_dwordx4 v129, s[40:43], s75 offen offset:0 lds
  buffer_load_dwordx4 v130, s[40:43], s75 offen offset:1024 lds
  buffer_load_dwordx4 v131, s[40:43], s75 offen offset:2048 lds
  v_add_u32 v128, 65536, v132
  v_add_u32 v134, 65536, v133
  ds_read_b64_tr_b16 a[72:73], v128 offset:0
  ds_read_b64_tr_b16 a[76:77], v128 offset:12288
  ds_read_b64_tr_b16 a[80:81], v134 offset:0
  ds_read_b64_tr_b16 a[74:75], v128 offset:768
  ds_read_b64_tr_b16 a[78:79], v128 offset:13056
  ds_read_b64_tr_b16 a[82:83], v134 offset:768
  ds_read_b64_tr_b16 a[84:85], v128 offset:6144
  ds_read_b64_tr_b16 a[88:89], v128 offset:18432
  ds_read_b64_tr_b16 a[92:93], v134 offset:6144
  ds_read_b64_tr_b16 a[86:87], v128 offset:6912
  ds_read_b64_tr_b16 a[90:91], v128 offset:19200
  ds_read_b64_tr_b16 a[94:95], v134 offset:6912
  v_add_u32 v128, 90112, v132
  v_add_u32 v134, 90112, v133
  ds_read_b64_tr_b16 a[96:97], v128 offset:0
  ds_read_b64_tr_b16 a[100:101], v128 offset:12288
  ds_read_b64_tr_b16 a[104:105], v134 offset:0
  ds_read_b64_tr_b16 a[98:99], v128 offset:768
  ds_read_b64_tr_b16 a[102:103], v128 offset:13056
  ds_read_b64_tr_b16 a[106:107], v134 offset:768
  ds_read_b64_tr_b16 a[108:109], v128 offset:6144
  ds_read_b64_tr_b16 a[112:113], v128 offset:18432
  ds_read_b64_tr_b16 a[116:117], v134 offset:6144
  ds_read_b64_tr_b16 a[110:111], v128 offset:6912
  ds_read_b64_tr_b16 a[114:115], v128 offset:19200
  ds_read_b64_tr_b16 a[118:119], v134 offset:6912
  v_add_u32 v128, 114688, v132
  v_add_u32 v134, 114688, v133
  ds_read_b64_tr_b16 a[120:121], v128 offset:0
  ds_read_b64_tr_b16 a[124:125], v128 offset:12288
  ds_read_b64_tr_b16 a[128:129], v134 offset:0
  ds_read_b64_tr_b16 a[122:123], v128 offset:768
  ds_read_b64_tr_b16 a[126:127], v128 offset:13056
  ds_read_b64_tr_b16 a[130:131], v134 offset:768
  ds_read_b64_tr_b16 a[132:133], v128 offset:6144
  ds_read_b64_tr_b16 a[136:137], v128 offset:18432
  ds_read_b64_tr_b16 a[140:141], v134 offset:6144
  ds_read_b64_tr_b16 a[134:135], v128 offset:6912
  ds_read_b64_tr_b16 a[138:139], v128 offset:19200
  ds_read_b64_tr_b16 a[142:143], v134 offset:6912
  ds_read_b64_tr_b16 v[144:145], v127 offset:0
  ds_read_b64_tr_b16 v[146:147], v127 offset:512
  ds_read_b64_tr_b16 v[148:149], v127 offset:8
  ds_read_b64_tr_b16 v[150:151], v127 offset:520
  ds_read_b64_tr_b16 v[152:153], v127 offset:64
  ds_read_b64_tr_b16 v[154:155], v127 offset:576
  ds_read_b64_tr_b16 v[156:157], v127 offset:72
  ds_read_b64_tr_b16 v[158:159], v127 offset:584
  s_add_u32 s60, s57, 0
  s_waitcnt lgkmcnt(6)
  buffer_store_dwordx4 v[144:147], v1, s[16:19], s60 offen offset:0 sc1
  s_waitcnt lgkmcnt(4)
  buffer_store_dwordx4 v[148:151], v1, s[16:19], s60 offen offset:1024 sc1
  s_add_u32 s60, s57, 88064
  s_waitcnt lgkmcnt(2)
  buffer_store_dwordx4 v[152:155], v1, s[16:19], s60 offen offset:0 sc1
  s_waitcnt lgkmcnt(0)
  buffer_store_dwordx4 v[156:159], v1, s[16:19], s60 offen offset:1024 sc1
  v_mov_b32 v192, 0x3f803f80
  v_lshlrev_b32 v24, 16, v200
  v_and_b32 v25, 0xffff0000, v200
  v_lshlrev_b32 v26, 16, v201
  v_and_b32 v27, 0xffff0000, v201
  v_lshlrev_b32 v28, 16, v202
  v_and_b32 v29, 0xffff0000, v202
  v_lshlrev_b32 v30, 16, v203
  v_and_b32 v31, 0xffff0000, v203
  v_dot2_f32_bf16 v106, v200, v192, 0
  v_dot2_f32_bf16 v107, v200, v200, 0
  v_dot2_f32_bf16 v106, v201, v192, v106
  v_dot2_f32_bf16 v107, v201, v201, v107
  v_dot2_f32_bf16 v106, v202, v192, v106
  v_dot2_f32_bf16 v107, v202, v202, v107
  v_dot2_f32_bf16 v106, v203, v192, v106
  v_dot2_f32_bf16 v107, v203, v203, v107
  s_waitcnt vmcnt(11)
  s_add_u32 s21, s72, 0
  buffer_load_dwordx4 v[40:43], v5, s[16:19], s21 offen offset:0 sc1
  buffer_load_dwordx4 v[44:47], v5, s[16:19], s21 offen offset:256 sc1
  buffer_load_dwordx4 v[48:51], v5, s[16:19], s21 offen offset:512 sc1
  buffer_load_dwordx4 v[52:55], v5, s[16:19], s21 offen offset:768 sc1
  v_lshlrev_b32 v56, 16, v32
  v_and_b32 v57, 0xffff0000, v32
  v_lshlrev_b32 v58, 16, v33
  v_and_b32 v59, 0xffff0000, v33
  v_lshlrev_b32 v60, 16, v34
  v_and_b32 v61, 0xffff0000, v34
  v_lshlrev_b32 v62, 16, v35
  v_and_b32 v63, 0xffff0000, v35
  buffer_load_dwordx4 v[188:191], v164, s[16:19], s0 offen sc1
  s_waitcnt lgkmcnt(0)
  s_barrier
  s_add_u32 s75, s4, 7
  s_and_b32 s75, s75, 7
  s_mul_i32 s75, s75, 176128
  s_add_u32 m0, s74, 65536
  s_nop 0
  buffer_load_dwordx4 v129, s[36:39], s75 offen offset:0 lds
  buffer_load_dwordx4 v130, s[36:39], s75 offen offset:1024 lds
  buffer_load_dwordx4 v131, s[36:39], s75 offen offset:2048 lds
  s_add_u32 m0, s74, 77824
  s_nop 0
  buffer_load_dwordx4 v129, s[40:43], s75 offen offset:0 lds
  buffer_load_dwordx4 v130, s[40:43], s75 offen offset:1024 lds
  buffer_load_dwordx4 v131, s[40:43], s75 offen offset:2048 lds
  s_waitcnt vmcnt(7)
  v_max3_u32 v122, v40, v41, v42
  v_max3_u32 v122, v122, v43, v44
  v_max3_u32 v122, v122, v45, v46
  v_max3_u32 v122, v122, v47, v48
  v_max3_u32 v122, v122, v49, v50
  v_max3_u32 v122, v122, v51, v52
  v_max3_u32 v122, v122, v53, v54
  v_max_u32 v122, v122, v55
  v_cmp_eq_u32 vcc, -1, v122
  s_cbranch_vccnz LS_grr_1
LS_grb_3:
  v_pk_add_f32 v[40:41], v[40:41], v[44:45]
  v_pk_add_f32 v[48:49], v[48:49], v[52:53]
  v_pk_add_f32 v[42:43], v[42:43], v[46:47]
  v_pk_add_f32 v[50:51], v[50:51], v[54:55]
  v_pk_add_f32 v[40:41], v[40:41], v[48:49]
  v_pk_add_f32 v[42:43], v[42:43], v[50:51]
  s_nop 1
  v_permlane32_swap_b32 v40, v42
  v_permlane32_swap_b32 v41, v43
  v_add_f32 v40, v40, v42
  v_add_f32 v41, v41, v43
  s_nop 1
  v_permlane16_swap_b32 v40, v41
  v_add_f32 v40, v40, v41
  v_mov_b32 v41, v40
  s_nop 1
  v_permlane16_swap_b32 v40, v41
  v_mov_b32 v42, v40
  v_mov_b32 v43, v41
  s_nop 0
  v_permlane32_swap_b32 v40, v42
  v_permlane32_swap_b32 v41, v43
  v_mul_f32 v40, 0x3b000000, v40
  v_mul_f32 v41, 0x3b000000, v41
  v_fma_f32 v41, -v40, v40, v41
  v_max_f32 v41, 0, v41
  v_add_f32 v41, 0x3727c5ac, v41
  v_rsq_f32 v41, v41
  v_fma_f32 v42, -v40, v43, v42
  v_mul_f32 v42, 0x3b000000, v42
  v_fma_f32 v42, v41, v42, v40
  v_mul_f32 v40, v40, v41
  v_pk_fma_f32 v[44:45], v[16:17], v[40:41], v[40:41] op_sel:[0,1,0] op_sel_hi:[1,1,0] neg_lo:[0,0,1] neg_hi:[0,0,1]
  v_pk_fma_f32 v[46:47], v[18:19], v[40:41], v[40:41] op_sel:[0,1,0] op_sel_hi:[1,1,0] neg_lo:[0,0,1] neg_hi:[0,0,1]
  v_pk_fma_f32 v[48:49], v[20:21], v[40:41], v[40:41] op_sel:[0,1,0] op_sel_hi:[1,1,0] neg_lo:[0,0,1] neg_hi:[0,0,1]
  v_pk_fma_f32 v[50:51], v[22:23], v[40:41], v[40:41] op_sel:[0,1,0] op_sel_hi:[1,1,0] neg_lo:[0,0,1] neg_hi:[0,0,1]
  v_pk_fma_f32 v[16:17], v[44:45], v[56:57], v[16:17]
  v_pk_fma_f32 v[18:19], v[46:47], v[58:59], v[18:19]
  v_pk_fma_f32 v[20:21], v[48:49], v[60:61], v[20:21]
  v_pk_fma_f32 v[22:23], v[50:51], v[62:63], v[22:23]
  v_pk_add_f32 v[56:57], v[16:17], v[42:43] op_sel_hi:[1,0] neg_lo:[0,1] neg_hi:[0,1]
  v_pk_add_f32 v[58:59], v[18:19], v[42:43] op_sel_hi:[1,0] neg_lo:[0,1] neg_hi:[0,1]
  v_pk_add_f32 v[60:61], v[20:21], v[42:43] op_sel_hi:[1,0] neg_lo:[0,1] neg_hi:[0,1]
  v_pk_add_f32 v[62:63], v[22:23], v[42:43] op_sel_hi:[1,0] neg_lo:[0,1] neg_hi:[0,1]
  s_add_u32 s3, s68, 0
  v_cvt_pk_bf16_f32 v44, v56, v57
  v_cvt_pk_bf16_f32 v45, v58, v59
  v_cvt_pk_bf16_f32 v46, v60, v61
  v_cvt_pk_bf16_f32 v47, v62, v63
  buffer_store_dwordx4 v[44:47], v1, s[16:19], s3 offen sc1
  v_mul_f32 v40, v56, v56
  v_fmac_f32 v40, v57, v57
  v_fmac_f32 v40, v58, v58
  v_fmac_f32 v40, v59, v59
  v_fmac_f32 v40, v60, v60
  v_fmac_f32 v40, v61, v61
  v_fmac_f32 v40, v62, v62
  v_fmac_f32 v40, v63, v63
  v_mov_b32 v41, v40
  s_nop 0
  s_add_u32 s15, s71, 0
  v_permlane32_swap_b32 v40, v41
  v_add_f32 v40, v40, v41
  v_mov_b32 v41, v40
  s_nop 1
  v_permlane16_swap_b32 v40, v41
  v_add_f32 v40, v40, v41
  buffer_store_dword v40, v6, s[16:19], s15 offen sc1
  s_waitcnt vmcnt(8)
  v_max3_u32 v192, v188, v189, v190
  v_max_u32 v192, v192, v191
  v_cmp_eq_u32 vcc, -1, v192
  s_cbranch_vccnz LS_ytr_7
LS_ytb_9:
  ds_write_b128 v165, v[188:191] offset:4096
  s_waitcnt lgkmcnt(0)
  s_barrier
  ds_read_b64_tr_b16 v[36:37], v166 offset:4096
  ds_read_b64_tr_b16 v[38:39], v166 offset:4352
  s_add_u32 s22, s23, 524288
  s_waitcnt vmcnt(1)
  buffer_store_dword v14, v2, s[16:19], s22 offen sc1
  buffer_store_dword v14, v2, s[16:19], s58 offen sc1
  v_add_u32 v128, 8192, v132
  v_add_u32 v134, 8192, v133
  ds_read_b64_tr_b16 a[144:145], v128 offset:0
  ds_read_b64_tr_b16 a[148:149], v128 offset:12288
  ds_read_b64_tr_b16 a[152:153], v134 offset:0
  ds_read_b64_tr_b16 a[146:147], v128 offset:768
  ds_read_b64_tr_b16 a[150:151], v128 offset:13056
  ds_read_b64_tr_b16 a[154:155], v134 offset:768
  ds_read_b64_tr_b16 a[156:157], v128 offset:6144
  ds_read_b64_tr_b16 a[160:161], v128 offset:18432
  ds_read_b64_tr_b16 a[164:165], v134 offset:6144
  ds_read_b64_tr_b16 a[158:159], v128 offset:6912
  ds_read_b64_tr_b16 a[162:163], v128 offset:19200
  ds_read_b64_tr_b16 a[166:167], v134 offset:6912
  s_waitcnt lgkmcnt(13)
  v_lshlrev_b32 v64, 16, v36
  v_and_b32 v65, 0xffff0000, v36
  v_lshlrev_b32 v66, 16, v37
  v_and_b32 v67, 0xffff0000, v37
  s_waitcnt lgkmcnt(12)
  v_lshlrev_b32 v68, 16, v38
  v_and_b32 v69, 0xffff0000, v38
  v_lshlrev_b32 v70, 16, v39
  v_and_b32 v71, 0xffff0000, v39
  v_mul_f32 v74, v24, v64
  v_add_f32 v75, v64, v65
  v_fmac_f32 v74, v25, v65
  v_fmac_f32 v74, v26, v66
  v_add_f32 v75, v75, v66
  v_fmac_f32 v74, v27, v67
  v_add_f32 v75, v75, v67
  v_fmac_f32 v74, v28, v68
  v_add_f32 v75, v75, v68
  v_fmac_f32 v74, v29, v69
  v_add_f32 v75, v75, v69
  v_fmac_f32 v74, v30, v70
  v_add_f32 v75, v75, v70
  v_fmac_f32 v74, v31, v71
  v_add_f32 v75, v75, v71
  s_nop 0
  v_permlane32_swap_b32 v106, v74
  v_permlane32_swap_b32 v107, v75
  v_add_f32 v106, v106, v74
  v_add_f32 v107, v107, v75
  s_add_u32 s3, s70, 262144
  s_nop 0
  v_permlane16_swap_b32 v106, v107
  v_add_f32 v106, v106, v107
  buffer_store_dword v106, v4, s[16:19], s3 offen sc1
  s_lshl_b32 s20, s69, 1
  s_add_u32 s20, s20, 524288
  buffer_load_dword v123, v12, s[16:19], s20 offen sc1
  s_waitcnt vmcnt(0)
  v_cmp_ne_u32 vcc, s13, v123
  s_cbranch_vccnz LS_xfr_13
LS_xfb_15:
  s_waitcnt lgkmcnt(0)
  s_barrier
  s_add_u32 s21, s72, 262144
  buffer_load_dwordx4 v[232:235], v5, s[16:19], s21 offen offset:0 sc1
  buffer_load_dwordx4 v[236:239], v5, s[16:19], s21 offen offset:256 sc1
  buffer_load_dwordx4 v[240:243], v5, s[16:19], s21 offen offset:512 sc1
  buffer_load_dwordx4 v[244:247], v5, s[16:19], s21 offen offset:768 sc1
  v_lshlrev_b32 v248, 16, v36
  v_and_b32 v249, 0xffff0000, v36
  v_lshlrev_b32 v250, 16, v37
  v_and_b32 v251, 0xffff0000, v37
  v_lshlrev_b32 v252, 16, v38
  v_and_b32 v253, 0xffff0000, v38
  v_lshlrev_b32 v254, 16, v39
  v_and_b32 v255, 0xffff0000, v39
  s_add_u32 m0, s64, 0
  s_mov_b32 s63, 0
  buffer_load_dwordx4 v8, s[16:19], s63 offen offset:0 sc1 lds
  buffer_load_dwordx4 v8, s[16:19], s63 offen offset:1024 sc1 lds
  buffer_load_dwordx4 v8, s[16:19], s63 offen offset:2048 sc1 lds
  buffer_load_dwordx4 v8, s[16:19], s63 offen offset:3072 sc1 lds
  s_add_u32 m0, s64, 8192
  s_mov_b32 s63, 8192
  buffer_load_dwordx4 v8, s[16:19], s63 offen offset:0 sc1 lds
  buffer_load_dwordx4 v8, s[16:19], s63 offen offset:1024 sc1 lds
  buffer_load_dwordx4 v8, s[16:19], s63 offen offset:2048 sc1 lds
  buffer_load_dwordx4 v8, s[16:19], s63 offen offset:3072 sc1 lds
  s_mul_i32 s3, s7, -327680
  s_add_u32 s3, s3, -2097152
  v_and_b32 v136, 1, v137
  v_mul_u32_u24 v136, 999424, v136
  s_mul_i32 s15, s9, 999424
  v_add_u32 v136, s3, v136
  s_add_u32 s3, s3, s15
  v_add_u32 v138, v11, v136
  v_add_u32 v136, v10, v136
  v_add_u32 v135, s3, v9
  s_waitcnt vmcnt(8)
  v_max3_u32 v122, v232, v233, v234
  v_max3_u32 v122, v122, v235, v236
  v_max3_u32 v122, v122, v237, v238
  v_max3_u32 v122, v122, v239, v240
  v_max3_u32 v122, v122, v241, v242
  v_max3_u32 v122, v122, v243, v244
  v_max3_u32 v122, v122, v245, v246
  v_max_u32 v122, v122, v247
  v_cmp_eq_u32 vcc, -1, v122
  s_cbranch_vccnz LS_grr_4
LS_grb_6:
  v_pk_add_f32 v[232:233], v[232:233], v[236:237]
  v_pk_add_f32 v[240:241], v[240:241], v[244:245]
  v_pk_add_f32 v[234:235], v[234:235], v[238:239]
  v_pk_add_f32 v[242:243], v[242:243], v[246:247]
  v_pk_add_f32 v[232:233], v[232:233], v[240:241]
  v_pk_add_f32 v[234:235], v[234:235], v[242:243]
  s_nop 1
  v_permlane32_swap_b32 v232, v234
  v_permlane32_swap_b32 v233, v235
  v_add_f32 v232, v232, v234
  v_add_f32 v233, v233, v235
  s_nop 1
  v_permlane16_swap_b32 v232, v233
  v_add_f32 v232, v232, v233
  v_mov_b32 v233, v232
  s_nop 1
  v_permlane16_swap_b32 v232, v233
  v_mov_b32 v234, v232
  v_mov_b32 v235, v233
  s_nop 0
  v_permlane32_swap_b32 v232, v234
  v_permlane32_swap_b32 v233, v235
  v_mul_f32 v232, 0x3b000000, v232
  v_mul_f32 v233, 0x3b000000, v233
  v_fma_f32 v233, -v232, v232, v233
  v_max_f32 v233, 0, v233
  v_add_f32 v233, 0x3727c5ac, v233
  v_rsq_f32 v233, v233
  v_fma_f32 v234, -v232, v235, v234
  v_mul_f32 v234, 0x3b000000, v234
  v_fma_f32 v234, v233, v234, v232
  v_mul_f32 v232, v232, v233
  v_pk_fma_f32 v[236:237], v[24:25], v[232:233], v[232:233] op_sel:[0,1,0] op_sel_hi:[1,1,0] neg_lo:[0,0,1] neg_hi:[0,0,1]
  v_pk_fma_f32 v[238:239], v[26:27], v[232:233], v[232:233] op_sel:[0,1,0] op_sel_hi:[1,1,0] neg_lo:[0,0,1] neg_hi:[0,0,1]
  v_pk_fma_f32 v[240:241], v[28:29], v[232:233], v[232:233] op_sel:[0,1,0] op_sel_hi:[1,1,0] neg_lo:[0,0,1] neg_hi:[0,0,1]
  v_pk_fma_f32 v[242:243], v[30:31], v[232:233], v[232:233] op_sel:[0,1,0] op_sel_hi:[1,1,0] neg_lo:[0,0,1] neg_hi:[0,0,1]
  v_pk_fma_f32 v[24:25], v[236:237], v[248:249], v[24:25]
  v_pk_fma_f32 v[26:27], v[238:239], v[250:251], v[26:27]
  v_pk_fma_f32 v[28:29], v[240:241], v[252:253], v[28:29]
  v_pk_fma_f32 v[30:31], v[242:243], v[254:255], v[30:31]
  v_pk_add_f32 v[248:249], v[24:25], v[234:235] op_sel_hi:[1,0] neg_lo:[0,1] neg_hi:[0,1]
  v_pk_add_f32 v[250:251], v[26:27], v[234:235] op_sel_hi:[1,0] neg_lo:[0,1] neg_hi:[0,1]
  v_pk_add_f32 v[252:253], v[28:29], v[234:235] op_sel_hi:[1,0] neg_lo:[0,1] neg_hi:[0,1]
  v_pk_add_f32 v[254:255], v[30:31], v[234:235] op_sel_hi:[1,0] neg_lo:[0,1] neg_hi:[0,1]
  s_add_u32 s3, s68, 65536
  v_cvt_pk_bf16_f32 v236, v248, v249
  v_cvt_pk_bf16_f32 v237, v250, v251
  v_cvt_pk_bf16_f32 v238, v252, v253
  v_cvt_pk_bf16_f32 v239, v254, v255
  buffer_store_dwordx4 v[236:239], v1, s[16:19], s3 offen sc1
  v_add_u32 v112, 0, v1
  s_waitcnt vmcnt(5)
  s_barrier
  ds_read_b128 v[88:91], v112 offset:0
  ds_read_b128 v[92:95], v112 offset:16384
  ds_read_b128 v[96:99], v112 offset:1024
  ds_read_b128 v[100:103], v112 offset:17408
  s_waitcnt lgkmcnt(2)
  v_mfma_f32_16x16x32_bf16 v[40:43], a[0:3], v[88:91], 0
  s_add_u32 m0, s64, 32768
  s_mov_b32 s63, 32768
  ds_read_b128 v[104:107], v112 offset:2048
  v_mfma_f32_16x16x32_bf16 v[44:47], a[4:7], v[88:91], 0
  s_add_u32 s22, s23, 524544
  buffer_load_dwordx4 v8, s[16:19], s63 offen offset:0 sc1 lds
  ds_read_b128 v[108:111], v112 offset:18432
  v_mfma_f32_16x16x32_bf16 v[48:51], a[8:11], v[88:91], 0
  buffer_load_dword v124, v125, s[16:19], s24 offen sc1
  v_add_u32 v128, 65536, v132
  v_mfma_f32_16x16x32_bf16 v[52:55], a[0:3], v[92:95], 0
  ds_read_b64_tr_b16 a[168:169], v128 offset:0
  v_add_u32 v134, 65536, v133
  v_mfma_f32_16x16x32_bf16 v[56:59], a[4:7], v[92:95], 0
  ds_read_b64_tr_b16 a[172:173], v128 offset:12288
  ds_read_b64_tr_b16 a[176:177], v134 offset:0
  v_mfma_f32_16x16x32_bf16 v[60:63], a[8:11], v[92:95], 0
  s_waitcnt lgkmcnt(5)
  ds_read_b64_tr_b16 a[170:171], v128 offset:768
  ds_read_b64_tr_b16 a[174:175], v128 offset:13056
  v_mfma_f32_16x16x32_bf16 v[40:43], a[12:15], v[96:99], v[40:43]
  buffer_load_dwordx4 v8, s[16:19], s63 offen offset:1024 sc1 lds
  ds_read_b128 v[88:91], v112 offset:3072
  v_mfma_f32_16x16x32_bf16 v[44:47], a[16:19], v[96:99], v[44:47]
  ds_read_b64_tr_b16 a[178:179], v134 offset:768
  ds_read_b128 v[92:95], v112 offset:19456
  v_mfma_f32_16x16x32_bf16 v[48:51], a[20:23], v[96:99], v[48:51]
  ds_read_b64_tr_b16 a[180:181], v128 offset:6144
  ds_read_b64_tr_b16 a[184:185], v128 offset:18432
  v_mfma_f32_16x16x32_bf16 v[52:55], a[12:15], v[100:103], v[52:55]
  ds_read_b64_tr_b16 a[188:189], v134 offset:6144
  ds_read_b64_tr_b16 a[182:183], v128 offset:6912
  v_mfma_f32_16x16x32_bf16 v[56:59], a[16:19], v[100:103], v[56:59]
  ds_read_b64_tr_b16 a[186:187], v128 offset:19200
  ds_read_b64_tr_b16 a[190:191], v134 offset:6912
  v_mfma_f32_16x16x32_bf16 v[60:63], a[20:23], v[100:103], v[60:63]
  s_waitcnt lgkmcnt(14)
  buffer_load_dwordx4 v8, s[16:19], s63 offen offset:2048 sc1 lds
  v_mul_f32 v232, v248, v248
  v_mfma_f32_16x16x32_bf16 v[40:43], a[24:27], v[104:107], v[40:43]
  ds_read_b128 v[96:99], v112 offset:4096
  v_fmac_f32 v232, v249, v249
  v_mfma_f32_16x16x32_bf16 v[44:47], a[28:31], v[104:107], v[44:47]
  ds_read_b128 v[100:103], v112 offset:20480
  v_fmac_f32 v232, v250, v250
  v_mfma_f32_16x16x32_bf16 v[48:51], a[32:35], v[104:107], v[48:51]
  s_waitcnt lgkmcnt(2)
  s_barrier
  v_fmac_f32 v232, v251, v251
  v_mfma_f32_16x16x32_bf16 v[52:55], a[24:27], v[108:111], v[52:55]
  buffer_load_dwordx4 v8, s[16:19], s63 offen offset:3072 sc1 lds
  s_add_u32 m0, s64, 40960
  s_mov_b32 s63, 40960
  v_mfma_f32_16x16x32_bf16 v[56:59], a[28:31], v[108:111], v[56:59]
  v_fmac_f32 v232, v252, v252
  v_fmac_f32 v232, v253, v253
  v_mfma_f32_16x16x32_bf16 v[60:63], a[32:35], v[108:111], v[60:63]
  v_fmac_f32 v232, v254, v254
  v_fmac_f32 v232, v255, v255
  v_mfma_f32_16x16x32_bf16 v[40:43], a[36:39], v[88:91], v[40:43]
  buffer_load_dwordx4 v8, s[16:19], s63 offen offset:0 sc1 lds
  ds_read_b128 v[104:107], v112 offset:5120
  v_mfma_f32_16x16x32_bf16 v[44:47], a[40:43], v[88:91], v[44:47]
  v_mov_b32 v233, v232
  s_nop 0
  ds_read_b128 v[108:111], v112 offset:21504
  v_mfma_f32_16x16x32_bf16 v[48:51], a[44:47], v[88:91], v[48:51]
  s_add_u32 s15, s71, 65536
  v_permlane32_swap_b32 v232, v233
  v_mfma_f32_16x16x32_bf16 v[52:55], a[36:39], v[92:95], v[52:55]
  v_add_f32 v232, v232, v233
  v_mov_b32 v233, v232
  v_mfma_f32_16x16x32_bf16 v[56:59], a[40:43], v[92:95], v[56:59]
  s_nop 0
  v_permlane16_swap_b32 v232, v233
  v_mfma_f32_16x16x32_bf16 v[60:63], a[44:47], v[92:95], v[60:63]
  s_waitcnt lgkmcnt(2)
  buffer_load_dwordx4 v8, s[16:19], s63 offen offset:1024 sc1 lds
  v_add_f32 v232, v232, v233
  v_mfma_f32_16x16x32_bf16 v[40:43], a[48:51], v[96:99], v[40:43]
  buffer_store_dword v232, v6, s[16:19], s15 offen sc1
  ds_read_b128 v[88:91], v112 offset:6144
  v_mfma_f32_16x16x32_bf16 v[44:47], a[52:55], v[96:99], v[44:47]
  ds_read_b128 v[92:95], v112 offset:22528
  v_mfma_f32_16x16x32_bf16 v[48:51], a[56:59], v[96:99], v[48:51]
  v_mfma_f32_16x16x32_bf16 v[52:55], a[48:51], v[100:103], v[52:55]
  v_mfma_f32_16x16x32_bf16 v[56:59], a[52:55], v[100:103], v[56:59]
  buffer_load_dwordx4 v8, s[16:19], s63 offen offset:2048 sc1 lds
  v_mfma_f32_16x16x32_bf16 v[60:63], a[56:59], v[100:103], v[60:63]
  s_waitcnt lgkmcnt(2)
  v_mfma_f32_16x16x32_bf16 v[40:43], a[60:63], v[104:107], v[40:43]
  ds_read_b128 v[96:99], v112 offset:7168
  v_mfma_f32_16x16x32_bf16 v[44:47], a[64:67], v[104:107], v[44:47]
  ds_read_b128 v[100:103], v112 offset:23552
  v_mfma_f32_16x16x32_bf16 v[48:51], a[68:71], v[104:107], v[48:51]
  v_mfma_f32_16x16x32_bf16 v[52:55], a[60:63], v[108:111], v[52:55]
  buffer_load_dwordx4 v8, s[16:19], s63 offen offset:3072 sc1 lds
  v_mfma_f32_16x16x32_bf16 v[56:59], a[64:67], v[108:111], v[56:59]
  v_mfma_f32_16x16x32_bf16 v[60:63], a[68:71], v[108:111], v[60:63]
  s_waitcnt lgkmcnt(2)
  v_mfma_f32_16x16x32_bf16 v[40:43], a[72:75], v[88:91], v[40:43]
  s_waitcnt vmcnt(11)
  s_barrier
  ds_read_b128 v[104:107], v112 offset:8192
  v_mfma_f32_16x16x32_bf16 v[44:47], a[76:79], v[88:91], v[44:47]
  ds_read_b128 v[108:111], v112 offset:24576
  v_mfma_f32_16x16x32_bf16 v[48:51], a[80:83], v[88:91], v[48:51]
  v_mfma_f32_16x16x32_bf16 v[52:55], a[72:75], v[92:95], v[52:55]
  v_mfma_f32_16x16x32_bf16 v[56:59], a[76:79], v[92:95], v[56:59]
  v_mfma_f32_16x16x32_bf16 v[60:63], a[80:83], v[92:95], v[60:63]
  s_waitcnt lgkmcnt(2)
  v_mfma_f32_16x16x32_bf16 v[40:43], a[84:87], v[96:99], v[40:43]
  ds_read_b128 v[88:91], v112 offset:9216
  v_mfma_f32_16x16x32_bf16 v[44:47], a[88:91], v[96:99], v[44:47]
  ds_read_b128 v[92:95], v112 offset:25600
  v_mfma_f32_16x16x32_bf16 v[48:51], a[92:95], v[96:99], v[48:51]
  v_mfma_f32_16x16x32_bf16 v[52:55], a[84:87], v[100:103], v[52:55]
  v_mfma_f32_16x16x32_bf16 v[56:59], a[88:91], v[100:103], v[56:59]
  v_mfma_f32_16x16x32_bf16 v[60:63], a[92:95], v[100:103], v[60:63]
  s_waitcnt lgkmcnt(2)
  v_mfma_f32_16x16x32_bf16 v[40:43], a[96:99], v[104:107], v[40:43]
  ds_read_b128 v[96:99], v112 offset:10240
  v_mfma_f32_16x16x32_bf16 v[44:47], a[100:103], v[104:107], v[44:47]
  ds_read_b128 v[100:103], v112 offset:26624
  v_mfma_f32_16x16x32_bf16 v[48:51], a[104:107], v[104:107], v[48:51]
  v_mfma_f32_16x16x32_bf16 v[52:55], a[96:99], v[108:111], v[52:55]
  v_mfma_f32_16x16x32_bf16 v[56:59], a[100:103], v[108:111], v[56:59]
  s_waitcnt vmcnt(10)
  buffer_store_dword v14, v2, s[16:19], s22 offen sc1
  v_mfma_f32_16x16x32_bf16 v[60:63], a[104:107], v[108:111], v[60:63]
  s_waitcnt vmcnt(9)
  v_cmp_ne_u32 vcc, s13, v124
  s_cbranch_vccnz LS_ppr_10
LS_ppb_12:
  s_waitcnt lgkmcnt(2)
  v_mfma_f32_16x16x32_bf16 v[40:43], a[108:111], v[88:91], v[40:43]
  buffer_load_dwordx4 v[144:147], v1, s[16:19], s59 offen offset:0 sc1
  ds_read_b128 v[104:107], v112 offset:11264
  v_mfma_f32_16x16x32_bf16 v[44:47], a[112:115], v[88:91], v[44:47]
  buffer_load_dwordx4 v[148:151], v1, s[16:19], s59 offen offset:1024 sc1
  ds_read_b128 v[108:111], v112 offset:27648
  v_mfma_f32_16x16x32_bf16 v[48:51], a[116:119], v[88:91], v[48:51]
  v_mfma_f32_16x16x32_bf16 v[52:55], a[108:111], v[92:95], v[52:55]
  v_mfma_f32_16x16x32_bf16 v[56:59], a[112:115], v[92:95], v[56:59]
  buffer_load_dwordx4 v[152:155], v1, s[16:19], s77 offen offset:2048 sc1
  v_mfma_f32_16x16x32_bf16 v[60:63], a[116:119], v[92:95], v[60:63]
  s_waitcnt lgkmcnt(2)
  v_mfma_f32_16x16x32_bf16 v[40:43], a[120:123], v[96:99], v[40:43]
  ds_read_b128 v[88:91], v112 offset:12288
  v_mfma_f32_16x16x32_bf16 v[44:47], a[124:127], v[96:99], v[44:47]
  ds_read_b128 v[92:95], v112 offset:28672
  v_mfma_f32_16x16x32_bf16 v[48:51], a[128:131], v[96:99], v[48:51]
  s_add_u32 s56, s77, 4096
  buffer_load_dwordx4 v[156:159], v1, s[16:19], s77 offen offset:3072 sc1
  v_mfma_f32_16x16x32_bf16 v[52:55], a[120:123], v[100:103], v[52:55]
  v_mfma_f32_16x16x32_bf16 v[56:59], a[124:127], v[100:103], v[56:59]
  v_mfma_f32_16x16x32_bf16 v[60:63], a[128:131], v[100:103], v[60:63]
  s_waitcnt lgkmcnt(2)
  v_mfma_f32_16x16x32_bf16 v[40:43], a[132:135], v[104:107], v[40:43]
  buffer_load_dwordx4 v[160:163], v1, s[16:19], s56 offen offset:0 sc1
  ds_read_b128 v[96:99], v112 offset:13312
  v_mfma_f32_16x16x32_bf16 v[44:47], a[136:139], v[104:107], v[44:47]
  ds_read_b128 v[100:103], v112 offset:29696
  v_mfma_f32_16x16x32_bf16 v[48:51], a[140:143], v[104:107], v[48:51]
  v_mfma_f32_16x16x32_bf16 v[52:55], a[132:135], v[108:111], v[52:55]
  v_mfma_f32_16x16x32_bf16 v[56:59], a[136:139], v[108:111], v[56:59]
  buffer_load_dwordx4 v[164:167], v1, s[16:19], s56 offen offset:1024 sc1
  v_mfma_f32_16x16x32_bf16 v[60:63], a[140:143], v[108:111], v[60:63]
  s_waitcnt lgkmcnt(2)
  v_mfma_f32_16x16x32_bf16 v[40:43], a[144:147], v[88:91], v[40:43]
  ds_read_b128 v[104:107], v112 offset:14336
  v_mfma_f32_16x16x32_bf16 v[44:47], a[148:151], v[88:91], v[44:47]
  buffer_load_dwordx4 v[168:171], v1, s[16:19], s56 offen offset:2048 sc1
  ds_read_b128 v[108:111], v112 offset:30720
  v_mfma_f32_16x16x32_bf16 v[48:51], a[152:155], v[88:91], v[48:51]
  v_mfma_f32_16x16x32_bf16 v[52:55], a[144:147], v[92:95], v[52:55]
  v_mfma_f32_16x16x32_bf16 v[56:59], a[148:151], v[92:95], v[56:59]
  v_mfma_f32_16x16x32_bf16 v[60:63], a[152:155], v[92:95], v[60:63]
  buffer_load_dwordx4 v[172:175], v1, s[16:19], s56 offen offset:3072 sc1
  s_add_u32 s56, s77, 8192
  s_waitcnt lgkmcnt(2)
  v_mfma_f32_16x16x32_bf16 v[40:43], a[156:159], v[96:99], v[40:43]
  ds_read_b128 v[88:91], v112 offset:15360
  v_mfma_f32_16x16x32_bf16 v[44:47], a[160:163], v[96:99], v[44:47]
  ds_read_b128 v[92:95], v112 offset:31744
  v_mfma_f32_16x16x32_bf16 v[48:51], a[164:167], v[96:99], v[48:51]
  v_mfma_f32_16x16x32_bf16 v[52:55], a[156:159], v[100:103], v[52:55]
  v_mfma_f32_16x16x32_bf16 v[56:59], a[160:163], v[100:103], v[56:59]
  s_lshl_b32 s20, s69, 1
  s_add_u32 s20, s20, 524544
  buffer_load_dword v123, v12, s[16:19], s20 offen sc1
  v_mfma_f32_16x16x32_bf16 v[60:63], a[164:167], v[100:103], v[60:63]
  s_waitcnt lgkmcnt(2)
  v_mfma_f32_16x16x32_bf16 v[40:43], a[168:171], v[104:107], v[40:43]
  s_waitcnt vmcnt(10)
  v_add_u32 v112, 0, v1
  s_barrier
  ds_read_b128 v[96:99], v112 offset:32768
  v_mfma_f32_16x16x32_bf16 v[44:47], a[172:175], v[104:107], v[44:47]
  buffer_load_dwordx4 v[176:179], v1, s[16:19], s56 offen offset:0 sc1
  ds_read_b128 v[100:103], v112 offset:49152
  v_mfma_f32_16x16x32_bf16 v[48:51], a[176:179], v[104:107], v[48:51]
  v_mfma_f32_16x16x32_bf16 v[52:55], a[168:171], v[108:111], v[52:55]
  v_mfma_f32_16x16x32_bf16 v[56:59], a[172:175], v[108:111], v[56:59]
  buffer_load_dwordx4 v[180:183], v1, s[16:19], s56 offen offset:1024 sc1
  v_mfma_f32_16x16x32_bf16 v[60:63], a[176:179], v[108:111], v[60:63]
  s_waitcnt lgkmcnt(2)
  v_mfma_f32_16x16x32_bf16 v[40:43], a[180:183], v[88:91], v[40:43]
  ds_read_b128 v[104:107], v112 offset:33792
  v_mfma_f32_16x16x32_bf16 v[44:47], a[184:187], v[88:91], v[44:47]
  buffer_load_dwordx4 v[184:187], v1, s[16:19], s56 offen offset:2048 sc1
  ds_read_b128 v[108:111], v112 offset:50176
  v_mfma_f32_16x16x32_bf16 v[48:51], a[188:191], v[88:91], v[48:51]
  v_mfma_f32_16x16x32_bf16 v[52:55], a[180:183], v[92:95], v[52:55]
  v_mfma_f32_16x16x32_bf16 v[56:59], a[184:187], v[92:95], v[56:59]
  v_mfma_f32_16x16x32_bf16 v[60:63], a[188:191], v[92:95], v[60:63]
  buffer_load_dwordx4 v[188:191], v1, s[16:19], s56 offen offset:3072 sc1
  s_add_u32 s56, s77, 12288
  s_waitcnt lgkmcnt(2)
  v_mfma_f32_16x16x32_bf16 v[64:67], a[0:3], v[96:99], 0
  ds_read_b128 v[88:91], v112 offset:34816
  v_mfma_f32_16x16x32_bf16 v[68:71], a[4:7], v[96:99], 0
  ds_read_b128 v[92:95], v112 offset:51200
  v_max_f32 v40, 0, v40
  v_max_f32 v41, 0, v41
  v_max_f32 v42, 0, v42
  v_max_f32 v43, 0, v43
  v_mul_f32 v40, v40, v44
  v_mul_f32 v41, v41, v45
  v_mul_f32 v42, v42, v46
  v_mfma_f32_16x16x32_bf16 v[72:75], a[8:11], v[96:99], 0
  buffer_load_dwordx4 v[192:195], v1, s[16:19], s56 offen offset:0 sc1
  v_mul_f32 v43, v43, v47
  v_cvt_pk_bf16_f32 v114, v40, v41
  v_cvt_pk_bf16_f32 v115, v42, v43
  v_max_f32 v52, 0, v52
  v_max_f32 v53, 0, v53
  v_max_f32 v54, 0, v54
  v_max_f32 v55, 0, v55
  v_mfma_f32_16x16x32_bf16 v[76:79], a[0:3], v[100:103], 0
  buffer_load_dwordx4 v[196:199], v1, s[16:19], s56 offen offset:1024 sc1
  v_mul_f32 v52, v52, v56
  v_mul_f32 v53, v53, v57
  v_mul_f32 v54, v54, v58
  v_mul_f32 v55, v55, v59
  v_cvt_pk_bf16_f32 v116, v52, v53
  v_cvt_pk_bf16_f32 v117, v54, v55
  v_mfma_f32_16x16x32_bf16 v[80:83], a[4:7], v[100:103], 0
  buffer_load_dwordx4 v[200:203], v1, s[16:19], s56 offen offset:2048 sc1
  v_permlane16_swap_b32 v48, v60
  v_permlane16_swap_b32 v49, v61
  v_permlane16_swap_b32 v50, v62
  v_mfma_f32_16x16x32_bf16 v[84:87], a[8:11], v[100:103], 0
  s_mov_b32 s15, 0
  s_waitcnt lgkmcnt(2)
  v_permlane16_swap_b32 v51, v63
  v_permlane16_swap_b32 v114, v116
  v_permlane16_swap_b32 v115, v117
  buffer_store_dwordx4 v[114:117], v10, s[16:19], s15 offen sc1
  v_mfma_f32_16x16x32_bf16 v[64:67], a[12:15], v[104:107], v[64:67]
  s_waitcnt vmcnt(8)
  v_cmp_ne_u32 vcc, s13, v123
  s_cbranch_vccnz LS_xfr_16
LS_xfb_18:
  v_max_f32 v48, 0, v48
  v_max_f32 v49, 0, v49
  v_max_f32 v50, 0, v50
  v_max_f32 v51, 0, v51
  v_mul_f32 v48, v48, v60
  ds_read_b128 v[96:99], v112 offset:35840
  v_mfma_f32_16x16x32_bf16 v[68:71], a[16:19], v[104:107], v[68:71]
  s_add_u32 m0, s64, 65536
  s_mov_b32 s63, 65536
  v_mul_f32 v49, v49, v61
  v_mul_f32 v50, v50, v62
  v_mul_f32 v51, v51, v63
  v_cvt_pk_bf16_f32 v118, v48, v49
  v_cvt_pk_bf16_f32 v119, v50, v51
  v_mov_b32 v120, v118
  ds_read_b128 v[100:103], v112 offset:52224
  v_mfma_f32_16x16x32_bf16 v[72:75], a[20:23], v[104:107], v[72:75]
  buffer_load_dwordx4 v8, s[16:19], s63 offen offset:0 sc1 lds
  v_mov_b32 v121, v119
  s_nop 0
  v_permlane32_swap_b32 v118, v120
  v_permlane32_swap_b32 v119, v121
  buffer_store_dwordx4 v[118:121], v11, s[16:19], s15 offen sc1
  v_mfma_f32_16x16x32_bf16 v[76:79], a[12:15], v[108:111], v[76:79]
  s_add_u32 s22, s23, 557056
  v_mfma_f32_16x16x32_bf16 v[80:83], a[16:19], v[108:111], v[80:83]
  v_mfma_f32_16x16x32_bf16 v[84:87], a[20:23], v[108:111], v[84:87]
  s_waitcnt lgkmcnt(2)
  v_mfma_f32_16x16x32_bf16 v[64:67], a[24:27], v[88:91], v[64:67]
  ds_read_b128 v[104:107], v112 offset:36864
  v_mfma_f32_16x16x32_bf16 v[68:71], a[28:31], v[88:91], v[68:71]
  ds_read_b128 v[108:111], v112 offset:53248
  v_mfma_f32_16x16x32_bf16 v[72:75], a[32:35], v[88:91], v[72:75]
  v_mfma_f32_16x16x32_bf16 v[76:79], a[24:27], v[92:95], v[76:79]
  v_mfma_f32_16x16x32_bf16 v[80:83], a[28:31], v[92:95], v[80:83]
  buffer_load_dwordx4 v8, s[16:19], s63 offen offset:1024 sc1 lds
  v_mfma_f32_16x16x32_bf16 v[84:87], a[32:35], v[92:95], v[84:87]
  s_waitcnt lgkmcnt(2)
  v_mfma_f32_16x16x32_bf16 v[64:67], a[36:39], v[96:99], v[64:67]
  ds_read_b128 v[88:91], v112 offset:37888
  v_mfma_f32_16x16x32_bf16 v[68:71], a[40:43], v[96:99], v[68:71]
  ds_read_b128 v[92:95], v112 offset:54272
  v_mfma_f32_16x16x32_bf16 v[72:75], a[44:47], v[96:99], v[72:75]
  buffer_load_dwordx4 v8, s[16:19], s63 offen offset:2048 sc1 lds
  v_mfma_f32_16x16x32_bf16 v[76:79], a[36:39], v[100:103], v[76:79]
  v_mfma_f32_16x16x32_bf16 v[80:83], a[40:43], v[100:103], v[80:83]
  v_mfma_f32_16x16x32_bf16 v[84:87], a[44:47], v[100:103], v[84:87]
  s_waitcnt lgkmcnt(2)
  v_mfma_f32_16x16x32_bf16 v[64:67], a[48:51], v[104:107], v[64:67]
  ds_read_b128 v[96:99], v112 offset:38912
  v_mfma_f32_16x16x32_bf16 v[68:71], a[52:55], v[104:107], v[68:71]
  buffer_load_dwordx4 v8, s[16:19], s63 offen offset:3072 sc1 lds
  s_add_u32 m0, s64, 73728
  ds_read_b128 v[100:103], v112 offset:55296
  v_mfma_f32_16x16x32_bf16 v[72:75], a[56:59], v[104:107], v[72:75]
  s_mov_b32 s63, 73728
  v_mfma_f32_16x16x32_bf16 v[76:79], a[48:51], v[108:111], v[76:79]
  v_mfma_f32_16x16x32_bf16 v[80:83], a[52:55], v[108:111], v[80:83]
  v_mfma_f32_16x16x32_bf16 v[84:87], a[56:59], v[108:111], v[84:87]
  s_waitcnt lgkmcnt(2)
  v_mfma_f32_16x16x32_bf16 v[64:67], a[60:63], v[88:91], v[64:67]
  buffer_load_dwordx4 v8, s[16:19], s63 offen offset:0 sc1 lds
  ds_read_b128 v[104:107], v112 offset:39936
  v_mfma_f32_16x16x32_bf16 v[68:71], a[64:67], v[88:91], v[68:71]
  ds_read_b128 v[108:111], v112 offset:56320
  v_mfma_f32_16x16x32_bf16 v[72:75], a[68:71], v[88:91], v[72:75]
  v_mfma_f32_16x16x32_bf16 v[76:79], a[60:63], v[92:95], v[76:79]
  v_mfma_f32_16x16x32_bf16 v[80:83], a[64:67], v[92:95], v[80:83]
  buffer_load_dwordx4 v8, s[16:19], s63 offen offset:1024 sc1 lds
  v_mfma_f32_16x16x32_bf16 v[84:87], a[68:71], v[92:95], v[84:87]
  s_waitcnt lgkmcnt(2)
  v_mfma_f32_16x16x32_bf16 v[64:67], a[72:75], v[96:99], v[64:67]
  ds_read_b128 v[88:91], v112 offset:40960
  v_mfma_f32_16x16x32_bf16 v[68:71], a[76:79], v[96:99], v[68:71]
  ds_read_b128 v[92:95], v112 offset:57344
  v_mfma_f32_16x16x32_bf16 v[72:75], a[80:83], v[96:99], v[72:75]
  v_mfma_f32_16x16x32_bf16 v[76:79], a[72:75], v[100:103], v[76:79]
  buffer_load_dwordx4 v8, s[16:19], s63 offen offset:2048 sc1 lds
  v_mfma_f32_16x16x32_bf16 v[80:83], a[76:79], v[100:103], v[80:83]
  v_mfma_f32_16x16x32_bf16 v[84:87], a[80:83], v[100:103], v[84:87]
  s_waitcnt lgkmcnt(2)
  v_mfma_f32_16x16x32_bf16 v[64:67], a[84:87], v[104:107], v[64:67]
  ds_read_b128 v[96:99], v112 offset:41984
  v_mfma_f32_16x16x32_bf16 v[68:71], a[88:91], v[104:107], v[68:71]
  ds_read_b128 v[100:103], v112 offset:58368
  v_mfma_f32_16x16x32_bf16 v[72:75], a[92:95], v[104:107], v[72:75]
  buffer_load_dwordx4 v8, s[16:19], s63 offen offset:3072 sc1 lds
  s_add_u32 m0, s64, 98304
  s_mov_b32 s63, 98304
  v_mfma_f32_16x16x32_bf16 v[76:79], a[84:87], v[108:111], v[76:79]
  v_mfma_f32_16x16x32_bf16 v[80:83], a[88:91], v[108:111], v[80:83]
  v_mfma_f32_16x16x32_bf16 v[84:87], a[92:95], v[108:111], v[84:87]
  s_waitcnt lgkmcnt(2)
  v_mfma_f32_16x16x32_bf16 v[64:67], a[96:99], v[88:91], v[64:67]
  ds_read_b128 v[104:107], v112 offset:43008
  v_mfma_f32_16x16x32_bf16 v[68:71], a[100:103], v[88:91], v[68:71]
  buffer_load_dwordx4 v8, s[16:19], s63 offen offset:0 sc1 lds
  ds_read_b128 v[108:111], v112 offset:59392
  v_mfma_f32_16x16x32_bf16 v[72:75], a[104:107], v[88:91], v[72:75]
  v_mfma_f32_16x16x32_bf16 v[76:79], a[96:99], v[92:95], v[76:79]
  v_mfma_f32_16x16x32_bf16 v[80:83], a[100:103], v[92:95], v[80:83]
  v_mfma_f32_16x16x32_bf16 v[84:87], a[104:107], v[92:95], v[84:87]
  s_waitcnt lgkmcnt(2)
  v_mfma_f32_16x16x32_bf16 v[64:67], a[108:111], v[96:99], v[64:67]
  buffer_load_dwordx4 v8, s[16:19], s63 offen offset:1024 sc1 lds
  ds_read_b128 v[88:91], v112 offset:44032
  v_mfma_f32_16x16x32_bf16 v[68:71], a[112:115], v[96:99], v[68:71]
  ds_read_b128 v[92:95], v112 offset:60416
  v_mfma_f32_16x16x32_bf16 v[72:75], a[116:119], v[96:99], v[72:75]
  v_mfma_f32_16x16x32_bf16 v[76:79], a[108:111], v[100:103], v[76:79]
  v_mfma_f32_16x16x32_bf16 v[80:83], a[112:115], v[100:103], v[80:83]
  v_mfma_f32_16x16x32_bf16 v[84:87], a[116:119], v[100:103], v[84:87]
  s_waitcnt lgkmcnt(2)
  buffer_load_dwordx4 v8, s[16:19], s63 offen offset:2048 sc1 lds
  v_mfma_f32_16x16x32_bf16 v[64:67], a[120:123], v[104:107], v[64:67]
  ds_read_b128 v[96:99], v112 offset:45056
  v_mfma_f32_16x16x32_bf16 v[68:71], a[124:127], v[104:107], v[68:71]
  ds_read_b128 v[100:103], v112 offset:61440
  v_mfma_f32_16x16x32_bf16 v[72:75], a[128:131], v[104:107], v[72:75]
  v_mfma_f32_16x16x32_bf16 v[76:79], a[120:123], v[108:111], v[76:79]
  buffer_load_dwordx4 v8, s[16:19], s63 offen offset:3072 sc1 lds
  s_add_u32 m0, s64, 106496
  s_mov_b32 s63, 106496
  v_mfma_f32_16x16x32_bf16 v[80:83], a[124:127], v[108:111], v[80:83]
  v_mfma_f32_16x16x32_bf16 v[84:87], a[128:131], v[108:111], v[84:87]
  s_waitcnt lgkmcnt(2)
  v_mfma_f32_16x16x32_bf16 v[64:67], a[132:135], v[88:91], v[64:67]
  ds_read_b128 v[104:107], v112 offset:46080
  v_mfma_f32_16x16x32_bf16 v[68:71], a[136:139], v[88:91], v[68:71]
  ds_read_b128 v[108:111], v112 offset:62464
  v_mfma_f32_16x16x32_bf16 v[72:75], a[140:143], v[88:91], v[72:75]
  buffer_load_dwordx4 v8, s[16:19], s63 offen offset:0 sc1 lds
  v_mfma_f32_16x16x32_bf16 v[76:79], a[132:135], v[92:95], v[76:79]
  v_mfma_f32_16x16x32_bf16 v[80:83], a[136:139], v[92:95], v[80:83]
  v_mfma_f32_16x16x32_bf16 v[84:87], a[140:143], v[92:95], v[84:87]
  s_waitcnt lgkmcnt(2)
  v_mfma_f32_16x16x32_bf16 v[64:67], a[144:147], v[96:99], v[64:67]
  s_waitcnt vmcnt(12)
  buffer_store_dword v14, v2, s[16:19], s22 offen sc1
  ds_read_b128 v[88:91], v112 offset:47104
  v_mfma_f32_16x16x32_bf16 v[68:71], a[148:151], v[96:99], v[68:71]
  ds_read_b128 v[92:95], v112 offset:63488
  v_mfma_f32_16x16x32_bf16 v[72:75], a[152:155], v[96:99], v[72:75]
  buffer_load_dwordx4 v8, s[16:19], s63 offen offset:1024 sc1 lds
  v_mfma_f32_16x16x32_bf16 v[76:79], a[144:147], v[100:103], v[76:79]
  v_mfma_f32_16x16x32_bf16 v[80:83], a[148:151], v[100:103], v[80:83]
  v_mfma_f32_16x16x32_bf16 v[84:87], a[152:155], v[100:103], v[84:87]
  s_waitcnt lgkmcnt(2)
  v_mfma_f32_16x16x32_bf16 v[64:67], a[156:159], v[104:107], v[64:67]
  buffer_load_dwordx4 v8, s[16:19], s63 offen offset:2048 sc1 lds
  ds_read_b128 v[96:99], v112 offset:48128
  v_mfma_f32_16x16x32_bf16 v[68:71], a[160:163], v[104:107], v[68:71]
  ds_read_b128 v[100:103], v112 offset:64512
  v_mfma_f32_16x16x32_bf16 v[72:75], a[164:167], v[104:107], v[72:75]
  v_mfma_f32_16x16x32_bf16 v[76:79], a[156:159], v[108:111], v[76:79]
  v_mfma_f32_16x16x32_bf16 v[80:83], a[160:163], v[108:111], v[80:83]
  v_mfma_f32_16x16x32_bf16 v[84:87], a[164:167], v[108:111], v[84:87]
  s_waitcnt lgkmcnt(2)
  buffer_load_dwordx4 v8, s[16:19], s63 offen offset:3072 sc1 lds
  v_mfma_f32_16x16x32_bf16 v[64:67], a[168:171], v[88:91], v[64:67]
  s_waitcnt vmcnt(9)
  v_add_u32 v112, 65536, v1
  s_barrier
  ds_read_b128 v[104:107], v112 offset:0
  v_mfma_f32_16x16x32_bf16 v[68:71], a[172:175], v[88:91], v[68:71]
  ds_read_b128 v[108:111], v112 offset:16384
  v_mfma_f32_16x16x32_bf16 v[72:75], a[176:179], v[88:91], v[72:75]
  buffer_load_dwordx4 v[204:207], v1, s[16:19], s56 offen offset:3072 sc1
  s_add_u32 s56, s77, 16384
  v_mfma_f32_16x16x32_bf16 v[76:79], a[168:171], v[92:95], v[76:79]
  v_mfma_f32_16x16x32_bf16 v[80:83], a[172:175], v[92:95], v[80:83]
  v_mfma_f32_16x16x32_bf16 v[84:87], a[176:179], v[92:95], v[84:87]
  s_waitcnt lgkmcnt(2)
  buffer_load_dwordx4 v[208:211], v1, s[16:19], s56 offen offset:0 sc1
  v_mfma_f32_16x16x32_bf16 v[64:67], a[180:183], v[96:99], v[64:67]
  ds_read_b128 v[88:91], v112 offset:1024
  v_mfma_f32_16x16x32_bf16 v[68:71], a[184:187], v[96:99], v[68:71]
  ds_read_b128 v[92:95], v112 offset:17408
  v_mfma_f32_16x16x32_bf16 v[72:75], a[188:191], v[96:99], v[72:75]
  v_mfma_f32_16x16x32_bf16 v[76:79], a[180:183], v[100:103], v[76:79]
  buffer_load_dwordx4 v[212:215], v1, s[16:19], s56 offen offset:1024 sc1
  v_mfma_f32_16x16x32_bf16 v[80:83], a[184:187], v[100:103], v[80:83]
  v_mfma_f32_16x16x32_bf16 v[84:87], a[188:191], v[100:103], v[84:87]
  s_waitcnt lgkmcnt(2)
  v_mfma_f32_16x16x32_bf16 v[40:43], a[0:3], v[104:107], 0
  s_lshl_b32 s20, s69, 1
  s_add_u32 s20, s20, 557056
  ds_read_b128 v[96:99], v112 offset:2048
  v_mfma_f32_16x16x32_bf16 v[44:47], a[4:7], v[104:107], 0
  buffer_load_dword v123, v13, s[16:19], s20 offen sc1
  ds_read_b128 v[100:103], v112 offset:18432
  v_max_f32 v64, 0, v64
  v_max_f32 v65, 0, v65
  v_max_f32 v66, 0, v66
  v_max_f32 v67, 0, v67
  v_mul_f32 v64, v64, v68
  v_mul_f32 v65, v65, v69
  v_mfma_f32_16x16x32_bf16 v[48:51], a[8:11], v[104:107], 0
  buffer_load_dwordx4 v[216:219], v1, s[16:19], s56 offen offset:2048 sc1
  v_mul_f32 v66, v66, v70
  v_mul_f32 v67, v67, v71
  v_cvt_pk_bf16_f32 v114, v64, v65
  v_cvt_pk_bf16_f32 v115, v66, v67
  v_max_f32 v76, 0, v76
  v_max_f32 v77, 0, v77
  v_max_f32 v78, 0, v78
  v_mfma_f32_16x16x32_bf16 v[52:55], a[0:3], v[108:111], 0
  buffer_load_dwordx4 v[220:223], v1, s[16:19], s56 offen offset:3072 sc1
  s_add_u32 s56, s77, 20480
  v_max_f32 v79, 0, v79
  v_mul_f32 v76, v76, v80
  v_mul_f32 v77, v77, v81
  v_mul_f32 v78, v78, v82
  v_mul_f32 v79, v79, v83
  v_cvt_pk_bf16_f32 v116, v76, v77
  v_cvt_pk_bf16_f32 v117, v78, v79
  v_mfma_f32_16x16x32_bf16 v[56:59], a[4:7], v[108:111], 0
  v_permlane16_swap_b32 v72, v84
  v_permlane16_swap_b32 v73, v85
  v_permlane16_swap_b32 v74, v86
  v_permlane16_swap_b32 v75, v87
  v_mfma_f32_16x16x32_bf16 v[60:63], a[8:11], v[108:111], 0
  s_mov_b32 s15, 98304
  s_waitcnt lgkmcnt(2)
  buffer_load_dwordx4 v[224:227], v1, s[16:19], s56 offen offset:0 sc1
  v_permlane16_swap_b32 v114, v116
  v_permlane16_swap_b32 v115, v117
  buffer_store_dwordx4 v[114:117], v10, s[16:19], s15 offen sc1
  v_max_f32 v72, 0, v72
  v_mfma_f32_16x16x32_bf16 v[40:43], a[12:15], v[88:91], v[40:43]
  ds_read_b128 v[104:107], v112 offset:3072
  v_max_f32 v73, 0, v73
  v_max_f32 v74, 0, v74
  v_max_f32 v75, 0, v75
  v_mul_f32 v72, v72, v84
  v_mul_f32 v73, v73, v85
  v_mul_f32 v74, v74, v86
  v_mul_f32 v75, v75, v87
  v_mfma_f32_16x16x32_bf16 v[44:47], a[16:19], v[88:91], v[44:47]
  v_cvt_pk_bf16_f32 v118, v72, v73
  v_cvt_pk_bf16_f32 v119, v74, v75
  v_mov_b32 v120, v118
  v_mov_b32 v121, v119
  s_nop 0
  ds_read_b128 v[108:111], v112 offset:19456
  v_permlane32_swap_b32 v118, v120
  v_mfma_f32_16x16x32_bf16 v[48:51], a[20:23], v[88:91], v[48:51]
  buffer_load_dwordx4 v[228:231], v1, s[16:19], s56 offen offset:1024 sc1
  v_permlane32_swap_b32 v119, v121
  buffer_store_dwordx4 v[118:121], v11, s[16:19], s15 offen sc1
  v_mfma_f32_16x16x32_bf16 v[52:55], a[12:15], v[92:95], v[52:55]
  s_add_u32 s22, s23, 557312
  v_mfma_f32_16x16x32_bf16 v[56:59], a[16:19], v[92:95], v[56:59]
  v_mfma_f32_16x16x32_bf16 v[60:63], a[20:23], v[92:95], v[60:63]
  s_waitcnt lgkmcnt(2)
  v_mfma_f32_16x16x32_bf16 v[40:43], a[24:27], v[96:99], v[40:43]
  ds_read_b128 v[88:91], v112 offset:4096
  v_mfma_f32_16x16x32_bf16 v[44:47], a[28:31], v[96:99], v[44:47]
  ds_read_b128 v[92:95], v112 offset:20480
  v_mfma_f32_16x16x32_bf16 v[48:51], a[32:35], v[96:99], v[48:51]
  v_mfma_f32_16x16x32_bf16 v[52:55], a[24:27], v[100:103], v[52:55]
  v_mfma_f32_16x16x32_bf16 v[56:59], a[28:31], v[100:103], v[56:59]
  buffer_load_dwordx4 v[232:235], v1, s[16:19], s56 offen offset:2048 sc1
  v_mfma_f32_16x16x32_bf16 v[60:63], a[32:35], v[100:103], v[60:63]
  s_waitcnt lgkmcnt(2)
  v_mfma_f32_16x16x32_bf16 v[40:43], a[36:39], v[104:107], v[40:43]
  ds_read_b128 v[96:99], v112 offset:5120
  v_mfma_f32_16x16x32_bf16 v[44:47], a[40:43], v[104:107], v[44:47]
  ds_read_b128 v[100:103], v112 offset:21504
  v_mfma_f32_16x16x32_bf16 v[48:51], a[44:47], v[104:107], v[48:51]
  buffer_load_dwordx4 v[236:239], v1, s[16:19], s56 offen offset:3072 sc1
  s_add_u32 s56, s77, 24576
  v_mfma_f32_16x16x32_bf16 v[52:55], a[36:39], v[108:111], v[52:55]
  v_mfma_f32_16x16x32_bf16 v[56:59], a[40:43], v[108:111], v[56:59]
  v_mfma_f32_16x16x32_bf16 v[60:63], a[44:47], v[108:111], v[60:63]
  s_waitcnt lgkmcnt(2)
  v_mfma_f32_16x16x32_bf16 v[40:43], a[48:51], v[88:91], v[40:43]
  buffer_load_dwordx4 v[240:243], v1, s[16:19], s56 offen offset:0 sc1
  ds_read_b128 v[104:107], v112 offset:6144
  v_mfma_f32_16x16x32_bf16 v[44:47], a[52:55], v[88:91], v[44:47]
  ds_read_b128 v[108:111], v112 offset:22528
  v_mfma_f32_16x16x32_bf16 v[48:51], a[56:59], v[88:91], v[48:51]
  v_mfma_f32_16x16x32_bf16 v[52:55], a[48:51], v[92:95], v[52:55]
  buffer_load_dwordx4 v[244:247], v1, s[16:19], s56 offen offset:1024 sc1
  v_mfma_f32_16x16x32_bf16 v[56:59], a[52:55], v[92:95], v[56:59]
  s_waitcnt vmcnt(10)
  v_cmp_ne_u32 vcc, s13, v123
  s_cbranch_vccnz LS_hfr_31
LS_hfb_33:
  v_mfma_f32_16x16x32_bf16 v[60:63], a[56:59], v[92:95], v[60:63]
  s_add_u32 m0, s54, 0
  s_add_u32 s63, s52, 0
  s_waitcnt lgkmcnt(2)
  v_mfma_f32_16x16x32_bf16 v[40:43], a[60:63], v[96:99], v[40:43]
  ds_read_b128 v[88:91], v112 offset:7168
  v_mfma_f32_16x16x32_bf16 v[44:47], a[64:67], v[96:99], v[44:47]
  ds_read_b128 v[92:95], v112 offset:23552
  v_mfma_f32_16x16x32_bf16 v[48:51], a[68:71], v[96:99], v[48:51]
  buffer_load_dwordx4 v9, s[16:19], s63 offen offset:0 sc1 lds
  v_mfma_f32_16x16x32_bf16 v[52:55], a[60:63], v[100:103], v[52:55]
  v_mfma_f32_16x16x32_bf16 v[56:59], a[64:67], v[100:103], v[56:59]
  v_mfma_f32_16x16x32_bf16 v[60:63], a[68:71], v[100:103], v[60:63]
  s_waitcnt lgkmcnt(2)
  v_mfma_f32_16x16x32_bf16 v[40:43], a[72:75], v[104:107], v[40:43]
  buffer_load_dwordx4 v9, s[16:19], s63 offen offset:1024 sc1 lds
  ds_read_b128 v[96:99], v112 offset:8192
  v_mfma_f32_16x16x32_bf16 v[44:47], a[76:79], v[104:107], v[44:47]
  ds_read_b128 v[100:103], v112 offset:24576
  v_mfma_f32_16x16x32_bf16 v[48:51], a[80:83], v[104:107], v[48:51]
  v_mfma_f32_16x16x32_bf16 v[52:55], a[72:75], v[108:111], v[52:55]
  v_mfma_f32_16x16x32_bf16 v[56:59], a[76:79], v[108:111], v[56:59]
  v_mfma_f32_16x16x32_bf16 v[60:63], a[80:83], v[108:111], v[60:63]
  s_waitcnt lgkmcnt(2)
  v_mfma_f32_16x16x32_bf16 v[40:43], a[84:87], v[88:91], v[40:43]
  buffer_load_dwordx4 v9, s[16:19], s63 offen offset:2048 sc1 lds
  ds_read_b128 v[104:107], v112 offset:9216
  v_mfma_f32_16x16x32_bf16 v[44:47], a[88:91], v[88:91], v[44:47]
  ds_read_b128 v[108:111], v112 offset:25600
  v_mfma_f32_16x16x32_bf16 v[48:51], a[92:95], v[88:91], v[48:51]
  v_mfma_f32_16x16x32_bf16 v[52:55], a[84:87], v[92:95], v[52:55]
  v_mfma_f32_16x16x32_bf16 v[56:59], a[88:91], v[92:95], v[56:59]
  v_mfma_f32_16x16x32_bf16 v[60:63], a[92:95], v[92:95], v[60:63]
  buffer_load_dwordx4 v9, s[16:19], s63 offen offset:3072 sc1 lds
  s_add_u32 m0, s54, 32768
  s_add_u32 s63, s52, 8192
  s_waitcnt lgkmcnt(2)
  v_mfma_f32_16x16x32_bf16 v[40:43], a[96:99], v[96:99], v[40:43]
  ds_read_b128 v[88:91], v112 offset:10240
  v_mfma_f32_16x16x32_bf16 v[44:47], a[100:103], v[96:99], v[44:47]
  ds_read_b128 v[92:95], v112 offset:26624
  v_mfma_f32_16x16x32_bf16 v[48:51], a[104:107], v[96:99], v[48:51]
  v_mfma_f32_16x16x32_bf16 v[52:55], a[96:99], v[100:103], v[52:55]
  v_mfma_f32_16x16x32_bf16 v[56:59], a[100:103], v[100:103], v[56:59]
  v_mfma_f32_16x16x32_bf16 v[60:63], a[104:107], v[100:103], v[60:63]
  s_waitcnt lgkmcnt(2)
  v_mfma_f32_16x16x32_bf16 v[40:43], a[108:111], v[104:107], v[40:43]
  ds_read_b128 v[96:99], v112 offset:11264
  v_mfma_f32_16x16x32_bf16 v[44:47], a[112:115], v[104:107], v[44:47]
  buffer_load_dwordx4 v9, s[16:19], s63 offen offset:0 sc1 lds
  ds_read_b128 v[100:103], v112 offset:27648
  v_mfma_f32_16x16x32_bf16 v[48:51], a[116:119], v[104:107], v[48:51]
  v_mfma_f32_16x16x32_bf16 v[52:55], a[108:111], v[108:111], v[52:55]
  v_mfma_f32_16x16x32_bf16 v[56:59], a[112:115], v[108:111], v[56:59]
  v_mfma_f32_16x16x32_bf16 v[60:63], a[116:119], v[108:111], v[60:63]
  s_waitcnt lgkmcnt(2)
  buffer_load_dwordx4 v9, s[16:19], s63 offen offset:1024 sc1 lds
  v_mfma_f32_16x16x32_bf16 v[40:43], a[120:123], v[88:91], v[40:43]
  ds_read_b128 v[104:107], v112 offset:12288
  v_mfma_f32_16x16x32_bf16 v[44:47], a[124:127], v[88:91], v[44:47]
  ds_read_b128 v[108:111], v112 offset:28672
  v_mfma_f32_16x16x32_bf16 v[48:51], a[128:131], v[88:91], v[48:51]
  v_mfma_f32_16x16x32_bf16 v[52:55], a[120:123], v[92:95], v[52:55]
  v_mfma_f32_16x16x32_bf16 v[56:59], a[124:127], v[92:95], v[56:59]
  v_mfma_f32_16x16x32_bf16 v[60:63], a[128:131], v[92:95], v[60:63]
  s_waitcnt lgkmcnt(2)
  buffer_load_dwordx4 v9, s[16:19], s63 offen offset:2048 sc1 lds
  v_mfma_f32_16x16x32_bf16 v[40:43], a[132:135], v[96:99], v[40:43]
  ds_read_b128 v[88:91], v112 offset:13312
  v_mfma_f32_16x16x32_bf16 v[44:47], a[136:139], v[96:99], v[44:47]
  ds_read_b128 v[92:95], v112 offset:29696
  v_mfma_f32_16x16x32_bf16 v[48:51], a[140:143], v[96:99], v[48:51]
  v_mfma_f32_16x16x32_bf16 v[52:55], a[132:135], v[100:103], v[52:55]
  v_mfma_f32_16x16x32_bf16 v[56:59], a[136:139], v[100:103], v[56:59]
  buffer_load_dwordx4 v9, s[16:19], s63 offen offset:3072 sc1 lds
  s_add_u32 m0, s55, 131072
  s_add_u32 s63, s53, 16384
  v_mfma_f32_16x16x32_bf16 v[60:63], a[140:143], v[100:103], v[60:63]
  s_waitcnt lgkmcnt(2)
  v_mfma_f32_16x16x32_bf16 v[40:43], a[144:147], v[104:107], v[40:43]
  s_waitcnt vmcnt(12)
  buffer_store_dword v14, v2, s[16:19], s22 offen sc1
  ds_read_b128 v[96:99], v112 offset:14336
  v_mfma_f32_16x16x32_bf16 v[44:47], a[148:151], v[104:107], v[44:47]
  ds_read_b128 v[100:103], v112 offset:30720
  v_mfma_f32_16x16x32_bf16 v[48:51], a[152:155], v[104:107], v[48:51]
  v_mfma_f32_16x16x32_bf16 v[52:55], a[144:147], v[108:111], v[52:55]
  v_mfma_f32_16x16x32_bf16 v[56:59], a[148:151], v[108:111], v[56:59]
  v_mfma_f32_16x16x32_bf16 v[60:63], a[152:155], v[108:111], v[60:63]
  s_waitcnt lgkmcnt(2)
  buffer_load_dwordx4 v9, s[16:19], s63 offen offset:0 sc1 lds
  v_mfma_f32_16x16x32_bf16 v[40:43], a[156:159], v[88:91], v[40:43]
  ds_read_b128 v[104:107], v112 offset:15360
  v_mfma_f32_16x16x32_bf16 v[44:47], a[160:163], v[88:91], v[44:47]
  ds_read_b128 v[108:111], v112 offset:31744
  v_mfma_f32_16x16x32_bf16 v[48:51], a[164:167], v[88:91], v[48:51]
  v_mfma_f32_16x16x32_bf16 v[52:55], a[156:159], v[92:95], v[52:55]
  v_mfma_f32_16x16x32_bf16 v[56:59], a[160:163], v[92:95], v[56:59]
  buffer_load_dwordx4 v9, s[16:19], s63 offen offset:1024 sc1 lds
  v_mfma_f32_16x16x32_bf16 v[60:63], a[164:167], v[92:95], v[60:63]
  s_waitcnt lgkmcnt(2)
  v_mfma_f32_16x16x32_bf16 v[40:43], a[168:171], v[96:99], v[40:43]
  v_add_u32 v112, 65536, v1
  s_barrier
  ds_read_b128 v[88:91], v112 offset:32768
  v_mfma_f32_16x16x32_bf16 v[44:47], a[172:175], v[96:99], v[44:47]
  ds_read_b128 v[92:95], v112 offset:49152
  v_mfma_f32_16x16x32_bf16 v[48:51], a[176:179], v[96:99], v[48:51]
  buffer_load_dwordx4 v9, s[16:19], s63 offen offset:2048 sc1 lds
  v_mfma_f32_16x16x32_bf16 v[52:55], a[168:171], v[100:103], v[52:55]
  v_mfma_f32_16x16x32_bf16 v[56:59], a[172:175], v[100:103], v[56:59]
  v_mfma_f32_16x16x32_bf16 v[60:63], a[176:179], v[100:103], v[60:63]
  s_waitcnt lgkmcnt(2)
  v_mfma_f32_16x16x32_bf16 v[40:43], a[180:183], v[104:107], v[40:43]
  ds_read_b128 v[96:99], v112 offset:33792
  v_mfma_f32_16x16x32_bf16 v[44:47], a[184:187], v[104:107], v[44:47]
  buffer_load_dwordx4 v[248:251], v1, s[16:19], s56 offen offset:2048 sc1
  ds_read_b128 v[100:103], v112 offset:50176
  v_mfma_f32_16x16x32_bf16 v[48:51], a[188:191], v[104:107], v[48:51]
  v_mfma_f32_16x16x32_bf16 v[52:55], a[180:183], v[108:111], v[52:55]
  v_mfma_f32_16x16x32_bf16 v[56:59], a[184:187], v[108:111], v[56:59]
  v_mfma_f32_16x16x32_bf16 v[60:63], a[188:191], v[108:111], v[60:63]
  buffer_load_dwordx4 v[252:255], v1, s[16:19], s56 offen offset:3072 sc1
  s_add_u32 s56, s77, 28672
  s_waitcnt lgkmcnt(2)
  v_mfma_f32_16x16x32_bf16 v[64:67], a[0:3], v[88:91], 0
  s_lshl_b32 s20, s69, 1
  s_add_u32 s20, s20, 557312
  ds_read_b128 v[104:107], v112 offset:34816
  v_mfma_f32_16x16x32_bf16 v[68:71], a[4:7], v[88:91], 0
  buffer_load_dword v123, v13, s[16:19], s20 offen sc1
  ds_read_b128 v[108:111], v112 offset:51200
  v_max_f32 v40, 0, v40
  v_max_f32 v41, 0, v41
  v_max_f32 v42, 0, v42
  v_max_f32 v43, 0, v43
  v_mul_f32 v40, v40, v44
  v_mul_f32 v41, v41, v45
  v_mfma_f32_16x16x32_bf16 v[72:75], a[8:11], v[88:91], 0
  v_mul_f32 v42, v42, v46
  v_mul_f32 v43, v43, v47
  v_cvt_pk_bf16_f32 v114, v40, v41
  v_cvt_pk_bf16_f32 v115, v42, v43
  v_max_f32 v52, 0, v52
  v_max_f32 v53, 0, v53
  v_max_f32 v54, 0, v54
  v_max_f32 v55, 0, v55
  v_mfma_f32_16x16x32_bf16 v[76:79], a[0:3], v[92:95], 0
  buffer_load_dwordx4 a[192:195], v1, s[16:19], s56 offen offset:0 sc1
  v_mul_f32 v52, v52, v56
  v_mul_f32 v53, v53, v57
  v_mul_f32 v54, v54, v58
  v_mul_f32 v55, v55, v59
  v_cvt_pk_bf16_f32 v116, v52, v53
  v_cvt_pk_bf16_f32 v117, v54, v55
  v_mfma_f32_16x16x32_bf16 v[80:83], a[4:7], v[92:95], 0
  v_permlane16_swap_b32 v48, v60
  v_permlane16_swap_b32 v49, v61
  v_permlane16_swap_b32 v50, v62
  v_permlane16_swap_b32 v51, v63
  v_mfma_f32_16x16x32_bf16 v[84:87], a[8:11], v[92:95], 0
  s_mov_b32 s15, 196608
  s_waitcnt lgkmcnt(2)
  v_permlane16_swap_b32 v114, v116
  v_permlane16_swap_b32 v115, v117
  buffer_store_dwordx4 v[114:117], v10, s[16:19], s15 offen sc1
  v_max_f32 v48, 0, v48
  v_max_f32 v49, 0, v49
  v_mfma_f32_16x16x32_bf16 v[64:67], a[12:15], v[96:99], v[64:67]
  buffer_load_dwordx4 a[196:199], v1, s[16:19], s56 offen offset:1024 sc1
  ds_read_b128 v[88:91], v112 offset:35840
  v_max_f32 v50, 0, v50
  v_max_f32 v51, 0, v51
  v_mul_f32 v48, v48, v60
  v_mul_f32 v49, v49, v61
  v_mul_f32 v50, v50, v62
  v_mul_f32 v51, v51, v63
  v_mfma_f32_16x16x32_bf16 v[68:71], a[16:19], v[96:99], v[68:71]
  v_cvt_pk_bf16_f32 v118, v48, v49
  v_cvt_pk_bf16_f32 v119, v50, v51
  v_mov_b32 v120, v118
  v_mov_b32 v121, v119
  s_nop 0
  ds_read_b128 v[92:95], v112 offset:52224
  v_permlane32_swap_b32 v118, v120
  v_mfma_f32_16x16x32_bf16 v[72:75], a[20:23], v[96:99], v[72:75]
  s_add_u32 s24, s73, 0
  v_permlane32_swap_b32 v119, v121
  buffer_store_dwordx4 v[118:121], v11, s[16:19], s15 offen sc1
  buffer_load_dwordx4 v[140:143], v7, s[16:19], s24 offen sc1
  v_mfma_f32_16x16x32_bf16 v[76:79], a[12:15], v[100:103], v[76:79]
  s_add_u32 s22, s23, 557568
  v_mfma_f32_16x16x32_bf16 v[80:83], a[16:19], v[100:103], v[80:83]
  v_mfma_f32_16x16x32_bf16 v[84:87], a[20:23], v[100:103], v[84:87]
  s_waitcnt lgkmcnt(2)
  v_mfma_f32_16x16x32_bf16 v[64:67], a[24:27], v[104:107], v[64:67]
  ds_read_b128 v[96:99], v112 offset:36864
  v_mfma_f32_16x16x32_bf16 v[68:71], a[28:31], v[104:107], v[68:71]
  ds_read_b128 v[100:103], v112 offset:53248
  v_mfma_f32_16x16x32_bf16 v[72:75], a[32:35], v[104:107], v[72:75]
  buffer_load_dwordx4 a[200:203], v1, s[16:19], s56 offen offset:2048 sc1
  v_mfma_f32_16x16x32_bf16 v[76:79], a[24:27], v[108:111], v[76:79]
  v_mfma_f32_16x16x32_bf16 v[80:83], a[28:31], v[108:111], v[80:83]
  v_mfma_f32_16x16x32_bf16 v[84:87], a[32:35], v[108:111], v[84:87]
  s_waitcnt lgkmcnt(2)
  v_mfma_f32_16x16x32_bf16 v[64:67], a[36:39], v[88:91], v[64:67]
  buffer_load_dwordx4 a[204:207], v1, s[16:19], s56 offen offset:3072 sc1
  s_add_u32 s56, s77, 32768
  ds_read_b128 v[104:107], v112 offset:37888
  v_mfma_f32_16x16x32_bf16 v[68:71], a[40:43], v[88:91], v[68:71]
  buffer_load_dwordx4 a[208:211], v1, s[16:19], s56 offen offset:0 sc1
  ds_read_b128 v[108:111], v112 offset:54272
  v_mfma_f32_16x16x32_bf16 v[72:75], a[44:47], v[88:91], v[72:75]
  v_mfma_f32_16x16x32_bf16 v[76:79], a[36:39], v[92:95], v[76:79]
  v_mfma_f32_16x16x32_bf16 v[80:83], a[40:43], v[92:95], v[80:83]
  v_mfma_f32_16x16x32_bf16 v[84:87], a[44:47], v[92:95], v[84:87]
  s_waitcnt lgkmcnt(2)
  v_mfma_f32_16x16x32_bf16 v[64:67], a[48:51], v[96:99], v[64:67]
  ds_read_b128 v[88:91], v112 offset:38912
  v_mfma_f32_16x16x32_bf16 v[68:71], a[52:55], v[96:99], v[68:71]
  buffer_load_dwordx4 a[212:215], v1, s[16:19], s56 offen offset:1024 sc1
  ds_read_b128 v[92:95], v112 offset:55296
  v_mfma_f32_16x16x32_bf16 v[72:75], a[56:59], v[96:99], v[72:75]
  v_mfma_f32_16x16x32_bf16 v[76:79], a[48:51], v[100:103], v[76:79]
  v_mfma_f32_16x16x32_bf16 v[80:83], a[52:55], v[100:103], v[80:83]
  v_mfma_f32_16x16x32_bf16 v[84:87], a[56:59], v[100:103], v[84:87]
  s_waitcnt lgkmcnt(2)
  buffer_load_dwordx4 a[216:219], v1, s[16:19], s56 offen offset:2048 sc1
  v_mfma_f32_16x16x32_bf16 v[64:67], a[60:63], v[104:107], v[64:67]
  s_waitcnt vmcnt(10)
  v_cmp_ne_u32 vcc, s13, v123
  s_cbranch_vccnz LS_hfr_34
LS_hfb_36:
  ds_read_b128 v[96:99], v112 offset:39936
  v_mfma_f32_16x16x32_bf16 v[68:71], a[64:67], v[104:107], v[68:71]
  s_add_u32 m0, s54, 8192
  s_add_u32 s63, s52, 98304
  ds_read_b128 v[100:103], v112 offset:56320
  v_mfma_f32_16x16x32_bf16 v[72:75], a[68:71], v[104:107], v[72:75]
  v_mfma_f32_16x16x32_bf16 v[76:79], a[60:63], v[108:111], v[76:79]
  buffer_load_dwordx4 v9, s[16:19], s63 offen offset:0 sc1 lds
  v_mfma_f32_16x16x32_bf16 v[80:83], a[64:67], v[108:111], v[80:83]
  v_mfma_f32_16x16x32_bf16 v[84:87], a[68:71], v[108:111], v[84:87]
  s_waitcnt lgkmcnt(2)
  v_mfma_f32_16x16x32_bf16 v[64:67], a[72:75], v[88:91], v[64:67]
  buffer_load_dwordx4 v9, s[16:19], s63 offen offset:1024 sc1 lds
  ds_read_b128 v[104:107], v112 offset:40960
  v_mfma_f32_16x16x32_bf16 v[68:71], a[76:79], v[88:91], v[68:71]
  ds_read_b128 v[108:111], v112 offset:57344
  v_mfma_f32_16x16x32_bf16 v[72:75], a[80:83], v[88:91], v[72:75]
  v_mfma_f32_16x16x32_bf16 v[76:79], a[72:75], v[92:95], v[76:79]
  v_mfma_f32_16x16x32_bf16 v[80:83], a[76:79], v[92:95], v[80:83]
  v_mfma_f32_16x16x32_bf16 v[84:87], a[80:83], v[92:95], v[84:87]
  s_waitcnt lgkmcnt(2)
  buffer_load_dwordx4 v9, s[16:19], s63 offen offset:2048 sc1 lds
  v_mfma_f32_16x16x32_bf16 v[64:67], a[84:87], v[96:99], v[64:67]
  ds_read_b128 v[88:91], v112 offset:41984
  v_mfma_f32_16x16x32_bf16 v[68:71], a[88:91], v[96:99], v[68:71]
  ds_read_b128 v[92:95], v112 offset:58368
  v_mfma_f32_16x16x32_bf16 v[72:75], a[92:95], v[96:99], v[72:75]
  v_mfma_f32_16x16x32_bf16 v[76:79], a[84:87], v[100:103], v[76:79]
  v_mfma_f32_16x16x32_bf16 v[80:83], a[88:91], v[100:103], v[80:83]
  v_mfma_f32_16x16x32_bf16 v[84:87], a[92:95], v[100:103], v[84:87]
  s_waitcnt lgkmcnt(2)
  v_mfma_f32_16x16x32_bf16 v[64:67], a[96:99], v[104:107], v[64:67]
  ds_read_b128 v[96:99], v112 offset:43008
  v_mfma_f32_16x16x32_bf16 v[68:71], a[100:103], v[104:107], v[68:71]
  ds_read_b128 v[100:103], v112 offset:59392
  v_mfma_f32_16x16x32_bf16 v[72:75], a[104:107], v[104:107], v[72:75]
  buffer_load_dwordx4 v9, s[16:19], s63 offen offset:3072 sc1 lds
  s_add_u32 m0, s54, 40960
  s_add_u32 s63, s52, 106496
  v_mfma_f32_16x16x32_bf16 v[76:79], a[96:99], v[108:111], v[76:79]
  v_mfma_f32_16x16x32_bf16 v[80:83], a[100:103], v[108:111], v[80:83]
  v_mfma_f32_16x16x32_bf16 v[84:87], a[104:107], v[108:111], v[84:87]
  s_waitcnt lgkmcnt(2)
  v_mfma_f32_16x16x32_bf16 v[64:67], a[108:111], v[88:91], v[64:67]
  buffer_load_dwordx4 v9, s[16:19], s63 offen offset:0 sc1 lds
  ds_read_b128 v[104:107], v112 offset:44032
  v_mfma_f32_16x16x32_bf16 v[68:71], a[112:115], v[88:91], v[68:71]
  ds_read_b128 v[108:111], v112 offset:60416
  v_mfma_f32_16x16x32_bf16 v[72:75], a[116:119], v[88:91], v[72:75]
  v_mfma_f32_16x16x32_bf16 v[76:79], a[108:111], v[92:95], v[76:79]
  v_mfma_f32_16x16x32_bf16 v[80:83], a[112:115], v[92:95], v[80:83]
  buffer_load_dwordx4 v9, s[16:19], s63 offen offset:1024 sc1 lds
  v_mfma_f32_16x16x32_bf16 v[84:87], a[116:119], v[92:95], v[84:87]
  s_waitcnt lgkmcnt(2)
  v_mfma_f32_16x16x32_bf16 v[64:67], a[120:123], v[96:99], v[64:67]
  ds_read_b128 v[88:91], v112 offset:45056
  v_mfma_f32_16x16x32_bf16 v[68:71], a[124:127], v[96:99], v[68:71]
  ds_read_b128 v[92:95], v112 offset:61440
  v_mfma_f32_16x16x32_bf16 v[72:75], a[128:131], v[96:99], v[72:75]
  v_mfma_f32_16x16x32_bf16 v[76:79], a[120:123], v[100:103], v[76:79]
  v_mfma_f32_16x16x32_bf16 v[80:83], a[124:127], v[100:103], v[80:83]
  buffer_load_dwordx4 v9, s[16:19], s63 offen offset:2048 sc1 lds
  v_mfma_f32_16x16x32_bf16 v[84:87], a[128:131], v[100:103], v[84:87]
  s_waitcnt lgkmcnt(2)
  v_mfma_f32_16x16x32_bf16 v[64:67], a[132:135], v[104:107], v[64:67]
  s_waitcnt vmcnt(13)
  buffer_store_dword v14, v2, s[16:19], s22 offen sc1
  ds_read_b128 v[96:99], v112 offset:46080
  v_mfma_f32_16x16x32_bf16 v[68:71], a[136:139], v[104:107], v[68:71]
  ds_read_b128 v[100:103], v112 offset:62464
  v_mfma_f32_16x16x32_bf16 v[72:75], a[140:143], v[104:107], v[72:75]
  v_mfma_f32_16x16x32_bf16 v[76:79], a[132:135], v[108:111], v[76:79]
  v_mfma_f32_16x16x32_bf16 v[80:83], a[136:139], v[108:111], v[80:83]
  v_mfma_f32_16x16x32_bf16 v[84:87], a[140:143], v[108:111], v[84:87]
  buffer_load_dwordx4 v9, s[16:19], s63 offen offset:3072 sc1 lds
  s_add_u32 m0, s55, 139264
  s_add_u32 s63, s53, 114688
  s_waitcnt lgkmcnt(2)
  v_mfma_f32_16x16x32_bf16 v[64:67], a[144:147], v[88:91], v[64:67]
  ds_read_b128 v[104:107], v112 offset:47104
  v_mfma_f32_16x16x32_bf16 v[68:71], a[148:151], v[88:91], v[68:71]
  ds_read_b128 v[108:111], v112 offset:63488
  v_mfma_f32_16x16x32_bf16 v[72:75], a[152:155], v[88:91], v[72:75]
  v_mfma_f32_16x16x32_bf16 v[76:79], a[144:147], v[92:95], v[76:79]
  v_mfma_f32_16x16x32_bf16 v[80:83], a[148:151], v[92:95], v[80:83]
  buffer_load_dwordx4 v9, s[16:19], s63 offen offset:0 sc1 lds
  v_mfma_f32_16x16x32_bf16 v[84:87], a[152:155], v[92:95], v[84:87]
  s_waitcnt lgkmcnt(2)
  v_mfma_f32_16x16x32_bf16 v[64:67], a[156:159], v[96:99], v[64:67]
  ds_read_b128 v[88:91], v112 offset:48128
  v_mfma_f32_16x16x32_bf16 v[68:71], a[160:163], v[96:99], v[68:71]
  ds_read_b128 v[92:95], v112 offset:64512
  v_mfma_f32_16x16x32_bf16 v[72:75], a[164:167], v[96:99], v[72:75]
  v_mfma_f32_16x16x32_bf16 v[76:79], a[156:159], v[100:103], v[76:79]
  v_mfma_f32_16x16x32_bf16 v[80:83], a[160:163], v[100:103], v[80:83]
  buffer_load_dwordx4 v9, s[16:19], s63 offen offset:1024 sc1 lds
  v_mfma_f32_16x16x32_bf16 v[84:87], a[164:167], v[100:103], v[84:87]
  s_waitcnt lgkmcnt(2)
  v_mfma_f32_16x16x32_bf16 v[64:67], a[168:171], v[104:107], v[64:67]
  s_add_u32 s25, s66, 0
  v_add_u32 v112, s25, v1
  s_add_u32 s25, s67, 0
  v_add_u32 v113, s25, v1
  s_waitcnt vmcnt(7)
  s_barrier
  ds_read_b128 v[56:59], v113 offset:0
  v_mfma_f32_16x16x32_bf16 v[68:71], a[172:175], v[104:107], v[68:71]
  buffer_load_dwordx4 v9, s[16:19], s63 offen offset:2048 sc1 lds
  ds_read_b128 v[60:63], v112 offset:0
  v_mfma_f32_16x16x32_bf16 v[72:75], a[176:179], v[104:107], v[72:75]
  v_mfma_f32_16x16x32_bf16 v[76:79], a[168:171], v[108:111], v[76:79]
  v_mfma_f32_16x16x32_bf16 v[80:83], a[172:175], v[108:111], v[80:83]
  ds_read_b128 v[96:99], v113 offset:1024
  v_mfma_f32_16x16x32_bf16 v[84:87], a[176:179], v[108:111], v[84:87]
  s_waitcnt lgkmcnt(3)
  ds_read_b128 v[100:103], v112 offset:1024
  v_mfma_f32_16x16x32_bf16 v[64:67], a[180:183], v[88:91], v[64:67]
  s_lshl_b32 s20, s69, 1
  s_add_u32 s20, s20, 557568
  buffer_load_dword v123, v13, s[16:19], s20 offen sc1
  v_mfma_f32_16x16x32_bf16 v[68:71], a[184:187], v[88:91], v[68:71]
  buffer_load_dwordx4 a[220:223], v1, s[16:19], s56 offen offset:3072 sc1
  s_add_u32 s56, s77, 36864
  v_mfma_f32_16x16x32_bf16 v[72:75], a[188:191], v[88:91], v[72:75]
  ds_read_b128 v[104:107], v113 offset:2048
  v_mfma_f32_16x16x32_bf16 v[76:79], a[180:183], v[92:95], v[76:79]
  ds_read_b128 v[108:111], v112 offset:2048
  v_mfma_f32_16x16x32_bf16 v[80:83], a[184:187], v[92:95], v[80:83]
  v_mfma_f32_16x16x32_bf16 v[84:87], a[188:191], v[92:95], v[84:87]
  s_waitcnt lgkmcnt(4)
  buffer_load_dwordx4 a[224:227], v1, s[16:19], s56 offen offset:0 sc1
  v_mfma_f32_16x16x32_bf16 v[48:51], v[144:147], v[56:59], 0
  ds_read_b128 v[88:91], v113 offset:3072
  v_max_f32 v64, 0, v64
  v_max_f32 v65, 0, v65
  v_max_f32 v66, 0, v66
  v_max_f32 v67, 0, v67
  v_mfma_f32_16x16x32_bf16 v[52:55], v[148:151], v[56:59], 0
  ds_read_b128 v[92:95], v112 offset:3072
  v_mul_f32 v64, v64, v68
  v_mul_f32 v65, v65, v69
  v_mul_f32 v66, v66, v70
  v_mul_f32 v67, v67, v71
  v_mfma_f32_16x16x32_bf16 v[40:43], v[144:147], v[60:63], 0
  v_cvt_pk_bf16_f32 v114, v64, v65
  v_cvt_pk_bf16_f32 v115, v66, v67
  v_max_f32 v76, 0, v76
  v_max_f32 v77, 0, v77
  v_max_f32 v78, 0, v78
  v_mfma_f32_16x16x32_bf16 v[44:47], v[148:151], v[60:63], 0
  s_waitcnt lgkmcnt(4)
  buffer_load_dwordx4 a[228:231], v1, s[16:19], s56 offen offset:1024 sc1
  v_max_f32 v79, 0, v79
  v_mul_f32 v76, v76, v80
  v_mul_f32 v77, v77, v81
  v_mul_f32 v78, v78, v82
  v_mfma_f32_16x16x32_bf16 v[48:51], v[152:155], v[96:99], v[48:51]
  ds_read_b128 v[56:59], v113 offset:4096
  v_mul_f32 v79, v79, v83
  v_cvt_pk_bf16_f32 v116, v76, v77
  v_cvt_pk_bf16_f32 v117, v78, v79
  v_mfma_f32_16x16x32_bf16 v[52:55], v[156:159], v[96:99], v[52:55]
  ds_read_b128 v[60:63], v112 offset:4096
  v_permlane16_swap_b32 v72, v84
  v_permlane16_swap_b32 v73, v85
  v_mfma_f32_16x16x32_bf16 v[40:43], v[152:155], v[100:103], v[40:43]
  v_permlane16_swap_b32 v74, v86
  v_permlane16_swap_b32 v75, v87
  v_mfma_f32_16x16x32_bf16 v[44:47], v[156:159], v[100:103], v[44:47]
  s_waitcnt lgkmcnt(4)
  buffer_load_dwordx4 a[232:235], v1, s[16:19], s56 offen offset:2048 sc1
  v_permlane16_swap_b32 v114, v116
  v_permlane16_swap_b32 v115, v117
  v_mfma_f32_16x16x32_bf16 v[48:51], v[160:163], v[104:107], v[48:51]
  s_mov_b32 s15, 0
  buffer_store_dwordx4 v[114:117], v136, s[16:19], s15 offen sc1
  ds_read_b128 v[96:99], v113 offset:5120
  v_max_f32 v72, 0, v72
  v_max_f32 v73, 0, v73
  v_mfma_f32_16x16x32_bf16 v[52:55], v[164:167], v[104:107], v[52:55]
  ds_read_b128 v[100:103], v112 offset:5120
  v_max_f32 v74, 0, v74
  v_max_f32 v75, 0, v75
  v_mul_f32 v72, v72, v84
  v_mul_f32 v73, v73, v85
  v_mfma_f32_16x16x32_bf16 v[40:43], v[160:163], v[108:111], v[40:43]
  v_mul_f32 v74, v74, v86
  v_mul_f32 v75, v75, v87
  v_cvt_pk_bf16_f32 v118, v72, v73
  v_cvt_pk_bf16_f32 v119, v74, v75
  v_mov_b32 v120, v118
  v_mfma_f32_16x16x32_bf16 v[44:47], v[164:167], v[108:111], v[44:47]
  buffer_load_dwordx4 a[236:239], v1, s[16:19], s56 offen offset:3072 sc1
  s_add_u32 s56, s77, 40960
  v_mov_b32 v121, v119
  s_nop 0
  s_waitcnt lgkmcnt(4)
  v_permlane32_swap_b32 v118, v120
  v_mfma_f32_16x16x32_bf16 v[48:51], v[168:171], v[88:91], v[48:51]
  buffer_load_dwordx4 a[240:243], v1, s[16:19], s56 offen offset:0 sc1
  v_permlane32_swap_b32 v119, v121
  buffer_store_dwordx4 v[118:121], v138, s[16:19], s15 offen sc1
  ds_read_b128 v[104:107], v113 offset:6144
  v_mfma_f32_16x16x32_bf16 v[52:55], v[172:175], v[88:91], v[52:55]
  s_add_u32 s22, s23, 557824
  ds_read_b128 v[108:111], v112 offset:6144
  v_mfma_f32_16x16x32_bf16 v[40:43], v[168:171], v[92:95], v[40:43]
  v_max3_u32 v124, v140, v141, v142
  v_max_u32 v124, v124, v143
  v_mfma_f32_16x16x32_bf16 v[44:47], v[172:175], v[92:95], v[44:47]
  v_cmp_eq_u32 vcc, -1, v124
  s_cbranch_vccnz LS_s5r_19
LS_s5b_21:
  s_waitcnt lgkmcnt(4)
  v_mfma_f32_16x16x32_bf16 v[48:51], v[176:179], v[56:59], v[48:51]
  ds_read_b128 v[88:91], v113 offset:7168
  v_add_f32 v140, v140, v141
  v_mfma_f32_16x16x32_bf16 v[52:55], v[180:183], v[56:59], v[52:55]
  ds_read_b128 v[92:95], v112 offset:7168
  v_add_f32 v142, v142, v143
  v_mfma_f32_16x16x32_bf16 v[40:43], v[176:179], v[60:63], v[40:43]
  v_add_f32 v140, v140, v142
  v_mov_b32 v141, v140
  s_nop 0
  v_mfma_f32_16x16x32_bf16 v[44:47], v[180:183], v[60:63], v[44:47]
  s_waitcnt lgkmcnt(4)
  v_permlane32_swap_b32 v140, v141
  v_mfma_f32_16x16x32_bf16 v[48:51], v[184:187], v[96:99], v[48:51]
  s_waitcnt vmcnt(12)
  s_barrier
  ds_read_b128 v[56:59], v113 offset:32768
  v_mfma_f32_16x16x32_bf16 v[52:55], v[188:191], v[96:99], v[52:55]
  s_waitcnt vmcnt(8)
  v_cmp_ne_u32 vcc, s13, v123
  s_cbranch_vccnz LS_hfr_37
LS_hfb_39:
  ds_read_b128 v[60:63], v112 offset:32768
  v_mfma_f32_16x16x32_bf16 v[40:43], v[184:187], v[100:103], v[40:43]
  s_add_u32 m0, s54, 65536
  s_add_u32 s63, s52, 196608
  buffer_load_dwordx4 v9, s[16:19], s63 offen offset:0 sc1 lds
  v_mfma_f32_16x16x32_bf16 v[44:47], v[188:191], v[100:103], v[44:47]
  s_waitcnt lgkmcnt(4)
  v_add_f32 v140, v140, v141
  v_mov_b32 v141, v140
  v_mfma_f32_16x16x32_bf16 v[48:51], v[192:195], v[104:107], v[48:51]
  s_nop 0
  ds_read_b128 v[96:99], v113 offset:33792
  v_mfma_f32_16x16x32_bf16 v[52:55], v[196:199], v[104:107], v[52:55]
  buffer_load_dwordx4 a[244:247], v1, s[16:19], s56 offen offset:1024 sc1
  ds_read_b128 v[100:103], v112 offset:33792
  v_mfma_f32_16x16x32_bf16 v[40:43], v[192:195], v[108:111], v[40:43]
  v_permlane16_swap_b32 v140, v141
  v_mfma_f32_16x16x32_bf16 v[44:47], v[196:199], v[108:111], v[44:47]
  s_waitcnt lgkmcnt(4)
  v_add_f32 v140, v140, v141
  v_mul_f32 v140, 0x3b000000, v140
  v_mfma_f32_16x16x32_bf16 v[48:51], v[200:203], v[88:91], v[48:51]
  buffer_load_dwordx4 a[248:251], v1, s[16:19], s56 offen offset:2048 sc1
  ds_read_b128 v[104:107], v113 offset:34816
  v_mfma_f32_16x16x32_bf16 v[52:55], v[204:207], v[88:91], v[52:55]
  ds_read_b128 v[108:111], v112 offset:34816
  v_add_f32 v140, 0x3727c5ac, v140
  v_mfma_f32_16x16x32_bf16 v[40:43], v[200:203], v[92:95], v[40:43]
  s_add_u32 s3, s65, 137216
  v_rcp_f32 v15, v140
  v_add_u32 v114, s3, v1
  v_mfma_f32_16x16x32_bf16 v[44:47], v[204:207], v[92:95], v[44:47]
  s_xor_b32 s3, s65, 16384
  s_add_u32 s3, s3, 137216
  s_waitcnt lgkmcnt(4)
  v_add_u32 v115, s3, v1
  v_mfma_f32_16x16x32_bf16 v[48:51], v[208:211], v[56:59], v[48:51]
  buffer_load_dwordx4 a[252:255], v1, s[16:19], s56 offen offset:3072 sc1
  ds_read_b128 v[88:91], v113 offset:35840
  v_mfma_f32_16x16x32_bf16 v[52:55], v[212:215], v[56:59], v[52:55]
  ds_read_b128 v[92:95], v112 offset:35840
  v_lshlrev_b32 v80, 16, v32
  v_mfma_f32_16x16x32_bf16 v[40:43], v[208:211], v[60:63], v[40:43]
  v_and_b32 v81, 0xffff0000, v32
  v_lshlrev_b32 v82, 16, v33
  v_mfma_f32_16x16x32_bf16 v[44:47], v[212:215], v[60:63], v[44:47]
  s_waitcnt lgkmcnt(4)
  v_and_b32 v83, 0xffff0000, v33
  v_lshlrev_b32 v84, 16, v34
  v_mfma_f32_16x16x32_bf16 v[48:51], v[216:219], v[96:99], v[48:51]
  buffer_load_dwordx4 v9, s[16:19], s63 offen offset:1024 sc1 lds
  ds_read_b128 v[56:59], v113 offset:36864
  v_mfma_f32_16x16x32_bf16 v[52:55], v[220:223], v[96:99], v[52:55]
  ds_read_b128 v[60:63], v112 offset:36864
  v_and_b32 v85, 0xffff0000, v34
  v_mfma_f32_16x16x32_bf16 v[40:43], v[216:219], v[100:103], v[40:43]
  s_add_u32 s24, s73, 65536
  v_lshlrev_b32 v86, 16, v35
  v_and_b32 v87, 0xffff0000, v35
  v_mfma_f32_16x16x32_bf16 v[44:47], v[220:223], v[100:103], v[44:47]
  s_waitcnt lgkmcnt(4)
  buffer_load_dwordx4 v[140:143], v7, s[16:19], s24 offen sc1
  v_mfma_f32_16x16x32_bf16 v[48:51], v[224:227], v[104:107], v[48:51]
  ds_read_b128 v[96:99], v113 offset:37888
  v_mfma_f32_16x16x32_bf16 v[52:55], v[228:231], v[104:107], v[52:55]
  ds_read_b128 v[100:103], v112 offset:37888
  v_mfma_f32_16x16x32_bf16 v[40:43], v[224:227], v[108:111], v[40:43]
  v_mfma_f32_16x16x32_bf16 v[44:47], v[228:231], v[108:111], v[44:47]
  s_waitcnt lgkmcnt(4)
  buffer_load_dwordx4 v9, s[16:19], s63 offen offset:2048 sc1 lds
  v_mfma_f32_16x16x32_bf16 v[48:51], v[232:235], v[88:91], v[48:51]
  ds_read_b128 v[104:107], v113 offset:38912
  v_mfma_f32_16x16x32_bf16 v[52:55], v[236:239], v[88:91], v[52:55]
  ds_read_b128 v[108:111], v112 offset:38912
  v_mfma_f32_16x16x32_bf16 v[40:43], v[232:235], v[92:95], v[40:43]
  v_mfma_f32_16x16x32_bf16 v[44:47], v[236:239], v[92:95], v[44:47]
  s_waitcnt lgkmcnt(4)
  v_mfma_f32_16x16x32_bf16 v[48:51], v[240:243], v[56:59], v[48:51]
  ds_read_b128 v[88:91], v113 offset:39936
  v_mfma_f32_16x16x32_bf16 v[52:55], v[244:247], v[56:59], v[52:55]
  buffer_load_dwordx4 v9, s[16:19], s63 offen offset:3072 sc1 lds
  s_add_u32 m0, s54, 98304
  ds_read_b128 v[92:95], v112 offset:39936
  v_mfma_f32_16x16x32_bf16 v[40:43], v[240:243], v[60:63], v[40:43]
  s_add_u32 s63, s52, 204800
  v_mfma_f32_16x16x32_bf16 v[44:47], v[244:247], v[60:63], v[44:47]
  s_waitcnt lgkmcnt(4)
  v_mfma_f32_16x16x32_bf16 v[48:51], v[248:251], v[96:99], v[48:51]
  s_add_u32 s25, s66, 131072
  v_add_u32 v112, s25, v1
  s_add_u32 s25, s67, 131072
  v_add_u32 v113, s25, v1
  s_barrier
  ds_read_b128 v[56:59], v113 offset:0
  v_mfma_f32_16x16x32_bf16 v[52:55], v[252:255], v[96:99], v[52:55]
  ds_read_b128 v[60:63], v112 offset:0
  v_mfma_f32_16x16x32_bf16 v[40:43], v[248:251], v[100:103], v[40:43]
  v_mfma_f32_16x16x32_bf16 v[44:47], v[252:255], v[100:103], v[44:47]
  s_waitcnt lgkmcnt(4)
  v_mfma_f32_16x16x32_bf16 v[48:51], a[192:195], v[104:107], v[48:51]
  s_waitcnt vmcnt(15)
  buffer_load_dwordx4 v9, s[16:19], s63 offen offset:0 sc1 lds
  ds_read_b128 v[96:99], v113 offset:1024
  v_mfma_f32_16x16x32_bf16 v[52:55], a[196:199], v[104:107], v[52:55]
  ds_read_b128 v[100:103], v112 offset:1024
  buffer_load_dwordx4 v9, s[16:19], s63 offen offset:1024 sc1 lds
  buffer_load_dwordx4 v9, s[16:19], s63 offen offset:2048 sc1 lds
  buffer_load_dwordx4 v9, s[16:19], s63 offen offset:3072 sc1 lds
  v_mfma_f32_16x16x32_bf16 v[40:43], a[192:195], v[108:111], v[40:43]
  s_add_u32 m0, s55, 0
  s_add_u32 s63, s53, 212992
  v_mfma_f32_16x16x32_bf16 v[44:47], a[196:199], v[108:111], v[44:47]
  s_waitcnt lgkmcnt(4)
  v_mfma_f32_16x16x32_bf16 v[48:51], a[200:203], v[88:91], v[48:51]
  s_waitcnt vmcnt(17)
  ds_read_b128 v[104:107], v113 offset:2048
  v_mfma_f32_16x16x32_bf16 v[52:55], a[204:207], v[88:91], v[52:55]
  ds_read_b128 v[108:111], v112 offset:2048
  v_mfma_f32_16x16x32_bf16 v[40:43], a[200:203], v[92:95], v[40:43]
  s_waitcnt vmcnt(12)
  buffer_store_dword v14, v2, s[16:19], s22 offen sc1
  v_mfma_f32_16x16x32_bf16 v[44:47], a[204:207], v[92:95], v[44:47]
  s_waitcnt lgkmcnt(4)
  v_mfma_f32_16x16x32_bf16 v[48:51], a[208:211], v[56:59], v[48:51]
  ds_read_b128 v[88:91], v113 offset:3072
  v_mfma_f32_16x16x32_bf16 v[52:55], a[212:215], v[56:59], v[52:55]
  ds_read_b128 v[92:95], v112 offset:3072
  v_mfma_f32_16x16x32_bf16 v[40:43], a[208:211], v[60:63], v[40:43]
  v_mfma_f32_16x16x32_bf16 v[44:47], a[212:215], v[60:63], v[44:47]
  s_waitcnt lgkmcnt(4)
  v_mfma_f32_16x16x32_bf16 v[48:51], a[216:219], v[96:99], v[48:51]
  s_waitcnt vmcnt(11)
  ds_read_b128 v[56:59], v113 offset:4096
  v_mfma_f32_16x16x32_bf16 v[52:55], a[220:223], v[96:99], v[52:55]
  buffer_load_dwordx4 v9, s[16:19], s63 offen offset:0 sc1 lds
  ds_read_b128 v[60:63], v112 offset:4096
  v_mfma_f32_16x16x32_bf16 v[40:43], a[216:219], v[100:103], v[40:43]
  v_mfma_f32_16x16x32_bf16 v[44:47], a[220:223], v[100:103], v[44:47]
  s_waitcnt lgkmcnt(4)
  v_mfma_f32_16x16x32_bf16 v[48:51], a[224:227], v[104:107], v[48:51]
  s_waitcnt vmcnt(10)
  ds_read_b128 v[96:99], v113 offset:5120
  v_mfma_f32_16x16x32_bf16 v[52:55], a[228:231], v[104:107], v[52:55]
  ds_read_b128 v[100:103], v112 offset:5120
  v_mfma_f32_16x16x32_bf16 v[40:43], a[224:227], v[108:111], v[40:43]
  v_mfma_f32_16x16x32_bf16 v[44:47], a[228:231], v[108:111], v[44:47]
  s_waitcnt lgkmcnt(4)
  buffer_load_dwordx4 v9, s[16:19], s63 offen offset:1024 sc1 lds
  v_mfma_f32_16x16x32_bf16 v[48:51], a[232:235], v[88:91], v[48:51]
  s_lshl_b32 s25, s11, 14
  s_add_u32 s25, s25, 65536
  s_waitcnt vmcnt(3)
  v_add_u32 v112, s25, v1
  s_barrier
  ds_read_b128 v[104:107], v112 offset:0
  v_mfma_f32_16x16x32_bf16 v[52:55], a[236:239], v[88:91], v[52:55]
  buffer_load_dwordx4 v9, s[16:19], s63 offen offset:2048 sc1 lds
  v_mfma_f32_16x16x32_bf16 v[40:43], a[232:235], v[92:95], v[40:43]
  s_lshl_b32 s20, s69, 1
  s_add_u32 s20, s20, 557824
  ds_read_b128 v[108:111], v112 offset:1024
  v_mfma_f32_16x16x32_bf16 v[44:47], a[236:239], v[92:95], v[44:47]
  s_waitcnt lgkmcnt(4)
  buffer_load_dword v123, v13, s[16:19], s20 offen sc1
  v_mfma_f32_16x16x32_bf16 v[48:51], a[240:243], v[56:59], v[48:51]
  ds_read_b128 v[88:91], v112 offset:2048
  v_mfma_f32_16x16x32_bf16 v[52:55], a[244:247], v[56:59], v[52:55]
  v_mfma_f32_16x16x32_bf16 v[40:43], a[240:243], v[60:63], v[40:43]
  ds_read_b128 v[92:95], v112 offset:3072
  v_mfma_f32_16x16x32_bf16 v[44:47], a[244:247], v[60:63], v[44:47]
  s_waitcnt lgkmcnt(4)
  v_mfma_f32_16x16x32_bf16 v[48:51], a[248:251], v[96:99], v[48:51]
  ds_read_b128 v[56:59], v112 offset:4096
  v_mfma_f32_16x16x32_bf16 v[52:55], a[252:255], v[96:99], v[52:55]
  v_mfma_f32_16x16x32_bf16 v[40:43], a[248:251], v[100:103], v[40:43]
  ds_read_b128 v[60:63], v112 offset:5120
  v_mfma_f32_16x16x32_bf16 v[44:47], a[252:255], v[100:103], v[44:47]
  s_waitcnt lgkmcnt(5)
  v_mfma_f32_16x16x32_bf16 v[64:67], v[144:147], v[104:107], 0
  s_nop 0
  ds_write_b128 v114, v[48:51]
  s_nop 0
  ds_write_b128 v114, v[52:55] offset:1024
  ds_read_b128 v[96:99], v112 offset:6144
  v_fmac_f32 v16, v15, v40
  v_fmac_f32 v17, v15, v41
  v_mfma_f32_16x16x32_bf16 v[68:71], v[148:151], v[104:107], 0
  s_waitcnt lgkmcnt(7)
  v_fmac_f32 v18, v15, v42
  v_fmac_f32 v19, v15, v43
  v_fmac_f32 v20, v15, v44
  v_fmac_f32 v21, v15, v45
  v_fmac_f32 v22, v15, v46
  v_mfma_f32_16x16x32_bf16 v[64:67], v[152:155], v[108:111], v[64:67]
  ds_read_b128 v[100:103], v112 offset:7168
  v_fmac_f32 v23, v15, v47
  v_mfma_f32_16x16x32_bf16 v[68:71], v[156:159], v[108:111], v[68:71]
  s_waitcnt lgkmcnt(7)
  v_mfma_f32_16x16x32_bf16 v[64:67], v[160:163], v[88:91], v[64:67]
  s_waitcnt lgkmcnt(2)
  s_barrier
  ds_read_b128 v[48:51], v115
  ds_read_b128 v[52:55], v115 offset:1024
  ds_read_b128 v[104:107], v112 offset:32768
  v_mfma_f32_16x16x32_bf16 v[68:71], v[164:167], v[88:91], v[68:71]
  v_mfma_f32_16x16x32_bf16 v[64:67], v[168:171], v[92:95], v[64:67]
  ds_read_b128 v[108:111], v112 offset:33792
  v_mfma_f32_16x16x32_bf16 v[68:71], v[172:175], v[92:95], v[68:71]
  v_mfma_f32_16x16x32_bf16 v[64:67], v[176:179], v[56:59], v[64:67]
  ds_read_b128 v[88:91], v112 offset:34816
  s_waitcnt lgkmcnt(4)
  v_fmac_f32 v16, v15, v48
  v_fmac_f32 v17, v15, v49
  v_fmac_f32 v18, v15, v50
  v_fmac_f32 v19, v15, v51
  v_mfma_f32_16x16x32_bf16 v[68:71], v[180:183], v[56:59], v[68:71]
  s_waitcnt lgkmcnt(3)
  v_fmac_f32 v20, v15, v52
  v_fmac_f32 v21, v15, v53
  v_fmac_f32 v22, v15, v54
  v_fmac_f32 v23, v15, v55
  v_add_f32 v40, v16, v17
  v_mfma_f32_16x16x32_bf16 v[64:67], v[184:187], v[60:63], v[64:67]
  ds_read_b128 v[92:95], v112 offset:35840
  v_mul_f32 v42, v16, v80
  v_mul_f32 v41, v16, v16
  v_add_f32 v43, v80, v81
  v_fmac_f32 v41, v17, v17
  v_mfma_f32_16x16x32_bf16 v[68:71], v[188:191], v[60:63], v[68:71]
  v_fmac_f32 v42, v17, v81
  v_add_f32 v40, v40, v18
  v_fmac_f32 v42, v18, v82
  v_fmac_f32 v41, v18, v18
  v_add_f32 v43, v43, v82
  v_mfma_f32_16x16x32_bf16 v[64:67], v[192:195], v[96:99], v[64:67]
  ds_read_b128 v[56:59], v112 offset:36864
  v_add_f32 v40, v40, v19
  v_fmac_f32 v42, v19, v83
  v_fmac_f32 v41, v19, v19
  v_add_f32 v43, v43, v83
  v_mfma_f32_16x16x32_bf16 v[68:71], v[196:199], v[96:99], v[68:71]
  v_add_f32 v40, v40, v20
  v_fmac_f32 v42, v20, v84
  v_fmac_f32 v41, v20, v20
  v_add_f32 v43, v43, v84
  v_add_f32 v40, v40, v21
  v_mfma_f32_16x16x32_bf16 v[64:67], v[200:203], v[100:103], v[64:67]
  ds_read_b128 v[60:63], v112 offset:37888
  v_fmac_f32 v42, v21, v85
  v_fmac_f32 v41, v21, v21
  v_add_f32 v43, v43, v85
  v_add_f32 v40, v40, v22
  v_mfma_f32_16x16x32_bf16 v[68:71], v[204:207], v[100:103], v[68:71]
  s_waitcnt lgkmcnt(5)
  v_fmac_f32 v42, v22, v86
  v_fmac_f32 v41, v22, v22
  v_add_f32 v43, v43, v86
  v_add_f32 v40, v40, v23
  v_fmac_f32 v42, v23, v87
  v_mfma_f32_16x16x32_bf16 v[64:67], v[208:211], v[104:107], v[64:67]
  ds_read_b128 v[96:99], v112 offset:38912
  v_fmac_f32 v41, v23, v23
  v_add_f32 v43, v43, v87
  v_permlane32_swap_b32 v40, v42
  v_mfma_f32_16x16x32_bf16 v[68:71], v[212:215], v[104:107], v[68:71]
  s_waitcnt vmcnt(0)
  v_cmp_ne_u32 vcc, s13, v123
  s_cbranch_vccnz LS_hfr_40
LS_hfb_42:
  s_waitcnt lgkmcnt(5)
  v_permlane32_swap_b32 v41, v43
  v_mfma_f32_16x16x32_bf16 v[64:67], v[216:219], v[108:111], v[64:67]
  s_add_u32 m0, s54, 73728
  s_add_u32 s63, s52, 0
  s_add_u32 s3, s70, 524288
  ds_read_b128 v[100:103], v112 offset:39936
  v_add_f32 v40, v40, v42
  v_add_f32 v41, v41, v43
  v_mfma_f32_16x16x32_bf16 v[68:71], v[220:223], v[108:111], v[68:71]
  s_waitcnt lgkmcnt(5)
  buffer_load_dwordx4 v135, s[16:19], s63 offen offset:0 sc1 lds
  v_permlane16_swap_b32 v40, v41
  v_add_f32 v40, v40, v41
  buffer_store_dword v40, v4, s[16:19], s3 offen sc1
  v_mfma_f32_16x16x32_bf16 v[64:67], v[224:227], v[88:91], v[64:67]
  s_lshl_b32 s25, s11, 14
  s_add_u32 s25, s25, 0
  v_add_u32 v112, s25, v1
  s_barrier
  ds_read_b128 v[104:107], v112 offset:0
  v_mfma_f32_16x16x32_bf16 v[68:71], v[228:231], v[88:91], v[68:71]
  s_waitcnt lgkmcnt(5)
  buffer_load_dwordx4 v135, s[16:19], s63 offen offset:1024 sc1 lds
  buffer_load_dwordx4 v135, s[16:19], s63 offen offset:2048 sc1 lds
  buffer_load_dwordx4 v135, s[16:19], s63 offen offset:3072 sc1 lds
  v_mfma_f32_16x16x32_bf16 v[64:67], v[232:235], v[92:95], v[64:67]
  s_add_u32 m0, s54, 106496
  s_add_u32 s63, s52, 8192
  ds_read_b128 v[108:111], v112 offset:1024
  v_mfma_f32_16x16x32_bf16 v[68:71], v[236:239], v[92:95], v[68:71]
  s_waitcnt lgkmcnt(5)
  v_max3_u32 v124, v140, v141, v142
  v_max_u32 v124, v124, v143
  v_mfma_f32_16x16x32_bf16 v[64:67], v[240:243], v[56:59], v[64:67]
  v_cmp_eq_u32 vcc, -1, v124
  s_cbranch_vccnz LS_s5r_22
LS_s5b_24:
  ds_read_b128 v[88:91], v112 offset:2048
  v_mfma_f32_16x16x32_bf16 v[68:71], v[244:247], v[56:59], v[68:71]
  s_waitcnt lgkmcnt(5)
  v_add_f32 v140, v140, v141
  v_add_f32 v142, v142, v143
  v_mfma_f32_16x16x32_bf16 v[64:67], v[248:251], v[60:63], v[64:67]
  ds_read_b128 v[92:95], v112 offset:3072
  v_add_f32 v140, v140, v142
  v_mfma_f32_16x16x32_bf16 v[68:71], v[252:255], v[60:63], v[68:71]
  v_mov_b32 v141, v140
  s_nop 0
  s_waitcnt lgkmcnt(5)
  v_mfma_f32_16x16x32_bf16 v[64:67], a[192:195], v[96:99], v[64:67]
  ds_read_b128 v[56:59], v112 offset:4096
  v_mfma_f32_16x16x32_bf16 v[68:71], a[196:199], v[96:99], v[68:71]
  s_waitcnt lgkmcnt(5)
  v_permlane32_swap_b32 v140, v141
  v_mfma_f32_16x16x32_bf16 v[64:67], a[200:203], v[100:103], v[64:67]
  ds_read_b128 v[60:63], v112 offset:5120
  v_add_f32 v140, v140, v141
  v_mfma_f32_16x16x32_bf16 v[68:71], a[204:207], v[100:103], v[68:71]
  v_mov_b32 v141, v140
  s_nop 0
  s_waitcnt lgkmcnt(5)
  v_mfma_f32_16x16x32_bf16 v[64:67], a[208:211], v[104:107], v[64:67]
  s_lshl_b32 s25, s11, 14
  s_add_u32 s25, s25, 73728
  s_waitcnt vmcnt(0)
  v_add_u32 v112, s25, v1
  s_barrier
  ds_read_b128 v[96:99], v112 offset:0
  v_mfma_f32_16x16x32_bf16 v[68:71], a[212:215], v[104:107], v[68:71]
  s_waitcnt lgkmcnt(5)
  buffer_load_dwordx4 v135, s[16:19], s63 offen offset:0 sc1 lds
  v_mfma_f32_16x16x32_bf16 v[64:67], a[216:219], v[108:111], v[64:67]
  ds_read_b128 v[100:103], v112 offset:1024
  v_mfma_f32_16x16x32_bf16 v[68:71], a[220:223], v[108:111], v[68:71]
  s_waitcnt lgkmcnt(5)
  buffer_load_dwordx4 v135, s[16:19], s63 offen offset:1024 sc1 lds
  v_mfma_f32_16x16x32_bf16 v[64:67], a[224:227], v[88:91], v[64:67]
  ds_read_b128 v[104:107], v112 offset:2048
  v_mfma_f32_16x16x32_bf16 v[68:71], a[228:231], v[88:91], v[68:71]
  s_waitcnt lgkmcnt(5)
  buffer_load_dwordx4 v135, s[16:19], s63 offen offset:2048 sc1 lds
  buffer_load_dwordx4 v135, s[16:19], s63 offen offset:3072 sc1 lds
  v_permlane16_swap_b32 v140, v141
  v_mfma_f32_16x16x32_bf16 v[64:67], a[232:235], v[92:95], v[64:67]
  s_add_u32 m0, s55, 8192
  s_add_u32 s63, s53, 16384
  ds_read_b128 v[108:111], v112 offset:3072
  v_mfma_f32_16x16x32_bf16 v[68:71], a[236:239], v[92:95], v[68:71]
  s_waitcnt lgkmcnt(5)
  v_add_f32 v140, v140, v141
  v_mul_f32 v140, 0x3b000000, v140
  v_mfma_f32_16x16x32_bf16 v[64:67], a[240:243], v[56:59], v[64:67]
  ds_read_b128 v[88:91], v112 offset:4096
  v_add_f32 v140, 0x3727c5ac, v140
  v_mfma_f32_16x16x32_bf16 v[68:71], a[244:247], v[56:59], v[68:71]
  s_add_u32 s3, s65, 6144
  s_waitcnt lgkmcnt(5)
  v_rcp_f32 v15, v140
  v_mfma_f32_16x16x32_bf16 v[64:67], a[248:251], v[60:63], v[64:67]
  v_add_u32 v114, s3, v1
  s_xor_b32 s3, s65, 16384
  ds_read_b128 v[92:95], v112 offset:5120
  v_mfma_f32_16x16x32_bf16 v[68:71], a[252:255], v[60:63], v[68:71]
  s_add_u32 s3, s3, 6144
  s_add_u32 s21, s72, 524288
  s_waitcnt lgkmcnt(5)
  v_add_u32 v115, s3, v1
  v_mfma_f32_16x16x32_bf16 v[72:75], v[144:147], v[96:99], 0
  buffer_load_dwordx4 v[40:43], v5, s[16:19], s21 offen offset:0 sc1
  ds_read_b128 v[56:59], v112 offset:6144
  v_mfma_f32_16x16x32_bf16 v[76:79], v[148:151], v[96:99], 0
  s_waitcnt lgkmcnt(5)
  buffer_load_dwordx4 v[44:47], v5, s[16:19], s21 offen offset:256 sc1
  buffer_load_dwordx4 v[48:51], v5, s[16:19], s21 offen offset:512 sc1
  v_mfma_f32_16x16x32_bf16 v[72:75], v[152:155], v[100:103], v[72:75]
  buffer_load_dwordx4 v[52:55], v5, s[16:19], s21 offen offset:768 sc1
  ds_read_b128 v[60:63], v112 offset:7168
  v_mfma_f32_16x16x32_bf16 v[76:79], v[156:159], v[100:103], v[76:79]
  s_waitcnt lgkmcnt(5)
  v_mfma_f32_16x16x32_bf16 v[72:75], v[160:163], v[104:107], v[72:75]
  s_waitcnt vmcnt(4)
  s_barrier
  ds_read_b128 v[96:99], v112 offset:32768
  v_mfma_f32_16x16x32_bf16 v[76:79], v[164:167], v[104:107], v[76:79]
  s_waitcnt lgkmcnt(5)
  buffer_load_dwordx4 v135, s[16:19], s63 offen offset:0 sc1 lds
  v_mfma_f32_16x16x32_bf16 v[72:75], v[168:171], v[108:111], v[72:75]
  ds_read_b128 v[100:103], v112 offset:33792
  v_mfma_f32_16x16x32_bf16 v[76:79], v[172:175], v[108:111], v[76:79]
  s_waitcnt lgkmcnt(5)
  buffer_load_dwordx4 v135, s[16:19], s63 offen offset:1024 sc1 lds
  v_mfma_f32_16x16x32_bf16 v[72:75], v[176:179], v[88:91], v[72:75]
  ds_read_b128 v[104:107], v112 offset:34816
  v_mfma_f32_16x16x32_bf16 v[76:79], v[180:183], v[88:91], v[76:79]
  s_waitcnt lgkmcnt(5)
  buffer_load_dwordx4 v135, s[16:19], s63 offen offset:2048 sc1 lds
  v_mfma_f32_16x16x32_bf16 v[72:75], v[184:187], v[92:95], v[72:75]
  ds_read_b128 v[108:111], v112 offset:35840
  v_mfma_f32_16x16x32_bf16 v[76:79], v[188:191], v[92:95], v[76:79]
  s_waitcnt lgkmcnt(5)
  v_mfma_f32_16x16x32_bf16 v[72:75], v[192:195], v[56:59], v[72:75]
  s_waitcnt vmcnt(3)
  v_max3_u32 v122, v40, v41, v42
  v_max3_u32 v122, v122, v43, v44
  v_max3_u32 v122, v122, v45, v46
  v_max3_u32 v122, v122, v47, v48
  v_max3_u32 v122, v122, v49, v50
  v_max3_u32 v122, v122, v51, v52
  v_max3_u32 v122, v122, v53, v54
  ds_read_b128 v[88:91], v112 offset:36864
  v_mfma_f32_16x16x32_bf16 v[76:79], v[196:199], v[56:59], v[76:79]
  v_max_u32 v122, v122, v55
  v_cmp_eq_u32 vcc, -1, v122
  s_cbranch_vccnz LS_grr_25
LS_grb_27:
  v_add_f32 v40, v40, v44
  v_add_f32 v48, v48, v52
  v_add_f32 v41, v41, v45
  v_add_f32 v49, v49, v53
  v_add_f32 v42, v42, v46
  s_waitcnt lgkmcnt(5)
  v_mfma_f32_16x16x32_bf16 v[72:75], v[200:203], v[60:63], v[72:75]
  ds_read_b128 v[92:95], v112 offset:37888
  v_add_f32 v50, v50, v54
  v_add_f32 v43, v43, v47
  v_add_f32 v51, v51, v55
  v_add_f32 v40, v40, v48
  v_add_f32 v42, v42, v50
  v_add_f32 v41, v41, v49
  v_add_f32 v43, v43, v51
  v_mfma_f32_16x16x32_bf16 v[76:79], v[204:207], v[60:63], v[76:79]
  s_waitcnt lgkmcnt(5)
  v_permlane32_swap_b32 v40, v42
  v_permlane32_swap_b32 v41, v43
  v_add_f32 v40, v40, v42
  v_add_f32 v41, v41, v43
  s_nop 1
  v_permlane16_swap_b32 v40, v41
  v_mfma_f32_16x16x32_bf16 v[72:75], v[208:211], v[96:99], v[72:75]
  ds_read_b128 v[56:59], v112 offset:38912
  v_add_f32 v40, v40, v41
  v_mov_b32 v41, v40
  s_nop 1
  v_permlane16_swap_b32 v40, v41
  v_mov_b32 v42, v40
  v_mov_b32 v43, v41
  v_mfma_f32_16x16x32_bf16 v[76:79], v[212:215], v[96:99], v[76:79]
  s_waitcnt lgkmcnt(5)
  v_permlane32_swap_b32 v40, v42
  v_permlane32_swap_b32 v41, v43
  v_mul_f32 v40, 0x3b000000, v40
  v_mul_f32 v41, 0x3b000000, v41
  v_fma_f32 v41, -v40, v40, v41
  v_max_f32 v41, 0, v41
  v_mfma_f32_16x16x32_bf16 v[72:75], v[216:219], v[100:103], v[72:75]
  ds_read_b128 v[60:63], v112 offset:39936
  v_add_f32 v41, 0x3727c5ac, v41
  v_rsq_f32 v41, v41
  v_fma_f32 v42, -v40, v43, v42
  v_mul_f32 v42, 0x3b000000, v42
  v_fma_f32 v42, v41, v42, v40
  v_mul_f32 v40, v40, v41
  v_fma_f32 v44, v16, v41, -v40
  v_mfma_f32_16x16x32_bf16 v[76:79], v[220:223], v[100:103], v[76:79]
  v_fma_f32 v45, v17, v41, -v40
  v_fma_f32 v46, v18, v41, -v40
  v_fma_f32 v47, v19, v41, -v40
  v_fma_f32 v48, v20, v41, -v40
  v_fma_f32 v49, v21, v41, -v40
  v_fma_f32 v50, v22, v41, -v40
  v_fma_f32 v51, v23, v41, -v40
  v_fmac_f32 v16, v44, v80
  s_waitcnt lgkmcnt(5)
  v_mfma_f32_16x16x32_bf16 v[72:75], v[224:227], v[104:107], v[72:75]
  v_fmac_f32 v17, v45, v81
  v_fmac_f32 v18, v46, v82
  v_fmac_f32 v19, v47, v83
  v_fmac_f32 v20, v48, v84
  s_lshl_b32 s25, s11, 14
  s_add_u32 s25, s25, 8192
  v_add_u32 v112, s25, v1
  s_waitcnt vmcnt(0)
  s_barrier
  ds_read_b128 v[96:99], v112 offset:0
  v_mfma_f32_16x16x32_bf16 v[76:79], v[228:231], v[104:107], v[76:79]
  v_fmac_f32 v21, v49, v85
  v_fmac_f32 v22, v50, v86
  v_fmac_f32 v23, v51, v87
  v_sub_f32 v80, v16, v42
  v_sub_f32 v81, v17, v42
  v_sub_f32 v82, v18, v42
  v_sub_f32 v83, v19, v42
  v_sub_f32 v84, v20, v42
  s_waitcnt lgkmcnt(5)
  v_mfma_f32_16x16x32_bf16 v[72:75], v[232:235], v[108:111], v[72:75]
  v_sub_f32 v85, v21, v42
  v_sub_f32 v86, v22, v42
  v_sub_f32 v87, v23, v42
  s_add_u32 s3, s68, 0
  v_cvt_pk_bf16_f32 v44, v80, v81
  v_cvt_pk_bf16_f32 v45, v82, v83
  v_cvt_pk_bf16_f32 v46, v84, v85
  v_cvt_pk_bf16_f32 v47, v86, v87
  ds_read_b128 v[100:103], v112 offset:1024
  v_mfma_f32_16x16x32_bf16 v[76:79], v[236:239], v[108:111], v[76:79]
  buffer_store_dwordx4 v[44:47], v1, s[16:19], s3 offen sc1
  v_mul_f32 v40, v80, v80
  v_fmac_f32 v40, v81, v81
  v_fmac_f32 v40, v82, v82
  v_fmac_f32 v40, v83, v83
  v_fmac_f32 v40, v84, v84
  v_fmac_f32 v40, v85, v85
  v_fmac_f32 v40, v86, v86
  s_waitcnt lgkmcnt(5)
  v_mfma_f32_16x16x32_bf16 v[72:75], v[240:243], v[88:91], v[72:75]
  ds_read_b128 v[104:107], v112 offset:2048
  v_fmac_f32 v40, v87, v87
  v_mfma_f32_16x16x32_bf16 v[76:79], v[244:247], v[88:91], v[76:79]
  v_mov_b32 v41, v40
  s_nop 0
  s_add_u32 s15, s71, 131072
  s_waitcnt lgkmcnt(5)
  v_mfma_f32_16x16x32_bf16 v[72:75], v[248:251], v[92:95], v[72:75]
  ds_read_b128 v[108:111], v112 offset:3072
  v_mfma_f32_16x16x32_bf16 v[76:79], v[252:255], v[92:95], v[76:79]
  s_waitcnt lgkmcnt(5)
  v_permlane32_swap_b32 v40, v41
  v_mfma_f32_16x16x32_bf16 v[72:75], a[192:195], v[56:59], v[72:75]
  ds_read_b128 v[88:91], v112 offset:4096
  v_add_f32 v40, v40, v41
  v_mfma_f32_16x16x32_bf16 v[76:79], a[196:199], v[56:59], v[76:79]
  s_waitcnt lgkmcnt(5)
  v_mov_b32 v41, v40
  v_mfma_f32_16x16x32_bf16 v[72:75], a[200:203], v[60:63], v[72:75]
  ds_read_b128 v[92:95], v112 offset:5120
  v_mfma_f32_16x16x32_bf16 v[76:79], a[204:207], v[60:63], v[76:79]
  s_waitcnt lgkmcnt(5)
  v_permlane16_swap_b32 v40, v41
  v_mfma_f32_16x16x32_bf16 v[72:75], a[208:211], v[96:99], v[72:75]
  v_add_f32 v40, v40, v41
  buffer_store_dword v40, v6, s[16:19], s15 offen sc1
  v_mfma_f32_16x16x32_bf16 v[76:79], a[212:215], v[96:99], v[76:79]
  s_waitcnt lgkmcnt(4)
  v_lshlrev_b32 v80, 16, v36
  v_and_b32 v81, 0xffff0000, v36
  v_mfma_f32_16x16x32_bf16 v[72:75], a[216:219], v[100:103], v[72:75]
  v_lshlrev_b32 v82, 16, v37
  v_and_b32 v83, 0xffff0000, v37
  v_mfma_f32_16x16x32_bf16 v[76:79], a[220:223], v[100:103], v[76:79]
  s_waitcnt lgkmcnt(3)
  v_lshlrev_b32 v84, 16, v38
  v_and_b32 v85, 0xffff0000, v38
  v_mfma_f32_16x16x32_bf16 v[72:75], a[224:227], v[104:107], v[72:75]
  v_lshlrev_b32 v86, 16, v39
  v_and_b32 v87, 0xffff0000, v39
  v_mfma_f32_16x16x32_bf16 v[76:79], a[228:231], v[104:107], v[76:79]
  s_waitcnt lgkmcnt(2)
  v_mfma_f32_16x16x32_bf16 v[72:75], a[232:235], v[108:111], v[72:75]
  v_mfma_f32_16x16x32_bf16 v[76:79], a[236:239], v[108:111], v[76:79]
  s_waitcnt lgkmcnt(1)
  v_mfma_f32_16x16x32_bf16 v[72:75], a[240:243], v[88:91], v[72:75]
  v_mfma_f32_16x16x32_bf16 v[76:79], a[244:247], v[88:91], v[76:79]
  s_waitcnt lgkmcnt(0)
  v_mfma_f32_16x16x32_bf16 v[72:75], a[248:251], v[92:95], v[72:75]
  v_mfma_f32_16x16x32_bf16 v[76:79], a[252:255], v[92:95], v[76:79]
  s_nop 7
  s_cmp_eq_u32 s11, 0
  s_cbranch_scc1 LS_sw_43
  v_swap_b32 v64, v72
  v_swap_b32 v65, v73
  v_swap_b32 v66, v74
  v_swap_b32 v67, v75
  v_swap_b32 v68, v76
  v_swap_b32 v69, v77
  v_swap_b32 v70, v78
  v_swap_b32 v71, v79
LS_sw_43:
  ds_write_b128 v114, v[72:75]
  ds_write_b128 v114, v[76:79] offset:1024
  v_fmac_f32 v24, v15, v64
  v_fmac_f32 v25, v15, v65
  v_fmac_f32 v26, v15, v66
  v_fmac_f32 v27, v15, v67
  v_fmac_f32 v28, v15, v68
  v_fmac_f32 v29, v15, v69
  v_fmac_f32 v30, v15, v70
  v_fmac_f32 v31, v15, v71
  s_add_u32 s22, s23, 540672
  s_waitcnt vmcnt(1)
  buffer_store_dword v14, v2, s[16:19], s22 offen sc1
  s_waitcnt lgkmcnt(0)
  s_barrier
  ds_read_b128 v[72:75], v115
  ds_read_b128 v[76:79], v115 offset:1024
  s_waitcnt lgkmcnt(1)
  v_fmac_f32 v24, v15, v72
  v_fmac_f32 v25, v15, v73
  v_fmac_f32 v26, v15, v74
  v_fmac_f32 v27, v15, v75
  s_waitcnt lgkmcnt(0)
  v_fmac_f32 v28, v15, v76
  v_fmac_f32 v29, v15, v77
  v_fmac_f32 v30, v15, v78
  v_fmac_f32 v31, v15, v79
  v_add_f32 v64, v24, v25
  v_mul_f32 v66, v24, v80
  v_mul_f32 v65, v24, v24
  v_add_f32 v67, v80, v81
  v_fmac_f32 v65, v25, v25
  v_fmac_f32 v66, v25, v81
  v_add_f32 v64, v64, v26
  v_fmac_f32 v66, v26, v82
  v_fmac_f32 v65, v26, v26
  v_add_f32 v67, v67, v82
  v_add_f32 v64, v64, v27
  v_fmac_f32 v66, v27, v83
  v_fmac_f32 v65, v27, v27
  v_add_f32 v67, v67, v83
  v_add_f32 v64, v64, v28
  v_fmac_f32 v66, v28, v84
  v_fmac_f32 v65, v28, v28
  v_add_f32 v67, v67, v84
  v_add_f32 v64, v64, v29
  v_fmac_f32 v66, v29, v85
  v_fmac_f32 v65, v29, v29
  v_add_f32 v67, v67, v85
  v_add_f32 v64, v64, v30
  v_fmac_f32 v66, v30, v86
  v_fmac_f32 v65, v30, v30
  v_add_f32 v67, v67, v86
  v_add_f32 v64, v64, v31
  v_fmac_f32 v66, v31, v87
  v_fmac_f32 v65, v31, v31
  v_add_f32 v67, v67, v87
  v_permlane32_swap_b32 v64, v66
  s_nop 0
  v_permlane32_swap_b32 v65, v67
  v_add_f32 v64, v64, v66
  v_add_f32 v65, v65, v67
  s_add_u32 s3, s70, 786432
  s_nop 0
  v_permlane16_swap_b32 v64, v65
  v_add_f32 v64, v64, v65
  buffer_store_dword v64, v4, s[16:19], s3 offen sc1
  s_lshl_b32 s20, s69, 1
  s_add_u32 s20, s20, 540672
  buffer_load_dword v123, v12, s[16:19], s20 offen sc1
  s_waitcnt vmcnt(0)
  v_cmp_ne_u32 vcc, s13, v123
  s_cbranch_vccnz LS_xfr_28
LS_xfb_30:
  s_add_u32 m0, s64, 32768
  s_mov_b32 s63, 0
  buffer_load_dwordx4 v8, s[16:19], s63 offen offset:0 sc1 lds
  buffer_load_dwordx4 v8, s[16:19], s63 offen offset:1024 sc1 lds
  buffer_load_dwordx4 v8, s[16:19], s63 offen offset:2048 sc1 lds
  buffer_load_dwordx4 v8, s[16:19], s63 offen offset:3072 sc1 lds
  s_add_u32 m0, s64, 40960
  s_mov_b32 s63, 8192
  buffer_load_dwordx4 v8, s[16:19], s63 offen offset:0 sc1 lds
  buffer_load_dwordx4 v8, s[16:19], s63 offen offset:1024 sc1 lds
  buffer_load_dwordx4 v8, s[16:19], s63 offen offset:2048 sc1 lds
  buffer_load_dwordx4 v8, s[16:19], s63 offen offset:3072 sc1 lds
  v_add_u32 v112, 0, v1
  s_waitcnt vmcnt(4)
  s_barrier
  ds_read_b128 v[88:91], v112 offset:32768
  ds_read_b128 v[92:95], v112 offset:49152
  ds_read_b128 v[96:99], v112 offset:33792
  ds_read_b128 v[100:103], v112 offset:50176
  s_waitcnt lgkmcnt(2)
  v_mfma_f32_16x16x32_bf16 v[40:43], a[0:3], v[88:91], 0
  s_add_u32 s21, s72, 786432
  buffer_load_dwordx4 v[64:67], v5, s[16:19], s21 offen offset:0 sc1
  ds_read_b128 v[104:107], v112 offset:34816
  v_mfma_f32_16x16x32_bf16 v[44:47], a[4:7], v[88:91], 0
  buffer_load_dwordx4 v[68:71], v5, s[16:19], s21 offen offset:256 sc1
  ds_read_b128 v[108:111], v112 offset:51200
  v_mfma_f32_16x16x32_bf16 v[48:51], a[8:11], v[88:91], 0
  buffer_load_dwordx4 v[72:75], v5, s[16:19], s21 offen offset:512 sc1
  buffer_load_dwordx4 v[76:79], v5, s[16:19], s21 offen offset:768 sc1
  v_mfma_f32_16x16x32_bf16 v[52:55], a[0:3], v[92:95], 0
  s_add_u32 m0, s64, 131072
  s_mov_b32 s63, 32768
  v_mfma_f32_16x16x32_bf16 v[56:59], a[4:7], v[92:95], 0
  buffer_load_dwordx4 v8, s[16:19], s63 offen offset:0 sc1 lds
  v_mfma_f32_16x16x32_bf16 v[60:63], a[8:11], v[92:95], 0
  s_waitcnt lgkmcnt(2)
  v_mfma_f32_16x16x32_bf16 v[40:43], a[12:15], v[96:99], v[40:43]
  ds_read_b128 v[88:91], v112 offset:35840
  v_mfma_f32_16x16x32_bf16 v[44:47], a[16:19], v[96:99], v[44:47]
  ds_read_b128 v[92:95], v112 offset:52224
  v_mfma_f32_16x16x32_bf16 v[48:51], a[20:23], v[96:99], v[48:51]
  v_mfma_f32_16x16x32_bf16 v[52:55], a[12:15], v[100:103], v[52:55]
  buffer_load_dwordx4 v8, s[16:19], s63 offen offset:1024 sc1 lds
  v_mfma_f32_16x16x32_bf16 v[56:59], a[16:19], v[100:103], v[56:59]
  v_mfma_f32_16x16x32_bf16 v[60:63], a[20:23], v[100:103], v[60:63]
  s_waitcnt lgkmcnt(2)
  v_mfma_f32_16x16x32_bf16 v[40:43], a[24:27], v[104:107], v[40:43]
  ds_read_b128 v[96:99], v112 offset:36864
  v_mfma_f32_16x16x32_bf16 v[44:47], a[28:31], v[104:107], v[44:47]
  buffer_load_dwordx4 v8, s[16:19], s63 offen offset:2048 sc1 lds
  ds_read_b128 v[100:103], v112 offset:53248
  v_mfma_f32_16x16x32_bf16 v[48:51], a[32:35], v[104:107], v[48:51]
  v_mfma_f32_16x16x32_bf16 v[52:55], a[24:27], v[108:111], v[52:55]
  v_mfma_f32_16x16x32_bf16 v[56:59], a[28:31], v[108:111], v[56:59]
  v_mfma_f32_16x16x32_bf16 v[60:63], a[32:35], v[108:111], v[60:63]
  s_waitcnt lgkmcnt(2)
  v_mfma_f32_16x16x32_bf16 v[40:43], a[36:39], v[88:91], v[40:43]
  buffer_load_dwordx4 v8, s[16:19], s63 offen offset:3072 sc1 lds
  s_add_u32 m0, s64, 139264
  ds_read_b128 v[104:107], v112 offset:37888
  v_mfma_f32_16x16x32_bf16 v[44:47], a[40:43], v[88:91], v[44:47]
  s_mov_b32 s63, 40960
  ds_read_b128 v[108:111], v112 offset:54272
  v_mfma_f32_16x16x32_bf16 v[48:51], a[44:47], v[88:91], v[48:51]
  v_mfma_f32_16x16x32_bf16 v[52:55], a[36:39], v[92:95], v[52:55]
  v_mfma_f32_16x16x32_bf16 v[56:59], a[40:43], v[92:95], v[56:59]
  v_mfma_f32_16x16x32_bf16 v[60:63], a[44:47], v[92:95], v[60:63]
  s_waitcnt lgkmcnt(2)
  buffer_load_dwordx4 v8, s[16:19], s63 offen offset:0 sc1 lds
  v_mfma_f32_16x16x32_bf16 v[40:43], a[48:51], v[96:99], v[40:43]
  ds_read_b128 v[88:91], v112 offset:38912
  v_mfma_f32_16x16x32_bf16 v[44:47], a[52:55], v[96:99], v[44:47]
  ds_read_b128 v[92:95], v112 offset:55296
  v_mfma_f32_16x16x32_bf16 v[48:51], a[56:59], v[96:99], v[48:51]
  v_mfma_f32_16x16x32_bf16 v[52:55], a[48:51], v[100:103], v[52:55]
  s_waitcnt vmcnt(5)
  v_max3_u32 v122, v64, v65, v66
  v_max3_u32 v122, v122, v67, v68
  v_max3_u32 v122, v122, v69, v70
  v_max3_u32 v122, v122, v71, v72
  v_mfma_f32_16x16x32_bf16 v[56:59], a[52:55], v[100:103], v[56:59]
  buffer_load_dwordx4 v8, s[16:19], s63 offen offset:1024 sc1 lds
  v_max3_u32 v122, v122, v73, v74
  v_max3_u32 v122, v122, v75, v76
  v_max3_u32 v122, v122, v77, v78
  v_mfma_f32_16x16x32_bf16 v[60:63], a[56:59], v[100:103], v[60:63]
  v_max_u32 v122, v122, v79
  v_cmp_eq_u32 vcc, -1, v122
  s_cbranch_vccnz LS_grr_44
LS_grb_46:
  s_waitcnt lgkmcnt(2)
  v_add_f32 v64, v64, v68
  v_mfma_f32_16x16x32_bf16 v[40:43], a[60:63], v[104:107], v[40:43]
  ds_read_b128 v[96:99], v112 offset:39936
  v_add_f32 v72, v72, v76
  v_add_f32 v65, v65, v69
  v_add_f32 v73, v73, v77
  v_mfma_f32_16x16x32_bf16 v[44:47], a[64:67], v[104:107], v[44:47]
  buffer_load_dwordx4 v8, s[16:19], s63 offen offset:2048 sc1 lds
  ds_read_b128 v[100:103], v112 offset:56320
  v_add_f32 v66, v66, v70
  v_add_f32 v74, v74, v78
  v_mfma_f32_16x16x32_bf16 v[48:51], a[68:71], v[104:107], v[48:51]
  v_add_f32 v67, v67, v71
  v_add_f32 v75, v75, v79
  v_add_f32 v64, v64, v72
  v_add_f32 v66, v66, v74
  v_mfma_f32_16x16x32_bf16 v[52:55], a[60:63], v[108:111], v[52:55]
  v_add_f32 v65, v65, v73
  v_add_f32 v67, v67, v75
  v_permlane32_swap_b32 v64, v66
  v_mfma_f32_16x16x32_bf16 v[56:59], a[64:67], v[108:111], v[56:59]
  v_permlane32_swap_b32 v65, v67
  v_add_f32 v64, v64, v66
  v_add_f32 v65, v65, v67
  v_mfma_f32_16x16x32_bf16 v[60:63], a[68:71], v[108:111], v[60:63]
  s_waitcnt lgkmcnt(2)
  buffer_load_dwordx4 v8, s[16:19], s63 offen offset:3072 sc1 lds
  v_permlane16_swap_b32 v64, v65
  v_add_f32 v64, v64, v65
  v_mfma_f32_16x16x32_bf16 v[40:43], a[72:75], v[88:91], v[40:43]
  v_mov_b32 v65, v64
  s_barrier
  ds_read_b128 v[104:107], v112 offset:40960
  v_mfma_f32_16x16x32_bf16 v[44:47], a[76:79], v[88:91], v[44:47]
  ds_read_b128 v[108:111], v112 offset:57344
  v_permlane16_swap_b32 v64, v65
  v_mov_b32 v66, v64
  v_mfma_f32_16x16x32_bf16 v[48:51], a[80:83], v[88:91], v[48:51]
  v_mov_b32 v67, v65
  v_permlane32_swap_b32 v64, v66
  v_mfma_f32_16x16x32_bf16 v[52:55], a[72:75], v[92:95], v[52:55]
  v_permlane32_swap_b32 v65, v67
  v_mul_f32 v64, 0x3b000000, v64
  v_mul_f32 v65, 0x3b000000, v65
  v_mfma_f32_16x16x32_bf16 v[56:59], a[76:79], v[92:95], v[56:59]
  v_fma_f32 v65, -v64, v64, v65
  v_max_f32 v65, 0, v65
  v_add_f32 v65, 0x3727c5ac, v65
  v_rsq_f32 v65, v65
  v_mfma_f32_16x16x32_bf16 v[60:63], a[80:83], v[92:95], v[60:63]
  s_waitcnt lgkmcnt(2)
  v_fma_f32 v66, -v64, v67, v66
  v_mul_f32 v66, 0x3b000000, v66
  v_fma_f32 v66, v65, v66, v64
  v_mul_f32 v64, v64, v65
  v_mfma_f32_16x16x32_bf16 v[40:43], a[84:87], v[96:99], v[40:43]
  ds_read_b128 v[88:91], v112 offset:41984
  v_fma_f32 v68, v24, v65, -v64
  v_fma_f32 v69, v25, v65, -v64
  v_fma_f32 v70, v26, v65, -v64
  v_mfma_f32_16x16x32_bf16 v[44:47], a[88:91], v[96:99], v[44:47]
  ds_read_b128 v[92:95], v112 offset:58368
  v_fma_f32 v71, v27, v65, -v64
  v_fma_f32 v72, v28, v65, -v64
  v_fma_f32 v73, v29, v65, -v64
  v_mfma_f32_16x16x32_bf16 v[48:51], a[92:95], v[96:99], v[48:51]
  v_fma_f32 v74, v30, v65, -v64
  v_fma_f32 v75, v31, v65, -v64
  v_fmac_f32 v24, v68, v80
  v_fmac_f32 v25, v69, v81
  v_mfma_f32_16x16x32_bf16 v[52:55], a[84:87], v[100:103], v[52:55]
  v_fmac_f32 v26, v70, v82
  v_fmac_f32 v27, v71, v83
  v_fmac_f32 v28, v72, v84
  v_fmac_f32 v29, v73, v85
  v_mfma_f32_16x16x32_bf16 v[56:59], a[88:91], v[100:103], v[56:59]
  v_fmac_f32 v30, v74, v86
  v_fmac_f32 v31, v75, v87
  v_sub_f32 v80, v24, v66
  v_sub_f32 v81, v25, v66
  v_mfma_f32_16x16x32_bf16 v[60:63], a[92:95], v[100:103], v[60:63]
  s_waitcnt lgkmcnt(2)
  v_sub_f32 v82, v26, v66
  v_sub_f32 v83, v27, v66
  v_sub_f32 v84, v28, v66
  v_sub_f32 v85, v29, v66
  v_mfma_f32_16x16x32_bf16 v[40:43], a[96:99], v[104:107], v[40:43]
  s_add_u32 s3, s68, 65536
  ds_read_b128 v[96:99], v112 offset:43008
  v_sub_f32 v86, v30, v66
  v_sub_f32 v87, v31, v66
  v_cvt_pk_bf16_f32 v68, v80, v81
  v_mfma_f32_16x16x32_bf16 v[44:47], a[100:103], v[104:107], v[44:47]
  ds_read_b128 v[100:103], v112 offset:59392
  v_cvt_pk_bf16_f32 v69, v82, v83
  v_cvt_pk_bf16_f32 v70, v84, v85
  v_cvt_pk_bf16_f32 v71, v86, v87
  v_mfma_f32_16x16x32_bf16 v[48:51], a[104:107], v[104:107], v[48:51]
  buffer_store_dwordx4 v[68:71], v1, s[16:19], s3 offen sc1
  v_mul_f32 v64, v80, v80
  v_fmac_f32 v64, v81, v81
  v_fmac_f32 v64, v82, v82
  v_mfma_f32_16x16x32_bf16 v[52:55], a[96:99], v[108:111], v[52:55]
  s_add_u32 s22, s23, 540928
  v_fmac_f32 v64, v83, v83
  v_fmac_f32 v64, v84, v84
  v_mfma_f32_16x16x32_bf16 v[56:59], a[100:103], v[108:111], v[56:59]
  v_fmac_f32 v64, v85, v85
  v_fmac_f32 v64, v86, v86
  v_mfma_f32_16x16x32_bf16 v[60:63], a[104:107], v[108:111], v[60:63]
  s_waitcnt lgkmcnt(2)
  v_fmac_f32 v64, v87, v87
  v_mov_b32 v65, v64
  v_mfma_f32_16x16x32_bf16 v[40:43], a[108:111], v[88:91], v[40:43]
  s_nop 0
  s_add_u32 s15, s71, 196608
  ds_read_b128 v[104:107], v112 offset:44032
  v_mfma_f32_16x16x32_bf16 v[44:47], a[112:115], v[88:91], v[44:47]
  ds_read_b128 v[108:111], v112 offset:60416
  v_mfma_f32_16x16x32_bf16 v[48:51], a[116:119], v[88:91], v[48:51]
  v_permlane32_swap_b32 v64, v65
  v_mfma_f32_16x16x32_bf16 v[52:55], a[108:111], v[92:95], v[52:55]
  v_add_f32 v64, v64, v65
  v_mov_b32 v65, v64
  v_mfma_f32_16x16x32_bf16 v[56:59], a[112:115], v[92:95], v[56:59]
  s_nop 0
  v_permlane16_swap_b32 v64, v65
  v_mfma_f32_16x16x32_bf16 v[60:63], a[116:119], v[92:95], v[60:63]
  s_waitcnt lgkmcnt(2)
  v_add_f32 v64, v64, v65
  buffer_store_dword v64, v6, s[16:19], s15 offen sc1
  v_mfma_f32_16x16x32_bf16 v[40:43], a[120:123], v[96:99], v[40:43]
  ds_read_b128 v[88:91], v112 offset:45056
  v_mfma_f32_16x16x32_bf16 v[44:47], a[124:127], v[96:99], v[44:47]
  ds_read_b128 v[92:95], v112 offset:61440
  v_mfma_f32_16x16x32_bf16 v[48:51], a[128:131], v[96:99], v[48:51]
  v_mfma_f32_16x16x32_bf16 v[52:55], a[120:123], v[100:103], v[52:55]
  v_mfma_f32_16x16x32_bf16 v[56:59], a[124:127], v[100:103], v[56:59]
  v_mfma_f32_16x16x32_bf16 v[60:63], a[128:131], v[100:103], v[60:63]
  s_waitcnt lgkmcnt(2)
  v_mfma_f32_16x16x32_bf16 v[40:43], a[132:135], v[104:107], v[40:43]
  ds_read_b128 v[96:99], v112 offset:46080
  v_mfma_f32_16x16x32_bf16 v[44:47], a[136:139], v[104:107], v[44:47]
  ds_read_b128 v[100:103], v112 offset:62464
  v_mfma_f32_16x16x32_bf16 v[48:51], a[140:143], v[104:107], v[48:51]
  v_mfma_f32_16x16x32_bf16 v[52:55], a[132:135], v[108:111], v[52:55]
  v_mfma_f32_16x16x32_bf16 v[56:59], a[136:139], v[108:111], v[56:59]
  v_mfma_f32_16x16x32_bf16 v[60:63], a[140:143], v[108:111], v[60:63]
  s_waitcnt lgkmcnt(2)
  v_mfma_f32_16x16x32_bf16 v[40:43], a[144:147], v[88:91], v[40:43]
  ds_read_b128 v[104:107], v112 offset:47104
  v_mfma_f32_16x16x32_bf16 v[44:47], a[148:151], v[88:91], v[44:47]
  ds_read_b128 v[108:111], v112 offset:63488
  v_mfma_f32_16x16x32_bf16 v[48:51], a[152:155], v[88:91], v[48:51]
  v_mfma_f32_16x16x32_bf16 v[52:55], a[144:147], v[92:95], v[52:55]
  v_mfma_f32_16x16x32_bf16 v[56:59], a[148:151], v[92:95], v[56:59]
  v_mfma_f32_16x16x32_bf16 v[60:63], a[152:155], v[92:95], v[60:63]
  s_waitcnt lgkmcnt(2)
  v_mfma_f32_16x16x32_bf16 v[40:43], a[156:159], v[96:99], v[40:43]
  ds_read_b128 v[88:91], v112 offset:48128
  v_mfma_f32_16x16x32_bf16 v[44:47], a[160:163], v[96:99], v[44:47]
  ds_read_b128 v[92:95], v112 offset:64512
  v_mfma_f32_16x16x32_bf16 v[48:51], a[164:167], v[96:99], v[48:51]
  v_mfma_f32_16x16x32_bf16 v[52:55], a[156:159], v[100:103], v[52:55]
  v_mfma_f32_16x16x32_bf16 v[56:59], a[160:163], v[100:103], v[56:59]
  v_mfma_f32_16x16x32_bf16 v[60:63], a[164:167], v[100:103], v[60:63]
  s_waitcnt lgkmcnt(2)
  v_mfma_f32_16x16x32_bf16 v[40:43], a[168:171], v[104:107], v[40:43]
  s_waitcnt vmcnt(2)
  v_add_u32 v112, 131072, v1
  s_barrier
  ds_read_b128 v[96:99], v112 offset:0
  v_mfma_f32_16x16x32_bf16 v[44:47], a[172:175], v[104:107], v[44:47]
  ds_read_b128 v[100:103], v112 offset:16384
  v_mfma_f32_16x16x32_bf16 v[48:51], a[176:179], v[104:107], v[48:51]
  v_mfma_f32_16x16x32_bf16 v[52:55], a[168:171], v[108:111], v[52:55]
  v_mfma_f32_16x16x32_bf16 v[56:59], a[172:175], v[108:111], v[56:59]
  v_mfma_f32_16x16x32_bf16 v[60:63], a[176:179], v[108:111], v[60:63]
  s_waitcnt lgkmcnt(2)
  v_mfma_f32_16x16x32_bf16 v[40:43], a[180:183], v[88:91], v[40:43]
  ds_read_b128 v[104:107], v112 offset:1024
  v_mfma_f32_16x16x32_bf16 v[44:47], a[184:187], v[88:91], v[44:47]
  ds_read_b128 v[108:111], v112 offset:17408
  v_mfma_f32_16x16x32_bf16 v[48:51], a[188:191], v[88:91], v[48:51]
  v_mfma_f32_16x16x32_bf16 v[52:55], a[180:183], v[92:95], v[52:55]
  v_mfma_f32_16x16x32_bf16 v[56:59], a[184:187], v[92:95], v[56:59]
  v_mfma_f32_16x16x32_bf16 v[60:63], a[188:191], v[92:95], v[60:63]
  s_waitcnt lgkmcnt(2)
  v_mfma_f32_16x16x32_bf16 v[64:67], a[0:3], v[96:99], 0
  ds_read_b128 v[88:91], v112 offset:2048
  v_mfma_f32_16x16x32_bf16 v[68:71], a[4:7], v[96:99], 0
  ds_read_b128 v[92:95], v112 offset:18432
  v_mfma_f32_16x16x32_bf16 v[72:75], a[8:11], v[96:99], 0
  v_mfma_f32_16x16x32_bf16 v[76:79], a[0:3], v[100:103], 0
  v_mfma_f32_16x16x32_bf16 v[80:83], a[4:7], v[100:103], 0
  v_mfma_f32_16x16x32_bf16 v[84:87], a[8:11], v[100:103], 0
  s_waitcnt lgkmcnt(2)
  v_mfma_f32_16x16x32_bf16 v[64:67], a[12:15], v[104:107], v[64:67]
  ds_read_b128 v[96:99], v112 offset:3072
  v_mfma_f32_16x16x32_bf16 v[68:71], a[16:19], v[104:107], v[68:71]
  ds_read_b128 v[100:103], v112 offset:19456
  v_mfma_f32_16x16x32_bf16 v[72:75], a[20:23], v[104:107], v[72:75]
  v_mfma_f32_16x16x32_bf16 v[76:79], a[12:15], v[108:111], v[76:79]
  s_waitcnt vmcnt(1)
  buffer_store_dword v14, v2, s[16:19], s22 offen sc1
  v_mfma_f32_16x16x32_bf16 v[80:83], a[16:19], v[108:111], v[80:83]
  v_mfma_f32_16x16x32_bf16 v[84:87], a[20:23], v[108:111], v[84:87]
  s_waitcnt lgkmcnt(2)
  v_mfma_f32_16x16x32_bf16 v[64:67], a[24:27], v[88:91], v[64:67]
  ds_read_b128 v[104:107], v112 offset:4096
  v_mfma_f32_16x16x32_bf16 v[68:71], a[28:31], v[88:91], v[68:71]
  ds_read_b128 v[108:111], v112 offset:20480
  v_mfma_f32_16x16x32_bf16 v[72:75], a[32:35], v[88:91], v[72:75]
  v_mfma_f32_16x16x32_bf16 v[76:79], a[24:27], v[92:95], v[76:79]
  v_mfma_f32_16x16x32_bf16 v[80:83], a[28:31], v[92:95], v[80:83]
  v_mfma_f32_16x16x32_bf16 v[84:87], a[32:35], v[92:95], v[84:87]
  s_waitcnt lgkmcnt(2)
  v_mfma_f32_16x16x32_bf16 v[64:67], a[36:39], v[96:99], v[64:67]
  ds_read_b128 v[88:91], v112 offset:5120
  v_mfma_f32_16x16x32_bf16 v[68:71], a[40:43], v[96:99], v[68:71]
  ds_read_b128 v[92:95], v112 offset:21504
  v_mfma_f32_16x16x32_bf16 v[72:75], a[44:47], v[96:99], v[72:75]
  v_mfma_f32_16x16x32_bf16 v[76:79], a[36:39], v[100:103], v[76:79]
  v_mfma_f32_16x16x32_bf16 v[80:83], a[40:43], v[100:103], v[80:83]
  v_mfma_f32_16x16x32_bf16 v[84:87], a[44:47], v[100:103], v[84:87]
  s_waitcnt lgkmcnt(2)
  v_mfma_f32_16x16x32_bf16 v[64:67], a[48:51], v[104:107], v[64:67]
  ds_read_b128 v[96:99], v112 offset:6144
  v_mfma_f32_16x16x32_bf16 v[68:71], a[52:55], v[104:107], v[68:71]
  ds_read_b128 v[100:103], v112 offset:22528
  v_mfma_f32_16x16x32_bf16 v[72:75], a[56:59], v[104:107], v[72:75]
  v_mfma_f32_16x16x32_bf16 v[76:79], a[48:51], v[108:111], v[76:79]
  s_lshl_b32 s20, s69, 1
  s_add_u32 s20, s20, 540928
  buffer_load_dword v123, v12, s[16:19], s20 offen sc1
  v_mfma_f32_16x16x32_bf16 v[80:83], a[52:55], v[108:111], v[80:83]
  v_max_f32 v40, 0, v40
  v_max_f32 v41, 0, v41
  v_mfma_f32_16x16x32_bf16 v[84:87], a[56:59], v[108:111], v[84:87]
  s_waitcnt lgkmcnt(2)
  v_max_f32 v42, 0, v42
  v_max_f32 v43, 0, v43
  v_mfma_f32_16x16x32_bf16 v[64:67], a[60:63], v[88:91], v[64:67]
  ds_read_b128 v[104:107], v112 offset:7168
  v_mul_f32 v40, v40, v44
  v_mfma_f32_16x16x32_bf16 v[68:71], a[64:67], v[88:91], v[68:71]
  ds_read_b128 v[108:111], v112 offset:23552
  v_mul_f32 v41, v41, v45
  v_mfma_f32_16x16x32_bf16 v[72:75], a[68:71], v[88:91], v[72:75]
  v_mul_f32 v42, v42, v46
  v_mul_f32 v43, v43, v47
  v_mfma_f32_16x16x32_bf16 v[76:79], a[60:63], v[92:95], v[76:79]
  v_cvt_pk_bf16_f32 v114, v40, v41
  v_cvt_pk_bf16_f32 v115, v42, v43
  v_mfma_f32_16x16x32_bf16 v[80:83], a[64:67], v[92:95], v[80:83]
  v_max_f32 v52, 0, v52
  v_max_f32 v53, 0, v53
  v_mfma_f32_16x16x32_bf16 v[84:87], a[68:71], v[92:95], v[84:87]
  s_waitcnt lgkmcnt(2)
  v_max_f32 v54, 0, v54
  v_max_f32 v55, 0, v55
  v_mfma_f32_16x16x32_bf16 v[64:67], a[72:75], v[96:99], v[64:67]
  ds_read_b128 v[88:91], v112 offset:8192
  v_mul_f32 v52, v52, v56
  v_mfma_f32_16x16x32_bf16 v[68:71], a[76:79], v[96:99], v[68:71]
  ds_read_b128 v[92:95], v112 offset:24576
  v_mul_f32 v53, v53, v57
  v_mfma_f32_16x16x32_bf16 v[72:75], a[80:83], v[96:99], v[72:75]
  v_mul_f32 v54, v54, v58
  v_mul_f32 v55, v55, v59
  v_mfma_f32_16x16x32_bf16 v[76:79], a[72:75], v[100:103], v[76:79]
  v_cvt_pk_bf16_f32 v116, v52, v53
  v_cvt_pk_bf16_f32 v117, v54, v55
  v_mfma_f32_16x16x32_bf16 v[80:83], a[76:79], v[100:103], v[80:83]
  v_permlane16_swap_b32 v48, v60
  v_mfma_f32_16x16x32_bf16 v[84:87], a[80:83], v[100:103], v[84:87]
  s_waitcnt lgkmcnt(2)
  v_permlane16_swap_b32 v49, v61
  v_mfma_f32_16x16x32_bf16 v[64:67], a[84:87], v[104:107], v[64:67]
  ds_read_b128 v[96:99], v112 offset:9216
  v_mfma_f32_16x16x32_bf16 v[68:71], a[88:91], v[104:107], v[68:71]
  ds_read_b128 v[100:103], v112 offset:25600
  v_mfma_f32_16x16x32_bf16 v[72:75], a[92:95], v[104:107], v[72:75]
  v_permlane16_swap_b32 v50, v62
  v_mfma_f32_16x16x32_bf16 v[76:79], a[84:87], v[108:111], v[76:79]
  v_permlane16_swap_b32 v51, v63
  v_mfma_f32_16x16x32_bf16 v[80:83], a[88:91], v[108:111], v[80:83]
  v_permlane16_swap_b32 v114, v116
  v_mfma_f32_16x16x32_bf16 v[84:87], a[92:95], v[108:111], v[84:87]
  s_waitcnt lgkmcnt(2)
  v_permlane16_swap_b32 v115, v117
  v_mfma_f32_16x16x32_bf16 v[64:67], a[96:99], v[88:91], v[64:67]
  s_mov_b32 s15, 0
  buffer_store_dwordx4 v[114:117], v10, s[16:19], s15 offen sc1
  ds_read_b128 v[104:107], v112 offset:10240
  v_mfma_f32_16x16x32_bf16 v[68:71], a[100:103], v[88:91], v[68:71]
  ds_read_b128 v[108:111], v112 offset:26624
  v_max_f32 v48, 0, v48
  v_mfma_f32_16x16x32_bf16 v[72:75], a[104:107], v[88:91], v[72:75]
  v_max_f32 v49, 0, v49
  v_max_f32 v50, 0, v50
  v_mfma_f32_16x16x32_bf16 v[76:79], a[96:99], v[92:95], v[76:79]
  v_max_f32 v51, 0, v51
  v_mul_f32 v48, v48, v60
  v_mfma_f32_16x16x32_bf16 v[80:83], a[100:103], v[92:95], v[80:83]
  v_mul_f32 v49, v49, v61
  v_mul_f32 v50, v50, v62
  v_mfma_f32_16x16x32_bf16 v[84:87], a[104:107], v[92:95], v[84:87]
  s_waitcnt lgkmcnt(2)
  v_mul_f32 v51, v51, v63
  v_cvt_pk_bf16_f32 v118, v48, v49
  v_mfma_f32_16x16x32_bf16 v[64:67], a[108:111], v[96:99], v[64:67]
  ds_read_b128 v[88:91], v112 offset:11264
  v_cvt_pk_bf16_f32 v119, v50, v51
  v_mfma_f32_16x16x32_bf16 v[68:71], a[112:115], v[96:99], v[68:71]
  ds_read_b128 v[92:95], v112 offset:27648
  v_mov_b32 v120, v118
  v_mfma_f32_16x16x32_bf16 v[72:75], a[116:119], v[96:99], v[72:75]
  v_mov_b32 v121, v119
  s_nop 0
  v_mfma_f32_16x16x32_bf16 v[76:79], a[108:111], v[100:103], v[76:79]
  v_permlane32_swap_b32 v118, v120
  v_mfma_f32_16x16x32_bf16 v[80:83], a[112:115], v[100:103], v[80:83]
  v_permlane32_swap_b32 v119, v121
  v_mfma_f32_16x16x32_bf16 v[84:87], a[116:119], v[100:103], v[84:87]
  s_waitcnt lgkmcnt(2)
  buffer_store_dwordx4 v[118:121], v11, s[16:19], s15 offen sc1
  v_mfma_f32_16x16x32_bf16 v[64:67], a[120:123], v[104:107], v[64:67]
  s_add_u32 s22, s23, 573440
  ds_read_b128 v[96:99], v112 offset:12288
  v_mfma_f32_16x16x32_bf16 v[68:71], a[124:127], v[104:107], v[68:71]
  ds_read_b128 v[100:103], v112 offset:28672
  v_mfma_f32_16x16x32_bf16 v[72:75], a[128:131], v[104:107], v[72:75]
  v_mfma_f32_16x16x32_bf16 v[76:79], a[120:123], v[108:111], v[76:79]
  v_mfma_f32_16x16x32_bf16 v[80:83], a[124:127], v[108:111], v[80:83]
  v_mfma_f32_16x16x32_bf16 v[84:87], a[128:131], v[108:111], v[84:87]
  s_waitcnt lgkmcnt(2)
  s_waitcnt vmcnt(2)
  v_cmp_ne_u32 vcc, s13, v123
  s_cbranch_vccnz LS_xfr_47
LS_xfb_49:
  s_add_u32 m0, s64, 65536
  s_mov_b32 s63, 65536
  buffer_load_dwordx4 v8, s[16:19], s63 offen offset:0 sc1 lds
  buffer_load_dwordx4 v8, s[16:19], s63 offen offset:1024 sc1 lds
  buffer_load_dwordx4 v8, s[16:19], s63 offen offset:2048 sc1 lds
  buffer_load_dwordx4 v8, s[16:19], s63 offen offset:3072 sc1 lds
  s_add_u32 m0, s64, 73728
  s_mov_b32 s63, 73728
  buffer_load_dwordx4 v8, s[16:19], s63 offen offset:0 sc1 lds
  buffer_load_dwordx4 v8, s[16:19], s63 offen offset:1024 sc1 lds
  buffer_load_dwordx4 v8, s[16:19], s63 offen offset:2048 sc1 lds
  buffer_load_dwordx4 v8, s[16:19], s63 offen offset:3072 sc1 lds
  v_mfma_f32_16x16x32_bf16 v[64:67], a[132:135], v[88:91], v[64:67]
  s_add_u32 m0, s64, 98304
  s_mov_b32 s63, 98304
  ds_read_b128 v[104:107], v112 offset:13312
  v_mfma_f32_16x16x32_bf16 v[68:71], a[136:139], v[88:91], v[68:71]
  ds_read_b128 v[108:111], v112 offset:29696
  v_mfma_f32_16x16x32_bf16 v[72:75], a[140:143], v[88:91], v[72:75]
  v_mfma_f32_16x16x32_bf16 v[76:79], a[132:135], v[92:95], v[76:79]
  v_mfma_f32_16x16x32_bf16 v[80:83], a[136:139], v[92:95], v[80:83]
  v_mfma_f32_16x16x32_bf16 v[84:87], a[140:143], v[92:95], v[84:87]
  s_waitcnt lgkmcnt(2)
  v_mfma_f32_16x16x32_bf16 v[64:67], a[144:147], v[96:99], v[64:67]
  ds_read_b128 v[88:91], v112 offset:14336
  v_mfma_f32_16x16x32_bf16 v[68:71], a[148:151], v[96:99], v[68:71]
  ds_read_b128 v[92:95], v112 offset:30720
  v_mfma_f32_16x16x32_bf16 v[72:75], a[152:155], v[96:99], v[72:75]
  v_mfma_f32_16x16x32_bf16 v[76:79], a[144:147], v[100:103], v[76:79]
  v_mfma_f32_16x16x32_bf16 v[80:83], a[148:151], v[100:103], v[80:83]
  v_mfma_f32_16x16x32_bf16 v[84:87], a[152:155], v[100:103], v[84:87]
  s_waitcnt lgkmcnt(2)
  v_mfma_f32_16x16x32_bf16 v[64:67], a[156:159], v[104:107], v[64:67]
  ds_read_b128 v[96:99], v112 offset:15360
  v_mfma_f32_16x16x32_bf16 v[68:71], a[160:163], v[104:107], v[68:71]
  ds_read_b128 v[100:103], v112 offset:31744
  v_mfma_f32_16x16x32_bf16 v[72:75], a[164:167], v[104:107], v[72:75]
  v_mfma_f32_16x16x32_bf16 v[76:79], a[156:159], v[108:111], v[76:79]
  v_mfma_f32_16x16x32_bf16 v[80:83], a[160:163], v[108:111], v[80:83]
  v_mfma_f32_16x16x32_bf16 v[84:87], a[164:167], v[108:111], v[84:87]
  s_waitcnt lgkmcnt(2)
  v_mfma_f32_16x16x32_bf16 v[64:67], a[168:171], v[88:91], v[64:67]
  s_waitcnt vmcnt(0)
  v_add_u32 v112, 65536, v1
  s_barrier
  ds_read_b128 v[104:107], v112 offset:0
  v_mfma_f32_16x16x32_bf16 v[68:71], a[172:175], v[88:91], v[68:71]
  buffer_store_dword v14, v2, s[16:19], s22 offen sc1
  ds_read_b128 v[108:111], v112 offset:16384
  v_mfma_f32_16x16x32_bf16 v[72:75], a[176:179], v[88:91], v[72:75]
  buffer_load_dwordx4 v8, s[16:19], s63 offen offset:0 sc1 lds
  v_mfma_f32_16x16x32_bf16 v[76:79], a[168:171], v[92:95], v[76:79]
  v_mfma_f32_16x16x32_bf16 v[80:83], a[172:175], v[92:95], v[80:83]
  buffer_load_dwordx4 v8, s[16:19], s63 offen offset:1024 sc1 lds
  v_mfma_f32_16x16x32_bf16 v[84:87], a[176:179], v[92:95], v[84:87]
  s_waitcnt lgkmcnt(2)
  v_mfma_f32_16x16x32_bf16 v[64:67], a[180:183], v[96:99], v[64:67]
  ds_read_b128 v[88:91], v112 offset:1024
  v_mfma_f32_16x16x32_bf16 v[68:71], a[184:187], v[96:99], v[68:71]
  ds_read_b128 v[92:95], v112 offset:17408
  v_mfma_f32_16x16x32_bf16 v[72:75], a[188:191], v[96:99], v[72:75]
  v_mfma_f32_16x16x32_bf16 v[76:79], a[180:183], v[100:103], v[76:79]
  buffer_load_dwordx4 v8, s[16:19], s63 offen offset:2048 sc1 lds
  v_mfma_f32_16x16x32_bf16 v[80:83], a[184:187], v[100:103], v[80:83]
  v_mfma_f32_16x16x32_bf16 v[84:87], a[188:191], v[100:103], v[84:87]
  s_waitcnt lgkmcnt(2)
  v_mfma_f32_16x16x32_bf16 v[40:43], a[0:3], v[104:107], 0
  ds_read_b128 v[96:99], v112 offset:2048
  v_mfma_f32_16x16x32_bf16 v[44:47], a[4:7], v[104:107], 0
  buffer_load_dwordx4 v8, s[16:19], s63 offen offset:3072 sc1 lds
  s_add_u32 m0, s64, 106496
  ds_read_b128 v[100:103], v112 offset:18432
  v_mfma_f32_16x16x32_bf16 v[48:51], a[8:11], v[104:107], 0
  s_mov_b32 s63, 106496
  v_max_f32 v64, 0, v64
  v_max_f32 v65, 0, v65
  v_mfma_f32_16x16x32_bf16 v[52:55], a[0:3], v[108:111], 0
  v_max_f32 v66, 0, v66
  v_max_f32 v67, 0, v67
  v_mfma_f32_16x16x32_bf16 v[56:59], a[4:7], v[108:111], 0
  v_mul_f32 v64, v64, v68
  v_mul_f32 v65, v65, v69
  v_mfma_f32_16x16x32_bf16 v[60:63], a[8:11], v[108:111], 0
  s_waitcnt lgkmcnt(2)
  v_mul_f32 v66, v66, v70
  v_mul_f32 v67, v67, v71
  v_mfma_f32_16x16x32_bf16 v[40:43], a[12:15], v[88:91], v[40:43]
  buffer_load_dwordx4 v8, s[16:19], s63 offen offset:0 sc1 lds
  ds_read_b128 v[104:107], v112 offset:3072
  v_mfma_f32_16x16x32_bf16 v[44:47], a[16:19], v[88:91], v[44:47]
  s_lshl_b32 s20, s69, 1
  s_add_u32 s20, s20, 573440
  ds_read_b128 v[108:111], v112 offset:19456
  v_mfma_f32_16x16x32_bf16 v[48:51], a[20:23], v[88:91], v[48:51]
  buffer_load_dword v123, v13, s[16:19], s20 offen sc1
  v_cvt_pk_bf16_f32 v114, v64, v65
  v_mfma_f32_16x16x32_bf16 v[52:55], a[12:15], v[92:95], v[52:55]
  v_cvt_pk_bf16_f32 v115, v66, v67
  v_max_f32 v76, 0, v76
  v_mfma_f32_16x16x32_bf16 v[56:59], a[16:19], v[92:95], v[56:59]
  v_max_f32 v77, 0, v77
  v_max_f32 v78, 0, v78
  v_mfma_f32_16x16x32_bf16 v[60:63], a[20:23], v[92:95], v[60:63]
  s_waitcnt lgkmcnt(2)
  v_max_f32 v79, 0, v79
  v_mul_f32 v76, v76, v80
  v_mfma_f32_16x16x32_bf16 v[40:43], a[24:27], v[96:99], v[40:43]
  buffer_load_dwordx4 v8, s[16:19], s63 offen offset:1024 sc1 lds
  ds_read_b128 v[88:91], v112 offset:4096
  v_mfma_f32_16x16x32_bf16 v[44:47], a[28:31], v[96:99], v[44:47]
  ds_read_b128 v[92:95], v112 offset:20480
  v_mul_f32 v77, v77, v81
  v_mfma_f32_16x16x32_bf16 v[48:51], a[32:35], v[96:99], v[48:51]
  v_mul_f32 v78, v78, v82
  v_mul_f32 v79, v79, v83
  v_mfma_f32_16x16x32_bf16 v[52:55], a[24:27], v[100:103], v[52:55]
  v_cvt_pk_bf16_f32 v116, v76, v77
  v_cvt_pk_bf16_f32 v117, v78, v79
  v_mfma_f32_16x16x32_bf16 v[56:59], a[28:31], v[100:103], v[56:59]
  buffer_load_dwordx4 v8, s[16:19], s63 offen offset:2048 sc1 lds
  v_mfma_f32_16x16x32_bf16 v[60:63], a[32:35], v[100:103], v[60:63]
  s_waitcnt lgkmcnt(2)
  v_permlane16_swap_b32 v72, v84
  v_mfma_f32_16x16x32_bf16 v[40:43], a[36:39], v[104:107], v[40:43]
  ds_read_b128 v[96:99], v112 offset:5120
  v_mfma_f32_16x16x32_bf16 v[44:47], a[40:43], v[104:107], v[44:47]
  ds_read_b128 v[100:103], v112 offset:21504
  v_mfma_f32_16x16x32_bf16 v[48:51], a[44:47], v[104:107], v[48:51]
  v_permlane16_swap_b32 v73, v85
  v_mfma_f32_16x16x32_bf16 v[52:55], a[36:39], v[108:111], v[52:55]
  buffer_load_dwordx4 v8, s[16:19], s63 offen offset:3072 sc1 lds
  v_mfma_f32_16x16x32_bf16 v[56:59], a[40:43], v[108:111], v[56:59]
  v_permlane16_swap_b32 v74, v86
  v_mfma_f32_16x16x32_bf16 v[60:63], a[44:47], v[108:111], v[60:63]
  s_waitcnt lgkmcnt(2)
  v_permlane16_swap_b32 v75, v87
  v_mfma_f32_16x16x32_bf16 v[40:43], a[48:51], v[88:91], v[40:43]
  ds_read_b128 v[104:107], v112 offset:6144
  v_mfma_f32_16x16x32_bf16 v[44:47], a[52:55], v[88:91], v[44:47]
  ds_read_b128 v[108:111], v112 offset:22528
  v_mfma_f32_16x16x32_bf16 v[48:51], a[56:59], v[88:91], v[48:51]
  v_permlane16_swap_b32 v114, v116
  v_mfma_f32_16x16x32_bf16 v[52:55], a[48:51], v[92:95], v[52:55]
  s_mov_b32 s15, 98304
  v_permlane16_swap_b32 v115, v117
  v_mfma_f32_16x16x32_bf16 v[56:59], a[52:55], v[92:95], v[56:59]
  buffer_store_dwordx4 v[114:117], v10, s[16:19], s15 offen sc1
  v_max_f32 v72, 0, v72
  v_mfma_f32_16x16x32_bf16 v[60:63], a[56:59], v[92:95], v[60:63]
  s_waitcnt lgkmcnt(2)
  v_max_f32 v73, 0, v73
  v_max_f32 v74, 0, v74
  v_mfma_f32_16x16x32_bf16 v[40:43], a[60:63], v[96:99], v[40:43]
  ds_read_b128 v[88:91], v112 offset:7168
  v_max_f32 v75, 0, v75
  v_mfma_f32_16x16x32_bf16 v[44:47], a[64:67], v[96:99], v[44:47]
  ds_read_b128 v[92:95], v112 offset:23552
  v_mul_f32 v72, v72, v84
  v_mfma_f32_16x16x32_bf16 v[48:51], a[68:71], v[96:99], v[48:51]
  v_mul_f32 v73, v73, v85
  v_mul_f32 v74, v74, v86
  v_mfma_f32_16x16x32_bf16 v[52:55], a[60:63], v[100:103], v[52:55]
  v_mul_f32 v75, v75, v87
  v_cvt_pk_bf16_f32 v118, v72, v73
  v_mfma_f32_16x16x32_bf16 v[56:59], a[64:67], v[100:103], v[56:59]
  v_cvt_pk_bf16_f32 v119, v74, v75
  v_mov_b32 v120, v118
  v_mfma_f32_16x16x32_bf16 v[60:63], a[68:71], v[100:103], v[60:63]
  v_mov_b32 v121, v119
  s_nop 0
  s_waitcnt lgkmcnt(2)
  v_mfma_f32_16x16x32_bf16 v[40:43], a[72:75], v[104:107], v[40:43]
  ds_read_b128 v[96:99], v112 offset:8192
  v_mfma_f32_16x16x32_bf16 v[44:47], a[76:79], v[104:107], v[44:47]
  ds_read_b128 v[100:103], v112 offset:24576
  v_mfma_f32_16x16x32_bf16 v[48:51], a[80:83], v[104:107], v[48:51]
  v_permlane32_swap_b32 v118, v120
  v_mfma_f32_16x16x32_bf16 v[52:55], a[72:75], v[108:111], v[52:55]
  v_permlane32_swap_b32 v119, v121
  v_mfma_f32_16x16x32_bf16 v[56:59], a[76:79], v[108:111], v[56:59]
  buffer_store_dwordx4 v[118:121], v11, s[16:19], s15 offen sc1
  v_mfma_f32_16x16x32_bf16 v[60:63], a[80:83], v[108:111], v[60:63]
  s_add_u32 s22, s23, 573696
  s_waitcnt lgkmcnt(2)
  v_mfma_f32_16x16x32_bf16 v[40:43], a[84:87], v[88:91], v[40:43]
  ds_read_b128 v[104:107], v112 offset:9216
  v_mfma_f32_16x16x32_bf16 v[44:47], a[88:91], v[88:91], v[44:47]
  ds_read_b128 v[108:111], v112 offset:25600
  v_mfma_f32_16x16x32_bf16 v[48:51], a[92:95], v[88:91], v[48:51]
  v_mfma_f32_16x16x32_bf16 v[52:55], a[84:87], v[92:95], v[52:55]
  v_mfma_f32_16x16x32_bf16 v[56:59], a[88:91], v[92:95], v[56:59]
  v_mfma_f32_16x16x32_bf16 v[60:63], a[92:95], v[92:95], v[60:63]
  s_waitcnt lgkmcnt(2)
  v_mfma_f32_16x16x32_bf16 v[40:43], a[96:99], v[96:99], v[40:43]
  s_waitcnt vmcnt(5)
  v_cmp_ne_u32 vcc, s13, v123
  s_cbranch_vccnz LS_hfr_56
LS_hfb_58:
  ds_read_b128 v[88:91], v112 offset:10240
  v_mfma_f32_16x16x32_bf16 v[44:47], a[100:103], v[96:99], v[44:47]
  s_add_u32 m0, s54, 32768
  s_add_u32 s63, s52, 0
  ds_read_b128 v[92:95], v112 offset:26624
  v_mfma_f32_16x16x32_bf16 v[48:51], a[104:107], v[96:99], v[48:51]
  buffer_load_dwordx4 v9, s[16:19], s63 offen offset:0 sc1 lds
  v_mfma_f32_16x16x32_bf16 v[52:55], a[96:99], v[100:103], v[52:55]
  v_mfma_f32_16x16x32_bf16 v[56:59], a[100:103], v[100:103], v[56:59]
  buffer_load_dwordx4 v9, s[16:19], s63 offen offset:1024 sc1 lds
  v_mfma_f32_16x16x32_bf16 v[60:63], a[104:107], v[100:103], v[60:63]
  s_waitcnt lgkmcnt(2)
  v_mfma_f32_16x16x32_bf16 v[40:43], a[108:111], v[104:107], v[40:43]
  ds_read_b128 v[96:99], v112 offset:11264
  v_mfma_f32_16x16x32_bf16 v[44:47], a[112:115], v[104:107], v[44:47]
  ds_read_b128 v[100:103], v112 offset:27648
  v_mfma_f32_16x16x32_bf16 v[48:51], a[116:119], v[104:107], v[48:51]
  v_mfma_f32_16x16x32_bf16 v[52:55], a[108:111], v[108:111], v[52:55]
  buffer_load_dwordx4 v9, s[16:19], s63 offen offset:2048 sc1 lds
  v_mfma_f32_16x16x32_bf16 v[56:59], a[112:115], v[108:111], v[56:59]
  v_mfma_f32_16x16x32_bf16 v[60:63], a[116:119], v[108:111], v[60:63]
  s_waitcnt lgkmcnt(2)
  v_mfma_f32_16x16x32_bf16 v[40:43], a[120:123], v[88:91], v[40:43]
  ds_read_b128 v[104:107], v112 offset:12288
  v_mfma_f32_16x16x32_bf16 v[44:47], a[124:127], v[88:91], v[44:47]
  buffer_load_dwordx4 v9, s[16:19], s63 offen offset:3072 sc1 lds
  s_add_u32 m0, s54, 131072
  ds_read_b128 v[108:111], v112 offset:28672
  v_mfma_f32_16x16x32_bf16 v[48:51], a[128:131], v[88:91], v[48:51]
  s_add_u32 s63, s52, 8192
  v_mfma_f32_16x16x32_bf16 v[52:55], a[120:123], v[92:95], v[52:55]
  v_mfma_f32_16x16x32_bf16 v[56:59], a[124:127], v[92:95], v[56:59]
  v_mfma_f32_16x16x32_bf16 v[60:63], a[128:131], v[92:95], v[60:63]
  s_waitcnt lgkmcnt(2)
  v_mfma_f32_16x16x32_bf16 v[40:43], a[132:135], v[96:99], v[40:43]
  buffer_load_dwordx4 v9, s[16:19], s63 offen offset:0 sc1 lds
  ds_read_b128 v[88:91], v112 offset:13312
  v_mfma_f32_16x16x32_bf16 v[44:47], a[136:139], v[96:99], v[44:47]
  ds_read_b128 v[92:95], v112 offset:29696
  v_mfma_f32_16x16x32_bf16 v[48:51], a[140:143], v[96:99], v[48:51]
  v_mfma_f32_16x16x32_bf16 v[52:55], a[132:135], v[100:103], v[52:55]
  v_mfma_f32_16x16x32_bf16 v[56:59], a[136:139], v[100:103], v[56:59]
  v_mfma_f32_16x16x32_bf16 v[60:63], a[140:143], v[100:103], v[60:63]
  s_waitcnt lgkmcnt(2)
  buffer_load_dwordx4 v9, s[16:19], s63 offen offset:1024 sc1 lds
  v_mfma_f32_16x16x32_bf16 v[40:43], a[144:147], v[104:107], v[40:43]
  ds_read_b128 v[96:99], v112 offset:14336
  v_mfma_f32_16x16x32_bf16 v[44:47], a[148:151], v[104:107], v[44:47]
  ds_read_b128 v[100:103], v112 offset:30720
  v_mfma_f32_16x16x32_bf16 v[48:51], a[152:155], v[104:107], v[48:51]
  v_mfma_f32_16x16x32_bf16 v[52:55], a[144:147], v[108:111], v[52:55]
  v_mfma_f32_16x16x32_bf16 v[56:59], a[148:151], v[108:111], v[56:59]
  buffer_load_dwordx4 v9, s[16:19], s63 offen offset:2048 sc1 lds
  v_mfma_f32_16x16x32_bf16 v[60:63], a[152:155], v[108:111], v[60:63]
  s_waitcnt lgkmcnt(2)
  v_mfma_f32_16x16x32_bf16 v[40:43], a[156:159], v[88:91], v[40:43]
  ds_read_b128 v[104:107], v112 offset:15360
  v_mfma_f32_16x16x32_bf16 v[44:47], a[160:163], v[88:91], v[44:47]
  ds_read_b128 v[108:111], v112 offset:31744
  v_mfma_f32_16x16x32_bf16 v[48:51], a[164:167], v[88:91], v[48:51]
  v_mfma_f32_16x16x32_bf16 v[52:55], a[156:159], v[92:95], v[52:55]
  buffer_load_dwordx4 v9, s[16:19], s63 offen offset:3072 sc1 lds
  s_add_u32 m0, s55, 0
  s_add_u32 s63, s53, 16384
  v_mfma_f32_16x16x32_bf16 v[56:59], a[160:163], v[92:95], v[56:59]
  v_mfma_f32_16x16x32_bf16 v[60:63], a[164:167], v[92:95], v[60:63]
  s_waitcnt lgkmcnt(2)
  v_mfma_f32_16x16x32_bf16 v[40:43], a[168:171], v[96:99], v[40:43]
  s_waitcnt vmcnt(10)
  v_add_u32 v112, 65536, v1
  s_barrier
  ds_read_b128 v[88:91], v112 offset:32768
  v_mfma_f32_16x16x32_bf16 v[44:47], a[172:175], v[96:99], v[44:47]
  buffer_load_dwordx4 v9, s[16:19], s63 offen offset:0 sc1 lds
  ds_read_b128 v[92:95], v112 offset:49152
  v_mfma_f32_16x16x32_bf16 v[48:51], a[176:179], v[96:99], v[48:51]
  v_mfma_f32_16x16x32_bf16 v[52:55], a[168:171], v[100:103], v[52:55]
  v_mfma_f32_16x16x32_bf16 v[56:59], a[172:175], v[100:103], v[56:59]
  buffer_load_dwordx4 v9, s[16:19], s63 offen offset:1024 sc1 lds
  v_mfma_f32_16x16x32_bf16 v[60:63], a[176:179], v[100:103], v[60:63]
  s_waitcnt lgkmcnt(2)
  v_mfma_f32_16x16x32_bf16 v[40:43], a[180:183], v[104:107], v[40:43]
  ds_read_b128 v[96:99], v112 offset:33792
  v_mfma_f32_16x16x32_bf16 v[44:47], a[184:187], v[104:107], v[44:47]
  ds_read_b128 v[100:103], v112 offset:50176
  v_mfma_f32_16x16x32_bf16 v[48:51], a[188:191], v[104:107], v[48:51]
  v_mfma_f32_16x16x32_bf16 v[52:55], a[180:183], v[108:111], v[52:55]
  buffer_load_dwordx4 v9, s[16:19], s63 offen offset:2048 sc1 lds
  v_mfma_f32_16x16x32_bf16 v[56:59], a[184:187], v[108:111], v[56:59]
  v_mfma_f32_16x16x32_bf16 v[60:63], a[188:191], v[108:111], v[60:63]
  s_waitcnt vmcnt(11)
  s_waitcnt lgkmcnt(2)
  buffer_store_dword v14, v2, s[16:19], s22 offen sc1
  v_mfma_f32_16x16x32_bf16 v[64:67], a[0:3], v[88:91], 0
  ds_read_b128 v[104:107], v112 offset:34816
  v_mfma_f32_16x16x32_bf16 v[68:71], a[4:7], v[88:91], 0
  ds_read_b128 v[108:111], v112 offset:51200
  v_max_f32 v40, 0, v40
  v_mfma_f32_16x16x32_bf16 v[72:75], a[8:11], v[88:91], 0
  v_max_f32 v41, 0, v41
  v_max_f32 v42, 0, v42
  v_mfma_f32_16x16x32_bf16 v[76:79], a[0:3], v[92:95], 0
  v_max_f32 v43, 0, v43
  v_mul_f32 v40, v40, v44
  v_mfma_f32_16x16x32_bf16 v[80:83], a[4:7], v[92:95], 0
  v_mul_f32 v41, v41, v45
  v_mul_f32 v42, v42, v46
  v_mfma_f32_16x16x32_bf16 v[84:87], a[8:11], v[92:95], 0
  s_waitcnt lgkmcnt(2)
  v_mul_f32 v43, v43, v47
  v_cvt_pk_bf16_f32 v114, v40, v41
  v_mfma_f32_16x16x32_bf16 v[64:67], a[12:15], v[96:99], v[64:67]
  ds_read_b128 v[88:91], v112 offset:35840
  v_cvt_pk_bf16_f32 v115, v42, v43
  v_mfma_f32_16x16x32_bf16 v[68:71], a[16:19], v[96:99], v[68:71]
  ds_read_b128 v[92:95], v112 offset:52224
  v_max_f32 v52, 0, v52
  v_mfma_f32_16x16x32_bf16 v[72:75], a[20:23], v[96:99], v[72:75]
  v_max_f32 v53, 0, v53
  v_max_f32 v54, 0, v54
  v_mfma_f32_16x16x32_bf16 v[76:79], a[12:15], v[100:103], v[76:79]
  v_max_f32 v55, 0, v55
  v_mul_f32 v52, v52, v56
  v_mfma_f32_16x16x32_bf16 v[80:83], a[16:19], v[100:103], v[80:83]
  v_mul_f32 v53, v53, v57
  v_mul_f32 v54, v54, v58
  v_mfma_f32_16x16x32_bf16 v[84:87], a[20:23], v[100:103], v[84:87]
  s_waitcnt lgkmcnt(2)
  v_mul_f32 v55, v55, v59
  v_cvt_pk_bf16_f32 v116, v52, v53
  v_mfma_f32_16x16x32_bf16 v[64:67], a[24:27], v[104:107], v[64:67]
  ds_read_b128 v[96:99], v112 offset:36864
  v_cvt_pk_bf16_f32 v117, v54, v55
  v_mfma_f32_16x16x32_bf16 v[68:71], a[28:31], v[104:107], v[68:71]
  ds_read_b128 v[100:103], v112 offset:53248
  v_mfma_f32_16x16x32_bf16 v[72:75], a[32:35], v[104:107], v[72:75]
  v_permlane16_swap_b32 v48, v60
  v_mfma_f32_16x16x32_bf16 v[76:79], a[24:27], v[108:111], v[76:79]
  v_permlane16_swap_b32 v49, v61
  v_mfma_f32_16x16x32_bf16 v[80:83], a[28:31], v[108:111], v[80:83]
  v_permlane16_swap_b32 v50, v62
  v_mfma_f32_16x16x32_bf16 v[84:87], a[32:35], v[108:111], v[84:87]
  s_lshl_b32 s20, s69, 1
  s_add_u32 s20, s20, 573696
  s_waitcnt lgkmcnt(2)
  buffer_load_dword v123, v13, s[16:19], s20 offen sc1
  v_mfma_f32_16x16x32_bf16 v[64:67], a[36:39], v[88:91], v[64:67]
  ds_read_b128 v[104:107], v112 offset:37888
  v_mfma_f32_16x16x32_bf16 v[68:71], a[40:43], v[88:91], v[68:71]
  ds_read_b128 v[108:111], v112 offset:54272
  v_mfma_f32_16x16x32_bf16 v[72:75], a[44:47], v[88:91], v[72:75]
  v_permlane16_swap_b32 v51, v63
  v_mfma_f32_16x16x32_bf16 v[76:79], a[36:39], v[92:95], v[76:79]
  v_permlane16_swap_b32 v114, v116
  v_mfma_f32_16x16x32_bf16 v[80:83], a[40:43], v[92:95], v[80:83]
  s_mov_b32 s15, 196608
  v_permlane16_swap_b32 v115, v117
  v_mfma_f32_16x16x32_bf16 v[84:87], a[44:47], v[92:95], v[84:87]
  s_waitcnt lgkmcnt(2)
  buffer_store_dwordx4 v[114:117], v10, s[16:19], s15 offen sc1
  v_max_f32 v48, 0, v48
  v_mfma_f32_16x16x32_bf16 v[64:67], a[48:51], v[96:99], v[64:67]
  ds_read_b128 v[88:91], v112 offset:38912
  v_max_f32 v49, 0, v49
  v_mfma_f32_16x16x32_bf16 v[68:71], a[52:55], v[96:99], v[68:71]
  ds_read_b128 v[92:95], v112 offset:55296
  v_max_f32 v50, 0, v50
  v_mfma_f32_16x16x32_bf16 v[72:75], a[56:59], v[96:99], v[72:75]
  v_max_f32 v51, 0, v51
  v_mul_f32 v48, v48, v60
  v_mfma_f32_16x16x32_bf16 v[76:79], a[48:51], v[100:103], v[76:79]
  v_mul_f32 v49, v49, v61
  v_mul_f32 v50, v50, v62
  v_mfma_f32_16x16x32_bf16 v[80:83], a[52:55], v[100:103], v[80:83]
  v_mul_f32 v51, v51, v63
  v_cvt_pk_bf16_f32 v118, v48, v49
  v_mfma_f32_16x16x32_bf16 v[84:87], a[56:59], v[100:103], v[84:87]
  s_waitcnt lgkmcnt(2)
  v_cvt_pk_bf16_f32 v119, v50, v51
  v_mov_b32 v120, v118
  v_mfma_f32_16x16x32_bf16 v[64:67], a[60:63], v[104:107], v[64:67]
  v_mov_b32 v121, v119
  s_nop 0
  ds_read_b128 v[96:99], v112 offset:39936
  v_mfma_f32_16x16x32_bf16 v[68:71], a[64:67], v[104:107], v[68:71]
  ds_read_b128 v[100:103], v112 offset:56320
  v_mfma_f32_16x16x32_bf16 v[72:75], a[68:71], v[104:107], v[72:75]
  v_permlane32_swap_b32 v118, v120
  v_mfma_f32_16x16x32_bf16 v[76:79], a[60:63], v[108:111], v[76:79]
  v_permlane32_swap_b32 v119, v121
  v_mfma_f32_16x16x32_bf16 v[80:83], a[64:67], v[108:111], v[80:83]
  s_add_u32 s24, s73, 131072
  buffer_store_dwordx4 v[118:121], v11, s[16:19], s15 offen sc1
  buffer_load_dwordx4 v[140:143], v7, s[16:19], s24 offen sc1
  v_mfma_f32_16x16x32_bf16 v[84:87], a[68:71], v[108:111], v[84:87]
  s_add_u32 s22, s23, 573952
  s_waitcnt lgkmcnt(2)
  v_mfma_f32_16x16x32_bf16 v[64:67], a[72:75], v[88:91], v[64:67]
  ds_read_b128 v[104:107], v112 offset:40960
  v_mfma_f32_16x16x32_bf16 v[68:71], a[76:79], v[88:91], v[68:71]
  ds_read_b128 v[108:111], v112 offset:57344
  v_mfma_f32_16x16x32_bf16 v[72:75], a[80:83], v[88:91], v[72:75]
  v_mfma_f32_16x16x32_bf16 v[76:79], a[72:75], v[92:95], v[76:79]
  v_mfma_f32_16x16x32_bf16 v[80:83], a[76:79], v[92:95], v[80:83]
  v_mfma_f32_16x16x32_bf16 v[84:87], a[80:83], v[92:95], v[84:87]
  s_waitcnt lgkmcnt(2)
  v_mfma_f32_16x16x32_bf16 v[64:67], a[84:87], v[96:99], v[64:67]
  ds_read_b128 v[88:91], v112 offset:41984
  v_mfma_f32_16x16x32_bf16 v[68:71], a[88:91], v[96:99], v[68:71]
  ds_read_b128 v[92:95], v112 offset:58368
  v_mfma_f32_16x16x32_bf16 v[72:75], a[92:95], v[96:99], v[72:75]
  v_mfma_f32_16x16x32_bf16 v[76:79], a[84:87], v[100:103], v[76:79]
  v_mfma_f32_16x16x32_bf16 v[80:83], a[88:91], v[100:103], v[80:83]
  v_mfma_f32_16x16x32_bf16 v[84:87], a[92:95], v[100:103], v[84:87]
  s_waitcnt lgkmcnt(2)
  v_mfma_f32_16x16x32_bf16 v[64:67], a[96:99], v[104:107], v[64:67]
  ds_read_b128 v[96:99], v112 offset:43008
  v_mfma_f32_16x16x32_bf16 v[68:71], a[100:103], v[104:107], v[68:71]
  ds_read_b128 v[100:103], v112 offset:59392
  v_mfma_f32_16x16x32_bf16 v[72:75], a[104:107], v[104:107], v[72:75]
  v_mfma_f32_16x16x32_bf16 v[76:79], a[96:99], v[108:111], v[76:79]
  v_mfma_f32_16x16x32_bf16 v[80:83], a[100:103], v[108:111], v[80:83]
  v_mfma_f32_16x16x32_bf16 v[84:87], a[104:107], v[108:111], v[84:87]
  s_waitcnt lgkmcnt(2)
  v_mfma_f32_16x16x32_bf16 v[64:67], a[108:111], v[88:91], v[64:67]
  ds_read_b128 v[104:107], v112 offset:44032
  v_mfma_f32_16x16x32_bf16 v[68:71], a[112:115], v[88:91], v[68:71]
  ds_read_b128 v[108:111], v112 offset:60416
  v_mfma_f32_16x16x32_bf16 v[72:75], a[116:119], v[88:91], v[72:75]
  v_mfma_f32_16x16x32_bf16 v[76:79], a[108:111], v[92:95], v[76:79]
  v_mfma_f32_16x16x32_bf16 v[80:83], a[112:115], v[92:95], v[80:83]
  v_mfma_f32_16x16x32_bf16 v[84:87], a[116:119], v[92:95], v[84:87]
  s_waitcnt lgkmcnt(2)
  s_waitcnt vmcnt(3)
  v_cmp_ne_u32 vcc, s13, v123
  s_cbranch_vccnz LS_hfr_59
LS_hfb_61:
  s_add_u32 m0, s54, 40960
  s_add_u32 s63, s52, 98304
  buffer_load_dwordx4 v9, s[16:19], s63 offen offset:0 sc1 lds
  buffer_load_dwordx4 v9, s[16:19], s63 offen offset:1024 sc1 lds
  buffer_load_dwordx4 v9, s[16:19], s63 offen offset:2048 sc1 lds
  buffer_load_dwordx4 v9, s[16:19], s63 offen offset:3072 sc1 lds
  v_mfma_f32_16x16x32_bf16 v[64:67], a[120:123], v[96:99], v[64:67]
  s_add_u32 m0, s54, 139264
  s_add_u32 s63, s52, 106496
  ds_read_b128 v[88:91], v112 offset:45056
  v_mfma_f32_16x16x32_bf16 v[68:71], a[124:127], v[96:99], v[68:71]
  ds_read_b128 v[92:95], v112 offset:61440
  v_mfma_f32_16x16x32_bf16 v[72:75], a[128:131], v[96:99], v[72:75]
  v_mfma_f32_16x16x32_bf16 v[76:79], a[120:123], v[100:103], v[76:79]
  v_mfma_f32_16x16x32_bf16 v[80:83], a[124:127], v[100:103], v[80:83]
  v_mfma_f32_16x16x32_bf16 v[84:87], a[128:131], v[100:103], v[84:87]
  s_waitcnt lgkmcnt(2)
  v_mfma_f32_16x16x32_bf16 v[64:67], a[132:135], v[104:107], v[64:67]
  ds_read_b128 v[96:99], v112 offset:46080
  v_mfma_f32_16x16x32_bf16 v[68:71], a[136:139], v[104:107], v[68:71]
  ds_read_b128 v[100:103], v112 offset:62464
  v_mfma_f32_16x16x32_bf16 v[72:75], a[140:143], v[104:107], v[72:75]
  v_mfma_f32_16x16x32_bf16 v[76:79], a[132:135], v[108:111], v[76:79]
  v_mfma_f32_16x16x32_bf16 v[80:83], a[136:139], v[108:111], v[80:83]
  v_mfma_f32_16x16x32_bf16 v[84:87], a[140:143], v[108:111], v[84:87]
  s_waitcnt lgkmcnt(2)
  v_mfma_f32_16x16x32_bf16 v[64:67], a[144:147], v[88:91], v[64:67]
  ds_read_b128 v[104:107], v112 offset:47104
  v_mfma_f32_16x16x32_bf16 v[68:71], a[148:151], v[88:91], v[68:71]
  ds_read_b128 v[108:111], v112 offset:63488
  v_mfma_f32_16x16x32_bf16 v[72:75], a[152:155], v[88:91], v[72:75]
  v_mfma_f32_16x16x32_bf16 v[76:79], a[144:147], v[92:95], v[76:79]
  buffer_load_dwordx4 v9, s[16:19], s63 offen offset:0 sc1 lds
  v_mfma_f32_16x16x32_bf16 v[80:83], a[148:151], v[92:95], v[80:83]
  v_mfma_f32_16x16x32_bf16 v[84:87], a[152:155], v[92:95], v[84:87]
  s_waitcnt lgkmcnt(2)
  v_mfma_f32_16x16x32_bf16 v[64:67], a[156:159], v[96:99], v[64:67]
  ds_read_b128 v[88:91], v112 offset:48128
  v_mfma_f32_16x16x32_bf16 v[68:71], a[160:163], v[96:99], v[68:71]
  ds_read_b128 v[92:95], v112 offset:64512
  v_mfma_f32_16x16x32_bf16 v[72:75], a[164:167], v[96:99], v[72:75]
  buffer_load_dwordx4 v9, s[16:19], s63 offen offset:1024 sc1 lds
  v_mfma_f32_16x16x32_bf16 v[76:79], a[156:159], v[100:103], v[76:79]
  v_mfma_f32_16x16x32_bf16 v[80:83], a[160:163], v[100:103], v[80:83]
  v_mfma_f32_16x16x32_bf16 v[84:87], a[164:167], v[100:103], v[84:87]
  s_waitcnt lgkmcnt(2)
  v_mfma_f32_16x16x32_bf16 v[64:67], a[168:171], v[104:107], v[64:67]
  s_add_u32 s25, s66, 0
  v_add_u32 v112, s25, v1
  s_add_u32 s25, s67, 0
  v_add_u32 v113, s25, v1
  s_waitcnt vmcnt(2)
  s_barrier
  ds_read_b128 v[56:59], v113 offset:32768
  v_mfma_f32_16x16x32_bf16 v[68:71], a[172:175], v[104:107], v[68:71]
  buffer_store_dword v14, v2, s[16:19], s22 offen sc1
  ds_read_b128 v[60:63], v112 offset:32768
  v_mfma_f32_16x16x32_bf16 v[72:75], a[176:179], v[104:107], v[72:75]
  buffer_load_dwordx4 v9, s[16:19], s63 offen offset:2048 sc1 lds
  v_mfma_f32_16x16x32_bf16 v[76:79], a[168:171], v[108:111], v[76:79]
  v_mfma_f32_16x16x32_bf16 v[80:83], a[172:175], v[108:111], v[80:83]
  buffer_load_dwordx4 v9, s[16:19], s63 offen offset:3072 sc1 lds
  s_add_u32 m0, s55, 8192
  ds_read_b128 v[96:99], v113 offset:33792
  v_mfma_f32_16x16x32_bf16 v[84:87], a[176:179], v[108:111], v[84:87]
  s_add_u32 s63, s53, 114688
  s_waitcnt lgkmcnt(3)
  ds_read_b128 v[100:103], v112 offset:33792
  v_mfma_f32_16x16x32_bf16 v[64:67], a[180:183], v[88:91], v[64:67]
  v_mfma_f32_16x16x32_bf16 v[68:71], a[184:187], v[88:91], v[68:71]
  v_mfma_f32_16x16x32_bf16 v[72:75], a[188:191], v[88:91], v[72:75]
  ds_read_b128 v[104:107], v113 offset:34816
  v_mfma_f32_16x16x32_bf16 v[76:79], a[180:183], v[92:95], v[76:79]
  buffer_load_dwordx4 v9, s[16:19], s63 offen offset:0 sc1 lds
  ds_read_b128 v[108:111], v112 offset:34816
  v_mfma_f32_16x16x32_bf16 v[80:83], a[184:187], v[92:95], v[80:83]
  v_mfma_f32_16x16x32_bf16 v[84:87], a[188:191], v[92:95], v[84:87]
  s_waitcnt lgkmcnt(4)
  v_mfma_f32_16x16x32_bf16 v[48:51], v[144:147], v[56:59], 0
  ds_read_b128 v[88:91], v113 offset:35840
  v_max_f32 v64, 0, v64
  v_max_f32 v65, 0, v65
  v_max_f32 v66, 0, v66
  v_max_f32 v67, 0, v67
  v_mfma_f32_16x16x32_bf16 v[52:55], v[148:151], v[56:59], 0
  buffer_load_dwordx4 v9, s[16:19], s63 offen offset:1024 sc1 lds
  ds_read_b128 v[92:95], v112 offset:35840
  v_mul_f32 v64, v64, v68
  v_mul_f32 v65, v65, v69
  v_mul_f32 v66, v66, v70
  v_mfma_f32_16x16x32_bf16 v[40:43], v[144:147], v[60:63], 0
  v_mul_f32 v67, v67, v71
  v_cvt_pk_bf16_f32 v114, v64, v65
  v_cvt_pk_bf16_f32 v115, v66, v67
  v_max_f32 v76, 0, v76
  v_max_f32 v77, 0, v77
  v_mfma_f32_16x16x32_bf16 v[44:47], v[148:151], v[60:63], 0
  s_waitcnt lgkmcnt(4)
  v_max_f32 v78, 0, v78
  v_max_f32 v79, 0, v79
  v_mul_f32 v76, v76, v80
  v_mul_f32 v77, v77, v81
  v_mul_f32 v78, v78, v82
  v_mfma_f32_16x16x32_bf16 v[48:51], v[152:155], v[96:99], v[48:51]
  buffer_load_dwordx4 v9, s[16:19], s63 offen offset:2048 sc1 lds
  ds_read_b128 v[56:59], v113 offset:36864
  v_mul_f32 v79, v79, v83
  v_cvt_pk_bf16_f32 v116, v76, v77
  v_cvt_pk_bf16_f32 v117, v78, v79
  v_mfma_f32_16x16x32_bf16 v[52:55], v[156:159], v[96:99], v[52:55]
  ds_read_b128 v[60:63], v112 offset:36864
  v_permlane16_swap_b32 v72, v84
  v_permlane16_swap_b32 v73, v85
  v_mfma_f32_16x16x32_bf16 v[40:43], v[152:155], v[100:103], v[40:43]
  v_permlane16_swap_b32 v74, v86
  v_permlane16_swap_b32 v75, v87
  v_mfma_f32_16x16x32_bf16 v[44:47], v[156:159], v[100:103], v[44:47]
  s_lshl_b32 s20, s69, 1
  s_add_u32 s20, s20, 573952
  s_waitcnt lgkmcnt(4)
  buffer_load_dword v123, v13, s[16:19], s20 offen sc1
  v_permlane16_swap_b32 v114, v116
  v_mfma_f32_16x16x32_bf16 v[48:51], v[160:163], v[104:107], v[48:51]
  s_mov_b32 s15, 0
  v_permlane16_swap_b32 v115, v117
  buffer_store_dwordx4 v[114:117], v136, s[16:19], s15 offen sc1
  ds_read_b128 v[96:99], v113 offset:37888
  v_max_f32 v72, 0, v72
  v_mfma_f32_16x16x32_bf16 v[52:55], v[164:167], v[104:107], v[52:55]
  ds_read_b128 v[100:103], v112 offset:37888
  v_max_f32 v73, 0, v73
  v_max_f32 v74, 0, v74
  v_max_f32 v75, 0, v75
  v_mul_f32 v72, v72, v84
  v_mfma_f32_16x16x32_bf16 v[40:43], v[160:163], v[108:111], v[40:43]
  v_mul_f32 v73, v73, v85
  v_mul_f32 v74, v74, v86
  v_mul_f32 v75, v75, v87
  v_cvt_pk_bf16_f32 v118, v72, v73
  v_cvt_pk_bf16_f32 v119, v74, v75
  v_mfma_f32_16x16x32_bf16 v[44:47], v[164:167], v[108:111], v[44:47]
  v_mov_b32 v120, v118
  v_mov_b32 v121, v119
  s_nop 0
  s_waitcnt lgkmcnt(4)
  v_permlane32_swap_b32 v118, v120
  v_mfma_f32_16x16x32_bf16 v[48:51], v[168:171], v[88:91], v[48:51]
  v_permlane32_swap_b32 v119, v121
  buffer_store_dwordx4 v[118:121], v138, s[16:19], s15 offen sc1
  ds_read_b128 v[104:107], v113 offset:38912
  v_max3_u32 v124, v140, v141, v142
  v_mfma_f32_16x16x32_bf16 v[52:55], v[172:175], v[88:91], v[52:55]
  s_add_u32 s22, s23, 574208
  ds_read_b128 v[108:111], v112 offset:38912
  v_max_u32 v124, v124, v143
  v_mfma_f32_16x16x32_bf16 v[40:43], v[168:171], v[92:95], v[40:43]
  v_cmp_eq_u32 vcc, -1, v124
  s_cbranch_vccnz LS_s5r_50
LS_s5b_52:
  v_mfma_f32_16x16x32_bf16 v[44:47], v[172:175], v[92:95], v[44:47]
  s_waitcnt lgkmcnt(4)
  v_add_f32 v140, v140, v141
  v_add_f32 v142, v142, v143
  v_mfma_f32_16x16x32_bf16 v[48:51], v[176:179], v[56:59], v[48:51]
  ds_read_b128 v[88:91], v113 offset:39936
  v_add_f32 v140, v140, v142
  v_mfma_f32_16x16x32_bf16 v[52:55], v[180:183], v[56:59], v[52:55]
  v_mov_b32 v141, v140
  s_nop 0
  ds_read_b128 v[92:95], v112 offset:39936
  v_mfma_f32_16x16x32_bf16 v[40:43], v[176:179], v[60:63], v[40:43]
  v_permlane32_swap_b32 v140, v141
  v_mfma_f32_16x16x32_bf16 v[44:47], v[180:183], v[60:63], v[44:47]
  s_waitcnt lgkmcnt(4)
  v_add_f32 v140, v140, v141
  v_mov_b32 v141, v140
  v_mfma_f32_16x16x32_bf16 v[48:51], v[184:187], v[96:99], v[48:51]
  s_add_u32 s25, s66, 131072
  v_add_u32 v112, s25, v1
  s_add_u32 s25, s67, 131072
  v_add_u32 v113, s25, v1
  s_waitcnt vmcnt(6)
  s_barrier
  ds_read_b128 v[56:59], v113 offset:0
  v_mfma_f32_16x16x32_bf16 v[52:55], v[188:191], v[96:99], v[52:55]
  s_waitcnt vmcnt(2)
  v_cmp_ne_u32 vcc, s13, v123
  s_cbranch_vccnz LS_hfr_62
LS_hfb_64:
  ds_read_b128 v[60:63], v112 offset:0
  v_mfma_f32_16x16x32_bf16 v[40:43], v[184:187], v[100:103], v[40:43]
  s_add_u32 m0, s54, 65536
  s_add_u32 s63, s52, 196608
  buffer_load_dwordx4 v9, s[16:19], s63 offen offset:0 sc1 lds
  s_nop 0
  v_mfma_f32_16x16x32_bf16 v[44:47], v[188:191], v[100:103], v[44:47]
  s_waitcnt lgkmcnt(4)
  v_permlane16_swap_b32 v140, v141
  v_mfma_f32_16x16x32_bf16 v[48:51], v[192:195], v[104:107], v[48:51]
  buffer_load_dwordx4 v9, s[16:19], s63 offen offset:1024 sc1 lds
  ds_read_b128 v[96:99], v113 offset:1024
  v_mfma_f32_16x16x32_bf16 v[52:55], v[196:199], v[104:107], v[52:55]
  ds_read_b128 v[100:103], v112 offset:1024
  v_add_f32 v140, v140, v141
  v_mfma_f32_16x16x32_bf16 v[40:43], v[192:195], v[108:111], v[40:43]
  v_mul_f32 v140, 0x3b000000, v140
  v_add_f32 v140, 0x3727c5ac, v140
  v_mfma_f32_16x16x32_bf16 v[44:47], v[196:199], v[108:111], v[44:47]
  s_add_u32 s3, s65, 6144
  s_waitcnt lgkmcnt(4)
  v_rcp_f32 v15, v140
  v_mfma_f32_16x16x32_bf16 v[48:51], v[200:203], v[88:91], v[48:51]
  v_add_u32 v114, s3, v1
  s_xor_b32 s3, s65, 16384
  ds_read_b128 v[104:107], v113 offset:2048
  v_mfma_f32_16x16x32_bf16 v[52:55], v[204:207], v[88:91], v[52:55]
  s_add_u32 s3, s3, 6144
  buffer_load_dwordx4 v9, s[16:19], s63 offen offset:2048 sc1 lds
  ds_read_b128 v[108:111], v112 offset:2048
  v_mfma_f32_16x16x32_bf16 v[40:43], v[200:203], v[92:95], v[40:43]
  s_add_u32 s24, s73, 196608
  buffer_load_dwordx4 v[140:143], v7, s[16:19], s24 offen sc1
  v_add_u32 v115, s3, v1
  v_mfma_f32_16x16x32_bf16 v[44:47], v[204:207], v[92:95], v[44:47]
  s_waitcnt lgkmcnt(4)
  v_mfma_f32_16x16x32_bf16 v[48:51], v[208:211], v[56:59], v[48:51]
  ds_read_b128 v[88:91], v113 offset:3072
  v_mfma_f32_16x16x32_bf16 v[52:55], v[212:215], v[56:59], v[52:55]
  ds_read_b128 v[92:95], v112 offset:3072
  v_mfma_f32_16x16x32_bf16 v[40:43], v[208:211], v[60:63], v[40:43]
  v_mfma_f32_16x16x32_bf16 v[44:47], v[212:215], v[60:63], v[44:47]
  buffer_load_dwordx4 v9, s[16:19], s63 offen offset:3072 sc1 lds
  s_add_u32 m0, s54, 98304
  s_add_u32 s63, s52, 204800
  s_waitcnt lgkmcnt(4)
  v_mfma_f32_16x16x32_bf16 v[48:51], v[216:219], v[96:99], v[48:51]
  ds_read_b128 v[56:59], v113 offset:4096
  v_mfma_f32_16x16x32_bf16 v[52:55], v[220:223], v[96:99], v[52:55]
  ds_read_b128 v[60:63], v112 offset:4096
  v_mfma_f32_16x16x32_bf16 v[40:43], v[216:219], v[100:103], v[40:43]
  v_mfma_f32_16x16x32_bf16 v[44:47], v[220:223], v[100:103], v[44:47]
  s_waitcnt lgkmcnt(4)
  v_mfma_f32_16x16x32_bf16 v[48:51], v[224:227], v[104:107], v[48:51]
  buffer_load_dwordx4 v9, s[16:19], s63 offen offset:0 sc1 lds
  ds_read_b128 v[96:99], v113 offset:5120
  v_mfma_f32_16x16x32_bf16 v[52:55], v[228:231], v[104:107], v[52:55]
  ds_read_b128 v[100:103], v112 offset:5120
  v_mfma_f32_16x16x32_bf16 v[40:43], v[224:227], v[108:111], v[40:43]
  v_mfma_f32_16x16x32_bf16 v[44:47], v[228:231], v[108:111], v[44:47]
  s_waitcnt lgkmcnt(4)
  v_mfma_f32_16x16x32_bf16 v[48:51], v[232:235], v[88:91], v[48:51]
  buffer_load_dwordx4 v9, s[16:19], s63 offen offset:1024 sc1 lds
  ds_read_b128 v[104:107], v113 offset:6144
  v_mfma_f32_16x16x32_bf16 v[52:55], v[236:239], v[88:91], v[52:55]
  ds_read_b128 v[108:111], v112 offset:6144
  v_mfma_f32_16x16x32_bf16 v[40:43], v[232:235], v[92:95], v[40:43]
  v_mfma_f32_16x16x32_bf16 v[44:47], v[236:239], v[92:95], v[44:47]
  s_waitcnt lgkmcnt(4)
  v_mfma_f32_16x16x32_bf16 v[48:51], v[240:243], v[56:59], v[48:51]
  ds_read_b128 v[88:91], v113 offset:7168
  v_mfma_f32_16x16x32_bf16 v[52:55], v[244:247], v[56:59], v[52:55]
  s_waitcnt vmcnt(7)
  buffer_store_dword v14, v2, s[16:19], s22 offen sc1
  ds_read_b128 v[92:95], v112 offset:7168
  v_mfma_f32_16x16x32_bf16 v[40:43], v[240:243], v[60:63], v[40:43]
  buffer_load_dwordx4 v9, s[16:19], s63 offen offset:2048 sc1 lds
  v_mfma_f32_16x16x32_bf16 v[44:47], v[244:247], v[60:63], v[44:47]
  s_waitcnt lgkmcnt(4)
  v_mfma_f32_16x16x32_bf16 v[48:51], v[248:251], v[96:99], v[48:51]
  s_add_u32 s25, s66, 0
  v_add_u32 v112, s25, v1
  s_add_u32 s25, s67, 0
  v_add_u32 v113, s25, v1
  s_barrier
  ds_read_b128 v[56:59], v113 offset:0
  v_mfma_f32_16x16x32_bf16 v[52:55], v[252:255], v[96:99], v[52:55]
  buffer_load_dwordx4 v9, s[16:19], s63 offen offset:3072 sc1 lds
  s_add_u32 m0, s55, 32768
  ds_read_b128 v[60:63], v112 offset:0
  v_mfma_f32_16x16x32_bf16 v[40:43], v[248:251], v[100:103], v[40:43]
  s_add_u32 s63, s53, 212992
  v_mfma_f32_16x16x32_bf16 v[44:47], v[252:255], v[100:103], v[44:47]
  s_waitcnt lgkmcnt(4)
  v_mfma_f32_16x16x32_bf16 v[48:51], a[192:195], v[104:107], v[48:51]
  ds_read_b128 v[96:99], v113 offset:1024
  v_mfma_f32_16x16x32_bf16 v[52:55], a[196:199], v[104:107], v[52:55]
  buffer_load_dwordx4 v9, s[16:19], s63 offen offset:0 sc1 lds
  ds_read_b128 v[100:103], v112 offset:1024
  v_mfma_f32_16x16x32_bf16 v[40:43], a[192:195], v[108:111], v[40:43]
  v_mfma_f32_16x16x32_bf16 v[44:47], a[196:199], v[108:111], v[44:47]
  s_waitcnt lgkmcnt(4)
  v_mfma_f32_16x16x32_bf16 v[48:51], a[200:203], v[88:91], v[48:51]
  ds_read_b128 v[104:107], v113 offset:2048
  v_mfma_f32_16x16x32_bf16 v[52:55], a[204:207], v[88:91], v[52:55]
  buffer_load_dwordx4 v9, s[16:19], s63 offen offset:1024 sc1 lds
  ds_read_b128 v[108:111], v112 offset:2048
  v_mfma_f32_16x16x32_bf16 v[40:43], a[200:203], v[92:95], v[40:43]
  v_mfma_f32_16x16x32_bf16 v[44:47], a[204:207], v[92:95], v[44:47]
  s_waitcnt lgkmcnt(4)
  v_mfma_f32_16x16x32_bf16 v[48:51], a[208:211], v[56:59], v[48:51]
  ds_read_b128 v[88:91], v113 offset:3072
  v_mfma_f32_16x16x32_bf16 v[52:55], a[212:215], v[56:59], v[52:55]
  s_lshl_b32 s20, s69, 1
  s_add_u32 s20, s20, 574208
  ds_read_b128 v[92:95], v112 offset:3072
  v_mfma_f32_16x16x32_bf16 v[40:43], a[208:211], v[60:63], v[40:43]
  buffer_load_dword v123, v13, s[16:19], s20 offen sc1
  v_mfma_f32_16x16x32_bf16 v[44:47], a[212:215], v[60:63], v[44:47]
  s_waitcnt lgkmcnt(4)
  buffer_load_dwordx4 v9, s[16:19], s63 offen offset:2048 sc1 lds
  v_mfma_f32_16x16x32_bf16 v[48:51], a[216:219], v[96:99], v[48:51]
  ds_read_b128 v[56:59], v113 offset:4096
  v_mfma_f32_16x16x32_bf16 v[52:55], a[220:223], v[96:99], v[52:55]
  ds_read_b128 v[60:63], v112 offset:4096
  v_mfma_f32_16x16x32_bf16 v[40:43], a[216:219], v[100:103], v[40:43]
  v_mfma_f32_16x16x32_bf16 v[44:47], a[220:223], v[100:103], v[44:47]
  s_waitcnt lgkmcnt(4)
  v_mfma_f32_16x16x32_bf16 v[48:51], a[224:227], v[104:107], v[48:51]
  ds_read_b128 v[96:99], v113 offset:5120
  v_mfma_f32_16x16x32_bf16 v[52:55], a[228:231], v[104:107], v[52:55]
  ds_read_b128 v[100:103], v112 offset:5120
  v_mfma_f32_16x16x32_bf16 v[40:43], a[224:227], v[108:111], v[40:43]
  v_mfma_f32_16x16x32_bf16 v[44:47], a[228:231], v[108:111], v[44:47]
  s_waitcnt lgkmcnt(4)
  v_mfma_f32_16x16x32_bf16 v[48:51], a[232:235], v[88:91], v[48:51]
  s_lshl_b32 s25, s11, 14
  s_add_u32 s25, s25, 65536
  s_waitcnt vmcnt(4)
  v_add_u32 v112, s25, v1
  s_barrier
  ds_read_b128 v[104:107], v112 offset:0
  v_mfma_f32_16x16x32_bf16 v[52:55], a[236:239], v[88:91], v[52:55]
  s_waitcnt vmcnt(1)
  v_cmp_ne_u32 vcc, s13, v123
  s_cbranch_vccnz LS_hfr_65
LS_hfb_67:
  v_mfma_f32_16x16x32_bf16 v[40:43], a[232:235], v[92:95], v[40:43]
  s_add_u32 m0, s54, 73728
  s_add_u32 s63, s52, 0
  ds_read_b128 v[108:111], v112 offset:1024
  v_mfma_f32_16x16x32_bf16 v[44:47], a[236:239], v[92:95], v[44:47]
  s_waitcnt lgkmcnt(4)
  buffer_load_dwordx4 v135, s[16:19], s63 offen offset:0 sc1 lds
  v_mfma_f32_16x16x32_bf16 v[48:51], a[240:243], v[56:59], v[48:51]
  ds_read_b128 v[88:91], v112 offset:2048
  v_mfma_f32_16x16x32_bf16 v[52:55], a[244:247], v[56:59], v[52:55]
  buffer_load_dwordx4 v135, s[16:19], s63 offen offset:1024 sc1 lds
  v_mfma_f32_16x16x32_bf16 v[40:43], a[240:243], v[60:63], v[40:43]
  ds_read_b128 v[92:95], v112 offset:3072
  v_mfma_f32_16x16x32_bf16 v[44:47], a[244:247], v[60:63], v[44:47]
  s_waitcnt lgkmcnt(4)
  v_mfma_f32_16x16x32_bf16 v[48:51], a[248:251], v[96:99], v[48:51]
  ds_read_b128 v[56:59], v112 offset:4096
  v_mfma_f32_16x16x32_bf16 v[52:55], a[252:255], v[96:99], v[52:55]
  v_mfma_f32_16x16x32_bf16 v[40:43], a[248:251], v[100:103], v[40:43]
  buffer_load_dwordx4 v135, s[16:19], s63 offen offset:2048 sc1 lds
  ds_read_b128 v[60:63], v112 offset:5120
  v_mfma_f32_16x16x32_bf16 v[44:47], a[252:255], v[100:103], v[44:47]
  s_waitcnt lgkmcnt(5)
  v_mfma_f32_16x16x32_bf16 v[64:67], v[144:147], v[104:107], 0
  ds_write_b128 v114, v[48:51]
  ds_read_b128 v[96:99], v112 offset:6144
  v_mfma_f32_16x16x32_bf16 v[68:71], v[148:151], v[104:107], 0
  s_waitcnt lgkmcnt(6)
  ds_write_b128 v114, v[52:55] offset:1024
  v_fmac_f32 v16, v15, v40
  v_mfma_f32_16x16x32_bf16 v[64:67], v[152:155], v[108:111], v[64:67]
  buffer_load_dwordx4 v135, s[16:19], s63 offen offset:3072 sc1 lds
  s_add_u32 m0, s54, 106496
  ds_read_b128 v[100:103], v112 offset:7168
  v_mfma_f32_16x16x32_bf16 v[68:71], v[156:159], v[108:111], v[68:71]
  s_add_u32 s63, s52, 8192
  s_waitcnt lgkmcnt(7)
  v_fmac_f32 v17, v15, v41
  v_mfma_f32_16x16x32_bf16 v[64:67], v[160:163], v[88:91], v[64:67]
  ds_read_b128 v[104:107], v112 offset:32768
  v_fmac_f32 v18, v15, v42
  v_mfma_f32_16x16x32_bf16 v[68:71], v[164:167], v[88:91], v[68:71]
  s_waitcnt lgkmcnt(7)
  v_fmac_f32 v19, v15, v43
  v_fmac_f32 v20, v15, v44
  v_mfma_f32_16x16x32_bf16 v[64:67], v[168:171], v[92:95], v[64:67]
  ds_read_b128 v[108:111], v112 offset:33792
  v_fmac_f32 v21, v15, v45
  v_mfma_f32_16x16x32_bf16 v[68:71], v[172:175], v[92:95], v[68:71]
  s_waitcnt lgkmcnt(7)
  buffer_load_dwordx4 v135, s[16:19], s63 offen offset:0 sc1 lds
  v_fmac_f32 v22, v15, v46
  v_mfma_f32_16x16x32_bf16 v[64:67], v[176:179], v[56:59], v[64:67]
  ds_read_b128 v[88:91], v112 offset:34816
  v_fmac_f32 v23, v15, v47
  v_mfma_f32_16x16x32_bf16 v[68:71], v[180:183], v[56:59], v[68:71]
  s_waitcnt lgkmcnt(7)
  v_mfma_f32_16x16x32_bf16 v[64:67], v[184:187], v[60:63], v[64:67]
  s_waitcnt lgkmcnt(4)
  s_barrier
  ds_read_b128 v[92:95], v112 offset:35840
  v_mfma_f32_16x16x32_bf16 v[68:71], v[188:191], v[60:63], v[68:71]
  buffer_load_dwordx4 v135, s[16:19], s63 offen offset:1024 sc1 lds
  ds_read_b128 v[48:51], v115
  v_mfma_f32_16x16x32_bf16 v[64:67], v[192:195], v[96:99], v[64:67]
  ds_read_b128 v[52:55], v115 offset:1024
  ds_read_b128 v[56:59], v112 offset:36864
  v_mfma_f32_16x16x32_bf16 v[68:71], v[196:199], v[96:99], v[68:71]
  s_waitcnt lgkmcnt(7)
  v_mfma_f32_16x16x32_bf16 v[64:67], v[200:203], v[100:103], v[64:67]
  ds_read_b128 v[60:63], v112 offset:37888
  v_mfma_f32_16x16x32_bf16 v[68:71], v[204:207], v[100:103], v[68:71]
  s_waitcnt lgkmcnt(7)
  buffer_load_dwordx4 v135, s[16:19], s63 offen offset:2048 sc1 lds
  v_mfma_f32_16x16x32_bf16 v[64:67], v[208:211], v[104:107], v[64:67]
  ds_read_b128 v[96:99], v112 offset:38912
  s_waitcnt lgkmcnt(4)
  v_fmac_f32 v16, v15, v48
  v_mfma_f32_16x16x32_bf16 v[68:71], v[212:215], v[104:107], v[68:71]
  v_fmac_f32 v17, v15, v49
  v_fmac_f32 v18, v15, v50
  v_mfma_f32_16x16x32_bf16 v[64:67], v[216:219], v[108:111], v[64:67]
  ds_read_b128 v[100:103], v112 offset:39936
  v_fmac_f32 v19, v15, v51
  v_mfma_f32_16x16x32_bf16 v[68:71], v[220:223], v[108:111], v[68:71]
  s_waitcnt lgkmcnt(3)
  v_fmac_f32 v20, v15, v52
  v_fmac_f32 v21, v15, v53
  v_mfma_f32_16x16x32_bf16 v[64:67], v[224:227], v[88:91], v[64:67]
  s_lshl_b32 s25, s11, 14
  s_add_u32 s25, s25, 0
  s_waitcnt vmcnt(7)
  v_add_u32 v112, s25, v1
  s_barrier
  ds_read_b128 v[104:107], v112 offset:32768
  v_mfma_f32_16x16x32_bf16 v[68:71], v[228:231], v[88:91], v[68:71]
  buffer_load_dwordx4 v135, s[16:19], s63 offen offset:3072 sc1 lds
  s_add_u32 m0, s55, 40960
  s_add_u32 s63, s53, 16384
  v_mfma_f32_16x16x32_bf16 v[64:67], v[232:235], v[92:95], v[64:67]
  ds_read_b128 v[108:111], v112 offset:33792
  v_fmac_f32 v22, v15, v54
  v_mfma_f32_16x16x32_bf16 v[68:71], v[236:239], v[92:95], v[68:71]
  buffer_load_dwordx4 v135, s[16:19], s63 offen offset:0 sc1 lds
  v_fmac_f32 v23, v15, v55
  v_mfma_f32_16x16x32_bf16 v[64:67], v[240:243], v[56:59], v[64:67]
  ds_read_b128 v[88:91], v112 offset:34816
  v_cvt_pk_bf16_f32 v80, v16, v17
  v_mfma_f32_16x16x32_bf16 v[68:71], v[244:247], v[56:59], v[68:71]
  s_waitcnt lgkmcnt(5)
  v_cvt_pk_bf16_f32 v81, v18, v19
  v_cvt_pk_bf16_f32 v82, v20, v21
  v_mfma_f32_16x16x32_bf16 v[64:67], v[248:251], v[60:63], v[64:67]
  ds_read_b128 v[92:95], v112 offset:35840
  v_cvt_pk_bf16_f32 v83, v22, v23
  v_mfma_f32_16x16x32_bf16 v[68:71], v[252:255], v[60:63], v[68:71]
  s_waitcnt lgkmcnt(5)
  buffer_store_dwordx4 v[80:83], v3, s[48:51], 0 offen nt
  v_mfma_f32_16x16x32_bf16 v[64:67], a[192:195], v[96:99], v[64:67]
  ds_read_b128 v[56:59], v112 offset:36864
  v_max3_u32 v124, v140, v141, v142
  v_mfma_f32_16x16x32_bf16 v[68:71], a[196:199], v[96:99], v[68:71]
  v_max_u32 v124, v124, v143
  v_cmp_eq_u32 vcc, -1, v124
  s_cbranch_vccnz LS_s5r_53
LS_s5b_55:
  s_waitcnt lgkmcnt(5)
  v_mfma_f32_16x16x32_bf16 v[64:67], a[200:203], v[100:103], v[64:67]
  ds_read_b128 v[60:63], v112 offset:37888
  v_add_f32 v140, v140, v141
  v_mfma_f32_16x16x32_bf16 v[68:71], a[204:207], v[100:103], v[68:71]
  s_waitcnt lgkmcnt(5)
  v_add_f32 v142, v142, v143
  v_add_f32 v140, v140, v142
  v_mfma_f32_16x16x32_bf16 v[64:67], a[208:211], v[104:107], v[64:67]
  s_lshl_b32 s25, s11, 14
  s_add_u32 s25, s25, 73728
  s_waitcnt vmcnt(6)
  v_add_u32 v112, s25, v1
  s_barrier
  ds_read_b128 v[96:99], v112 offset:0
  v_mfma_f32_16x16x32_bf16 v[68:71], a[212:215], v[104:107], v[68:71]
  s_waitcnt lgkmcnt(5)
  buffer_load_dwordx4 v135, s[16:19], s63 offen offset:1024 sc1 lds
  v_mov_b32 v141, v140
  v_mfma_f32_16x16x32_bf16 v[64:67], a[216:219], v[108:111], v[64:67]
  s_nop 0
  ds_read_b128 v[100:103], v112 offset:1024
  v_mfma_f32_16x16x32_bf16 v[68:71], a[220:223], v[108:111], v[68:71]
  s_waitcnt lgkmcnt(5)
  buffer_load_dwordx4 v135, s[16:19], s63 offen offset:2048 sc1 lds
  v_mfma_f32_16x16x32_bf16 v[64:67], a[224:227], v[88:91], v[64:67]
  ds_read_b128 v[104:107], v112 offset:2048
  v_mfma_f32_16x16x32_bf16 v[68:71], a[228:231], v[88:91], v[68:71]
  s_waitcnt lgkmcnt(5)
  v_permlane32_swap_b32 v140, v141
  v_mfma_f32_16x16x32_bf16 v[64:67], a[232:235], v[92:95], v[64:67]
  ds_read_b128 v[108:111], v112 offset:3072
  v_add_f32 v140, v140, v141
  v_mfma_f32_16x16x32_bf16 v[68:71], a[236:239], v[92:95], v[68:71]
  v_mov_b32 v141, v140
  s_nop 0
  s_waitcnt lgkmcnt(5)
  v_mfma_f32_16x16x32_bf16 v[64:67], a[240:243], v[56:59], v[64:67]
  ds_read_b128 v[88:91], v112 offset:4096
  v_mfma_f32_16x16x32_bf16 v[68:71], a[244:247], v[56:59], v[68:71]
  s_waitcnt lgkmcnt(5)
  v_permlane16_swap_b32 v140, v141
  v_mfma_f32_16x16x32_bf16 v[64:67], a[248:251], v[60:63], v[64:67]
  ds_read_b128 v[92:95], v112 offset:5120
  v_add_f32 v140, v140, v141
  v_mfma_f32_16x16x32_bf16 v[68:71], a[252:255], v[60:63], v[68:71]
  s_waitcnt lgkmcnt(5)
  v_mul_f32 v140, 0x3b000000, v140
  v_add_f32 v140, 0x3727c5ac, v140
  v_mfma_f32_16x16x32_bf16 v[72:75], v[144:147], v[96:99], 0
  s_add_u32 s3, s65, 38912
  ds_read_b128 v[56:59], v112 offset:6144
  v_rcp_f32 v15, v140
  v_mfma_f32_16x16x32_bf16 v[76:79], v[148:151], v[96:99], 0
  v_add_u32 v114, s3, v1
  s_xor_b32 s3, s65, 16384
  s_add_u32 s3, s3, 38912
  s_waitcnt lgkmcnt(5)
  v_mfma_f32_16x16x32_bf16 v[72:75], v[152:155], v[100:103], v[72:75]
  ds_read_b128 v[60:63], v112 offset:7168
  v_add_u32 v115, s3, v1
  v_mfma_f32_16x16x32_bf16 v[76:79], v[156:159], v[100:103], v[76:79]
  s_waitcnt lgkmcnt(5)
  v_mfma_f32_16x16x32_bf16 v[72:75], v[160:163], v[104:107], v[72:75]
  s_waitcnt vmcnt(4)
  s_barrier
  ds_read_b128 v[96:99], v112 offset:32768
  v_mfma_f32_16x16x32_bf16 v[76:79], v[164:167], v[104:107], v[76:79]
  s_waitcnt lgkmcnt(5)
  v_mfma_f32_16x16x32_bf16 v[72:75], v[168:171], v[108:111], v[72:75]
  ds_read_b128 v[100:103], v112 offset:33792
  v_mfma_f32_16x16x32_bf16 v[76:79], v[172:175], v[108:111], v[76:79]
  s_waitcnt lgkmcnt(5)
  v_mfma_f32_16x16x32_bf16 v[72:75], v[176:179], v[88:91], v[72:75]
  ds_read_b128 v[104:107], v112 offset:34816
  v_mfma_f32_16x16x32_bf16 v[76:79], v[180:183], v[88:91], v[76:79]
  s_waitcnt lgkmcnt(5)
  v_mfma_f32_16x16x32_bf16 v[72:75], v[184:187], v[92:95], v[72:75]
  ds_read_b128 v[108:111], v112 offset:35840
  v_mfma_f32_16x16x32_bf16 v[76:79], v[188:191], v[92:95], v[76:79]
  s_waitcnt lgkmcnt(5)
  v_mfma_f32_16x16x32_bf16 v[72:75], v[192:195], v[56:59], v[72:75]
  ds_read_b128 v[88:91], v112 offset:36864
  v_mfma_f32_16x16x32_bf16 v[76:79], v[196:199], v[56:59], v[76:79]
  s_waitcnt lgkmcnt(5)
  v_mfma_f32_16x16x32_bf16 v[72:75], v[200:203], v[60:63], v[72:75]
  ds_read_b128 v[92:95], v112 offset:37888
  v_mfma_f32_16x16x32_bf16 v[76:79], v[204:207], v[60:63], v[76:79]
  s_waitcnt lgkmcnt(5)
  v_mfma_f32_16x16x32_bf16 v[72:75], v[208:211], v[96:99], v[72:75]
  ds_read_b128 v[56:59], v112 offset:38912
  v_mfma_f32_16x16x32_bf16 v[76:79], v[212:215], v[96:99], v[76:79]
  s_waitcnt lgkmcnt(5)
  v_mfma_f32_16x16x32_bf16 v[72:75], v[216:219], v[100:103], v[72:75]
  ds_read_b128 v[60:63], v112 offset:39936
  v_mfma_f32_16x16x32_bf16 v[76:79], v[220:223], v[100:103], v[76:79]
  s_waitcnt lgkmcnt(5)
  v_mfma_f32_16x16x32_bf16 v[72:75], v[224:227], v[104:107], v[72:75]
  s_lshl_b32 s25, s11, 14
  s_add_u32 s25, s25, 8192
  s_waitcnt vmcnt(0)
  v_add_u32 v112, s25, v1
  s_barrier
  ds_read_b128 v[96:99], v112 offset:32768
  v_mfma_f32_16x16x32_bf16 v[76:79], v[228:231], v[104:107], v[76:79]
  s_waitcnt lgkmcnt(5)
  v_mfma_f32_16x16x32_bf16 v[72:75], v[232:235], v[108:111], v[72:75]
  ds_read_b128 v[100:103], v112 offset:33792
  v_mfma_f32_16x16x32_bf16 v[76:79], v[236:239], v[108:111], v[76:79]
  s_waitcnt lgkmcnt(5)
  v_mfma_f32_16x16x32_bf16 v[72:75], v[240:243], v[88:91], v[72:75]
  ds_read_b128 v[104:107], v112 offset:34816
  v_mfma_f32_16x16x32_bf16 v[76:79], v[244:247], v[88:91], v[76:79]
  s_waitcnt lgkmcnt(5)
  v_mfma_f32_16x16x32_bf16 v[72:75], v[248:251], v[92:95], v[72:75]
  ds_read_b128 v[108:111], v112 offset:35840
  v_mfma_f32_16x16x32_bf16 v[76:79], v[252:255], v[92:95], v[76:79]
  s_waitcnt lgkmcnt(5)
  v_mfma_f32_16x16x32_bf16 v[72:75], a[192:195], v[56:59], v[72:75]
  ds_read_b128 v[88:91], v112 offset:36864
  v_mfma_f32_16x16x32_bf16 v[76:79], a[196:199], v[56:59], v[76:79]
  s_waitcnt lgkmcnt(5)
  v_mfma_f32_16x16x32_bf16 v[72:75], a[200:203], v[60:63], v[72:75]
  ds_read_b128 v[92:95], v112 offset:37888
  v_mfma_f32_16x16x32_bf16 v[76:79], a[204:207], v[60:63], v[76:79]
  s_waitcnt lgkmcnt(5)
  v_mfma_f32_16x16x32_bf16 v[72:75], a[208:211], v[96:99], v[72:75]
  v_mfma_f32_16x16x32_bf16 v[76:79], a[212:215], v[96:99], v[76:79]
  s_waitcnt lgkmcnt(4)
  v_mfma_f32_16x16x32_bf16 v[72:75], a[216:219], v[100:103], v[72:75]
  v_mfma_f32_16x16x32_bf16 v[76:79], a[220:223], v[100:103], v[76:79]
  s_waitcnt lgkmcnt(3)
  v_mfma_f32_16x16x32_bf16 v[72:75], a[224:227], v[104:107], v[72:75]
  v_mfma_f32_16x16x32_bf16 v[76:79], a[228:231], v[104:107], v[76:79]
  s_waitcnt lgkmcnt(2)
  v_mfma_f32_16x16x32_bf16 v[72:75], a[232:235], v[108:111], v[72:75]
  v_mfma_f32_16x16x32_bf16 v[76:79], a[236:239], v[108:111], v[76:79]
  s_waitcnt lgkmcnt(1)
  v_mfma_f32_16x16x32_bf16 v[72:75], a[240:243], v[88:91], v[72:75]
  v_mfma_f32_16x16x32_bf16 v[76:79], a[244:247], v[88:91], v[76:79]
  s_waitcnt lgkmcnt(0)
  v_mfma_f32_16x16x32_bf16 v[72:75], a[248:251], v[92:95], v[72:75]
  v_mfma_f32_16x16x32_bf16 v[76:79], a[252:255], v[92:95], v[76:79]
  s_nop 7
  s_cmp_eq_u32 s11, 0
  s_cbranch_scc1 LS_sw_68
  v_swap_b32 v64, v72
  v_swap_b32 v65, v73
  v_swap_b32 v66, v74
  v_swap_b32 v67, v75
  v_swap_b32 v68, v76
  v_swap_b32 v69, v77
  v_swap_b32 v70, v78
  v_swap_b32 v71, v79
LS_sw_68:
  ds_write_b128 v114, v[72:75]
  ds_write_b128 v114, v[76:79] offset:1024
  v_fmac_f32 v24, v15, v64
  v_fmac_f32 v25, v15, v65
  v_fmac_f32 v26, v15, v66
  v_fmac_f32 v27, v15, v67
  v_fmac_f32 v28, v15, v68
  v_fmac_f32 v29, v15, v69
  v_fmac_f32 v30, v15, v70
  v_fmac_f32 v31, v15, v71
  s_waitcnt lgkmcnt(0)
  s_barrier
  ds_read_b128 v[72:75], v115
  ds_read_b128 v[76:79], v115 offset:1024
  s_waitcnt lgkmcnt(1)
  v_fmac_f32 v24, v15, v72
  v_fmac_f32 v25, v15, v73
  v_fmac_f32 v26, v15, v74
  v_fmac_f32 v27, v15, v75
  s_waitcnt lgkmcnt(0)
  v_fmac_f32 v28, v15, v76
  v_fmac_f32 v29, v15, v77
  v_fmac_f32 v30, v15, v78
  v_fmac_f32 v31, v15, v79
  v_cvt_pk_bf16_f32 v80, v24, v25
  v_cvt_pk_bf16_f32 v81, v26, v27
  v_cvt_pk_bf16_f32 v82, v28, v29
  v_cvt_pk_bf16_f32 v83, v30, v31
  buffer_store_dwordx4 v[80:83], v3, s[48:51], s0 offen nt
  s_or_b32 s3, s2, s6
  s_cmp_eq_u32 s3, 0
  s_cselect_b32 s3, 0, 2147483392
  buffer_store_dword v14, v2, s[16:19], s3 offen sc1
  s_endpgm
LS_grr_1:
  s_mov_b32 s62, 0
LS_grl_2:
  buffer_load_dwordx4 v[40:43], v5, s[16:19], s21 offen offset:0 sc1
  buffer_load_dwordx4 v[44:47], v5, s[16:19], s21 offen offset:256 sc1
  buffer_load_dwordx4 v[48:51], v5, s[16:19], s21 offen offset:512 sc1
  buffer_load_dwordx4 v[52:55], v5, s[16:19], s21 offen offset:768 sc1
  s_waitcnt vmcnt(0)
  v_max3_u32 v122, v40, v41, v42
  v_max3_u32 v122, v122, v43, v44
  v_max3_u32 v122, v122, v45, v46
  v_max3_u32 v122, v122, v47, v48
  v_max3_u32 v122, v122, v49, v50
  v_max3_u32 v122, v122, v51, v52
  v_max3_u32 v122, v122, v53, v54
  v_max_u32 v122, v122, v55
  v_cmp_eq_u32 vcc, -1, v122
  s_cbranch_vccz LS_grb_3
  s_add_u32 s62, s62, 1
  s_cmp_lt_u32 s62, 65536
  s_cbranch_scc1 LS_grl_2
  s_branch LS_grb_3
LS_grr_4:
  s_mov_b32 s62, 0
LS_grl_5:
  buffer_load_dwordx4 v[232:235], v5, s[16:19], s21 offen offset:0 sc1
  buffer_load_dwordx4 v[236:239], v5, s[16:19], s21 offen offset:256 sc1
  buffer_load_dwordx4 v[240:243], v5, s[16:19], s21 offen offset:512 sc1
  buffer_load_dwordx4 v[244:247], v5, s[16:19], s21 offen offset:768 sc1
  s_waitcnt vmcnt(0)
  v_max3_u32 v122, v232, v233, v234
  v_max3_u32 v122, v122, v235, v236
  v_max3_u32 v122, v122, v237, v238
  v_max3_u32 v122, v122, v239, v240
  v_max3_u32 v122, v122, v241, v242
  v_max3_u32 v122, v122, v243, v244
  v_max3_u32 v122, v122, v245, v246
  v_max_u32 v122, v122, v247
  v_cmp_eq_u32 vcc, -1, v122
  s_cbranch_vccz LS_grb_6
  s_add_u32 s62, s62, 1
  s_cmp_lt_u32 s62, 65536
  s_cbranch_scc1 LS_grl_5
  s_branch LS_grb_6
LS_ytr_7:
  s_mov_b32 s62, 0
LS_ytl_8:
  buffer_load_dwordx4 v[188:191], v164, s[16:19], s0 offen sc1
  s_waitcnt vmcnt(0)
  v_max3_u32 v192, v188, v189, v190
  v_max_u32 v192, v192, v191
  v_cmp_eq_u32 vcc, -1, v192
  s_cbranch_vccz LS_ytb_9
  s_add_u32 s62, s62, 1
  s_cmp_lt_u32 s62, 65536
  s_cbranch_scc1 LS_ytl_8
  s_branch LS_ytb_9
LS_ppr_10:
  s_mov_b32 s62, 0
LS_ppl_11:
  buffer_load_dword v124, v125, s[16:19], s24 offen sc1
  s_waitcnt vmcnt(0)
  v_cmp_ne_u32 vcc, s13, v124
  s_cbranch_vccz LS_ppb_12
  s_add_u32 s62, s62, 1
  s_cmp_lt_u32 s62, 65536
  s_cbranch_scc1 LS_ppl_11
  s_branch LS_ppb_12
LS_xfr_13:
  s_mov_b32 s62, 0
LS_xfl_14:
  buffer_load_dword v123, v12, s[16:19], s20 offen sc1
  s_waitcnt vmcnt(0)
  v_cmp_ne_u32 vcc, s13, v123
  s_cbranch_vccz LS_xfb_15
  s_add_u32 s62, s62, 1
  s_cmp_lt_u32 s62, 65536
  s_cbranch_scc1 LS_xfl_14
  s_branch LS_xfb_15
LS_xfr_16:
  s_mov_b32 s62, 0
LS_xfl_17:
  buffer_load_dword v123, v12, s[16:19], s20 offen sc1
  s_waitcnt vmcnt(0)
  v_cmp_ne_u32 vcc, s13, v123
  s_cbranch_vccz LS_xfb_18
  s_add_u32 s62, s62, 1
  s_cmp_lt_u32 s62, 65536
  s_cbranch_scc1 LS_xfl_17
  s_branch LS_xfb_18
LS_s5r_19:
  s_mov_b32 s62, 0
LS_s5l_20:
  buffer_load_dwordx4 v[140:143], v7, s[16:19], s24 offen sc1
  s_waitcnt vmcnt(0)
  v_max3_u32 v124, v140, v141, v142
  v_max_u32 v124, v124, v143
  v_cmp_eq_u32 vcc, -1, v124
  s_cbranch_vccz LS_s5b_21
  s_add_u32 s62, s62, 1
  s_cmp_lt_u32 s62, 65536
  s_cbranch_scc1 LS_s5l_20
  s_branch LS_s5b_21
LS_s5r_22:
  s_mov_b32 s62, 0
LS_s5l_23:
  buffer_load_dwordx4 v[140:143], v7, s[16:19], s24 offen sc1
  s_waitcnt vmcnt(0)
  v_max3_u32 v124, v140, v141, v142
  v_max_u32 v124, v124, v143
  v_cmp_eq_u32 vcc, -1, v124
  s_cbranch_vccz LS_s5b_24
  s_add_u32 s62, s62, 1
  s_cmp_lt_u32 s62, 65536
  s_cbranch_scc1 LS_s5l_23
  s_branch LS_s5b_24
LS_grr_25:
  s_mov_b32 s62, 0
LS_grl_26:
  buffer_load_dwordx4 v[40:43], v5, s[16:19], s21 offen offset:0 sc1
  buffer_load_dwordx4 v[44:47], v5, s[16:19], s21 offen offset:256 sc1
  buffer_load_dwordx4 v[48:51], v5, s[16:19], s21 offen offset:512 sc1
  buffer_load_dwordx4 v[52:55], v5, s[16:19], s21 offen offset:768 sc1
  s_waitcnt vmcnt(0)
  v_max3_u32 v122, v40, v41, v42
  v_max3_u32 v122, v122, v43, v44
  v_max3_u32 v122, v122, v45, v46
  v_max3_u32 v122, v122, v47, v48
  v_max3_u32 v122, v122, v49, v50
  v_max3_u32 v122, v122, v51, v52
  v_max3_u32 v122, v122, v53, v54
  v_max_u32 v122, v122, v55
  v_cmp_eq_u32 vcc, -1, v122
  s_cbranch_vccz LS_grb_27
  s_add_u32 s62, s62, 1
  s_cmp_lt_u32 s62, 65536
  s_cbranch_scc1 LS_grl_26
  s_branch LS_grb_27
LS_xfr_28:
  s_mov_b32 s62, 0
LS_xfl_29:
  buffer_load_dword v123, v12, s[16:19], s20 offen sc1
  s_waitcnt vmcnt(0)
  v_cmp_ne_u32 vcc, s13, v123
  s_cbranch_vccz LS_xfb_30
  s_add_u32 s62, s62, 1
  s_cmp_lt_u32 s62, 65536
  s_cbranch_scc1 LS_xfl_29
  s_branch LS_xfb_30
LS_hfr_31:
  s_mov_b32 s62, 0
LS_hfl_32:
  buffer_load_dword v123, v13, s[16:19], s20 offen sc1
  s_waitcnt vmcnt(0)
  v_cmp_ne_u32 vcc, s13, v123
  s_cbranch_vccz LS_hfb_33
  s_add_u32 s62, s62, 1
  s_cmp_lt_u32 s62, 65536
  s_cbranch_scc1 LS_hfl_32
  s_branch LS_hfb_33
LS_hfr_34:
  s_mov_b32 s62, 0
LS_hfl_35:
  buffer_load_dword v123, v13, s[16:19], s20 offen sc1
  s_waitcnt vmcnt(0)
  v_cmp_ne_u32 vcc, s13, v123
  s_cbranch_vccz LS_hfb_36
  s_add_u32 s62, s62, 1
  s_cmp_lt_u32 s62, 65536
  s_cbranch_scc1 LS_hfl_35
  s_branch LS_hfb_36
LS_hfr_37:
  s_mov_b32 s62, 0
LS_hfl_38:
  buffer_load_dword v123, v13, s[16:19], s20 offen sc1
  s_waitcnt vmcnt(0)
  v_cmp_ne_u32 vcc, s13, v123
  s_cbranch_vccz LS_hfb_39
  s_add_u32 s62, s62, 1
  s_cmp_lt_u32 s62, 65536
  s_cbranch_scc1 LS_hfl_38
  s_branch LS_hfb_39
LS_hfr_40:
  s_mov_b32 s62, 0
LS_hfl_41:
  buffer_load_dword v123, v13, s[16:19], s20 offen sc1
  s_waitcnt vmcnt(0)
  v_cmp_ne_u32 vcc, s13, v123
  s_cbranch_vccz LS_hfb_42
  s_add_u32 s62, s62, 1
  s_cmp_lt_u32 s62, 65536
  s_cbranch_scc1 LS_hfl_41
  s_branch LS_hfb_42
LS_grr_44:
  s_mov_b32 s62, 0
LS_grl_45:
  buffer_load_dwordx4 v[64:67], v5, s[16:19], s21 offen offset:0 sc1
  buffer_load_dwordx4 v[68:71], v5, s[16:19], s21 offen offset:256 sc1
  buffer_load_dwordx4 v[72:75], v5, s[16:19], s21 offen offset:512 sc1
  buffer_load_dwordx4 v[76:79], v5, s[16:19], s21 offen offset:768 sc1
  s_waitcnt vmcnt(0)
  v_max3_u32 v122, v64, v65, v66
  v_max3_u32 v122, v122, v67, v68
  v_max3_u32 v122, v122, v69, v70
  v_max3_u32 v122, v122, v71, v72
  v_max3_u32 v122, v122, v73, v74
  v_max3_u32 v122, v122, v75, v76
  v_max3_u32 v122, v122, v77, v78
  v_max_u32 v122, v122, v79
  v_cmp_eq_u32 vcc, -1, v122
  s_cbranch_vccz LS_grb_46
  s_add_u32 s62, s62, 1
  s_cmp_lt_u32 s62, 65536
  s_cbranch_scc1 LS_grl_45
  s_branch LS_grb_46
LS_xfr_47:
  s_mov_b32 s62, 0
LS_xfl_48:
  buffer_load_dword v123, v12, s[16:19], s20 offen sc1
  s_waitcnt vmcnt(0)
  v_cmp_ne_u32 vcc, s13, v123
  s_cbranch_vccz LS_xfb_49
  s_add_u32 s62, s62, 1
  s_cmp_lt_u32 s62, 65536
  s_cbranch_scc1 LS_xfl_48
  s_branch LS_xfb_49
LS_s5r_50:
  s_mov_b32 s62, 0
LS_s5l_51:
  buffer_load_dwordx4 v[140:143], v7, s[16:19], s24 offen sc1
  s_waitcnt vmcnt(0)
  v_max3_u32 v124, v140, v141, v142
  v_max_u32 v124, v124, v143
  v_cmp_eq_u32 vcc, -1, v124
  s_cbranch_vccz LS_s5b_52
  s_add_u32 s62, s62, 1
  s_cmp_lt_u32 s62, 65536
  s_cbranch_scc1 LS_s5l_51
  s_branch LS_s5b_52
LS_s5r_53:
  s_mov_b32 s62, 0
LS_s5l_54:
  buffer_load_dwordx4 v[140:143], v7, s[16:19], s24 offen sc1
  s_waitcnt vmcnt(0)
  v_max3_u32 v124, v140, v141, v142
  v_max_u32 v124, v124, v143
  v_cmp_eq_u32 vcc, -1, v124
  s_cbranch_vccz LS_s5b_55
  s_add_u32 s62, s62, 1
  s_cmp_lt_u32 s62, 65536
  s_cbranch_scc1 LS_s5l_54
  s_branch LS_s5b_55
LS_hfr_56:
  s_mov_b32 s62, 0
LS_hfl_57:
  buffer_load_dword v123, v13, s[16:19], s20 offen sc1
  s_waitcnt vmcnt(0)
  v_cmp_ne_u32 vcc, s13, v123
  s_cbranch_vccz LS_hfb_58
  s_add_u32 s62, s62, 1
  s_cmp_lt_u32 s62, 65536
  s_cbranch_scc1 LS_hfl_57
  s_branch LS_hfb_58
LS_hfr_59:
  s_mov_b32 s62, 0
LS_hfl_60:
  buffer_load_dword v123, v13, s[16:19], s20 offen sc1
  s_waitcnt vmcnt(0)
  v_cmp_ne_u32 vcc, s13, v123
  s_cbranch_vccz LS_hfb_61
  s_add_u32 s62, s62, 1
  s_cmp_lt_u32 s62, 65536
  s_cbranch_scc1 LS_hfl_60
  s_branch LS_hfb_61
LS_hfr_62:
  s_mov_b32 s62, 0
LS_hfl_63:
  buffer_load_dword v123, v13, s[16:19], s20 offen sc1
  s_waitcnt vmcnt(0)
  v_cmp_ne_u32 vcc, s13, v123
  s_cbranch_vccz LS_hfb_64
  s_add_u32 s62, s62, 1
  s_cmp_lt_u32 s62, 65536
  s_cbranch_scc1 LS_hfl_63
  s_branch LS_hfb_64
LS_hfr_65:
  s_mov_b32 s62, 0
LS_hfl_66:
  buffer_load_dword v123, v13, s[16:19], s20 offen sc1
  s_waitcnt vmcnt(0)
  v_cmp_ne_u32 vcc, s13, v123
  s_cbranch_vccz LS_hfb_67
  s_add_u32 s62, s62, 1
  s_cmp_lt_u32 s62, 65536
  s_cbranch_scc1 LS_hfl_66
  s_branch LS_hfb_67
L_end:
  s_endpgm
.section .rodata,"a"
.p2align 6
.amdhsa_kernel interleave_layers__ssm_conv_h3__glu_gated_reglu__prompt_kernel
  .amdhsa_next_free_vgpr 512
  .amdhsa_next_free_sgpr 102
  .amdhsa_accum_offset 256
  .amdhsa_group_segment_fixed_size 0
  .amdhsa_kernarg_size 104
  .amdhsa_user_sgpr_count 2
  .amdhsa_user_sgpr_kernarg_segment_ptr 1
  .amdhsa_system_sgpr_workgroup_id_x 1
.end_amdhsa_kernel
```
